```python
import torch

def _softmax(x, axis=-1):
    return torch.softmax(x, dim=axis)
def _gelu(x):
    return torch.nn.functional.gelu(x, approximate="tanh")
def _silu(x):
    return torch.nn.functional.silu(x)
def _sigmoid(x):
    return torch.sigmoid(x)
def _layernorm(x, axis=-1, eps=1e-5):
    m = x.mean(dim=axis, keepdim=True)
    v = x.var(dim=axis, keepdim=True, unbiased=False)
    return (x - m) / torch.sqrt(v + eps)
def _scatter_add(tgt, idx, src, axis=0):
    return tgt.clone().index_add_(axis, idx, src)
def _segment_sum(src, seg, n):
    out = torch.zeros((n,) + src.shape[1:], dtype=src.dtype)
    return out.index_add_(0, seg, src)
def _pad(x, pw):
    flat = tuple(v for pair in reversed(pw) for v in pair)
    return torch.nn.functional.pad(x, flat)

kernel_name = 'sequential_preLN__spectral_fnet__glu_gated_glu__prompt'

def setup_inputs():

    _w = (lambda a: (lambda t: t.to(torch.bfloat16) if t.is_floating_point() else t)(torch.as_tensor(a)))
    def _A_setup():
        B, S, D = 1, 2048, 576
        ns = torch.arange(S)[:, None] * torch.arange(S)[None, :]
        nd = torch.arange(D)[:, None] * torch.arange(D)[None, :]
        Ws_re = torch.cos(-2.0 * torch.pi * ns / S).to(float)
        Ws_im = torch.sin(-2.0 * torch.pi * ns / S).to(float)
        Wd_re = torch.cos(-2.0 * torch.pi * nd / D).to(float)
        Wd_im = torch.sin(-2.0 * torch.pi * nd / D).to(float)
        return {
            "x": _w((lambda *s: torch.randn(*s, dtype=torch.bfloat16) * 0.05)(B, S, D)),
            "dft_seq_re": _w(Ws_re),
            "dft_seq_im": _w(Ws_im),
            "dft_hid_re": _w(Wd_re),
            "dft_hid_im": _w(Wd_im),
        }
    _A_in = _A_setup()

    def _B_setup():
        B, S, D, F = 1, 2048, 576, 4608
        return {
            "x": _w((lambda *s: torch.randn(*s, dtype=torch.bfloat16) * 0.05)(B, S, D)),
            "w_gate": _w((lambda *s: torch.randn(*s, dtype=torch.bfloat16) * 1.6)(D, F)),
            "w_up": _w((lambda *s: torch.randn(*s, dtype=torch.bfloat16) * 0.4)(D, F)),
            "w_down": _w((lambda *s: torch.randn(*s, dtype=torch.bfloat16) * 0.4)(F, D)),
        }
    _B_in = _B_setup()

    return {
        "A_x": _A_in["x"],
        "A_dft_seq_re": _A_in["dft_seq_re"],
        "A_dft_seq_im": _A_in["dft_seq_im"],
        "A_dft_hid_re": _A_in["dft_hid_re"],
        "A_dft_hid_im": _A_in["dft_hid_im"],
        "B_x": _B_in["x"],
        "B_w_gate": _B_in["w_gate"],
        "B_w_up": _B_in["w_up"],
        "B_w_down": _B_in["w_down"],
    }

def reference(A_x, A_dft_seq_re, A_dft_seq_im, A_dft_hid_re, A_dft_hid_im, B_x, B_w_gate, B_w_up, B_w_down):
    def _A_ref(x, dft_seq_re, dft_seq_im, dft_hid_re, dft_hid_im):
        a = torch.einsum("bsd,ed->bse", x, dft_hid_re)
        b = torch.einsum("bsd,ed->bse", x, dft_hid_im)
        y = torch.einsum("ts,bse->bte", dft_seq_re, a) - torch.einsum("ts,bse->bte", dft_seq_im, b)
        return y

    def _B_ref(x, w_gate, w_up, w_down):
        g = torch.einsum("bsd,df->bsf", x, w_gate)
        u = torch.einsum("bsd,df->bsf", x, w_up)
        h = _sigmoid(g) * u
        return torch.einsum("bsf,fd->bsd", h, w_down)

    x = A_x
    h = x + _A_ref(_layernorm(x, axis=-1), A_dft_seq_re, A_dft_seq_im, A_dft_hid_re, A_dft_hid_im)
    h2 = h + _B_ref(_layernorm(h, axis=-1), B_w_gate, B_w_up, B_w_down)
    return h2
```

```asm
; @launch kernel=sequential_preLN__spectral_fnet__glu_gated_glu__prompt_kernel grid=(256,1,1) block=(512,1,1) lds=147712
.amdgcn_target "amdgcn-amd-amdhsa--gfx950"
.text
.globl sequential_preLN__spectral_fnet__glu_gated_glu__prompt_kernel
.p2align 8
.type sequential_preLN__spectral_fnet__glu_gated_glu__prompt_kernel,@function
sequential_preLN__spectral_fnet__glu_gated_glu__prompt_kernel:
    s_cmp_ge_u32 s2, 256
    s_cbranch_scc1 L_k1_end
    s_load_dwordx2 s[4:5], s[0:1], 0
    s_load_dwordx4 s[12:15], s[0:1], 24
    s_load_dwordx2 s[8:9], s[0:1], 88
    s_load_dwordx4 s[60:63], s[0:1], 8
    s_load_dwordx4 s[92:95], s[0:1], 48
    s_load_dwordx2 s[90:91], s[0:1], 64
    s_load_dwordx2 s[88:89], s[0:1], 80
    s_getpc_b64 s[98:99]
L_sequential_preLN__spectral_fnet__glu_gated_glu__prompt_pc_1:
    v_min_u32 v198, 63, v0
    v_lshlrev_b32 v198, 7, v198
    global_load_dword v198, v198, s[98:99]
    v_lshrrev_b32 v1, 6, v0
    v_and_b32 v2, 63, v0
    v_readfirstlane_b32 s28, v1
    s_and_b32 s3, s2, 7
    s_lshr_b32 s33, s2, 3
    s_lshr_b32 s30, s3, 2
    s_cmp_ge_u32 s33, 24
    s_cbranch_scc1 L_k1_pf
    s_mul_i32 s34, s33, 43
    s_lshr_b32 s35, s34, 7
    s_mul_i32 s34, s35, 3
    s_sub_u32 s31, s33, s34
    s_and_b32 s29, s3, 3
    s_lshl_b32 s29, s29, 3
    s_add_u32 s29, s29, s35
    v_lshrrev_b32 v3, 3, v2
    v_and_b32 v4, 7, v2
    v_mul_u32_u24 v5, 1152, v3
    v_lshl_add_u32 v6, v4, 4, v5
    v_xor_b32 v7, v4, v3
    v_lshl_add_u32 v7, v7, 4, v5
    s_lshl_b32 s34, s29, 3
    s_add_u32 s34, s34, s28
    s_mul_i32 s34, s34, 9216
    s_waitcnt lgkmcnt(0)
    s_mov_b32 s16, s4
    s_mov_b32 s17, s5
    s_mov_b32 s18, 0x240000
    s_mov_b32 s19, 0x20000
    buffer_load_dwordx4 v[8:11], v6, s[16:19], s34 offen offset:0
    buffer_load_dwordx4 v[12:15], v6, s[16:19], s34 offen offset:128
    buffer_load_dwordx4 v[16:19], v6, s[16:19], s34 offen offset:256
    buffer_load_dwordx4 v[20:23], v6, s[16:19], s34 offen offset:384
    buffer_load_dwordx4 v[24:27], v6, s[16:19], s34 offen offset:512
    buffer_load_dwordx4 v[28:31], v6, s[16:19], s34 offen offset:640
    buffer_load_dwordx4 v[32:35], v6, s[16:19], s34 offen offset:768
    buffer_load_dwordx4 v[36:39], v6, s[16:19], s34 offen offset:896
    buffer_load_dwordx4 v[40:43], v6, s[16:19], s34 offen offset:1024
    s_cmp_eq_u32 s30, 0
    s_cselect_b32 s20, s12, s14
    s_cselect_b32 s21, s13, s15
    s_mov_b32 s22, 663552
    s_mov_b32 s23, 0x20000
    s_mul_i32 s39, s31, 221184
    s_mul_i32 s37, s28, 27648
    s_add_u32 s37, s37, s39
    s_mul_i32 s40, s28, 3072
    s_add_u32 s40, s40, 73728
    s_mov_b32 s48, s35
    s_add_u32 s24, s8, 0x0
    s_addc_u32 s25, s9, 0
    s_mov_b32 s26, 0x480000
    s_mov_b32 s27, 0x20000
    s_lshl_b32 s47, s48, 7
    s_add_u32 s47, s47, s37
    s_add_u32 m0, s40, 0
    s_add_u32 s41, s47, 0
    buffer_load_dwordx4 v7, s[20:23], s41 offen lds
    s_add_u32 m0, s40, 1024
    s_add_u32 s41, s47, 9216
    buffer_load_dwordx4 v7, s[20:23], s41 offen lds
    s_add_u32 m0, s40, 2048
    s_add_u32 s41, s47, 18432
    buffer_load_dwordx4 v7, s[20:23], s41 offen lds
    s_add_u32 s48, s48, 1
    s_cmp_eq_u32 s48, 9
    s_cselect_b32 s48, 0, s48
    s_lshl_b32 s47, s48, 7
    s_add_u32 s47, s47, s37
    s_add_u32 m0, s40, 24576
    s_add_u32 s41, s47, 0
    buffer_load_dwordx4 v7, s[20:23], s41 offen lds
    s_add_u32 m0, s40, 25600
    s_add_u32 s41, s47, 9216
    buffer_load_dwordx4 v7, s[20:23], s41 offen lds
    s_add_u32 m0, s40, 26624
    s_add_u32 s41, s47, 18432
    buffer_load_dwordx4 v7, s[20:23], s41 offen lds
    s_add_u32 s48, s48, 1
    s_cmp_eq_u32 s48, 9
    s_cselect_b32 s48, 0, s48
    s_lshl_b32 s47, s48, 7
    s_add_u32 s47, s47, s37
    s_add_u32 m0, s40, 49152
    s_add_u32 s41, s47, 0
    buffer_load_dwordx4 v7, s[20:23], s41 offen lds
    s_add_u32 m0, s40, 50176
    s_add_u32 s41, s47, 9216
    buffer_load_dwordx4 v7, s[20:23], s41 offen lds
    s_add_u32 m0, s40, 51200
    s_add_u32 s41, s47, 18432
    buffer_load_dwordx4 v7, s[20:23], s41 offen lds
    s_add_u32 s48, s48, 1
    s_cmp_eq_u32 s48, 9
    s_cselect_b32 s48, 0, s48
    v_lshlrev_b32 v180, 4, v2
    s_cmp_ge_u32 s28, 4
    s_cbranch_scc1 L_k1_nosetup
    v_and_b32 v184, 15, v2
    v_lshrrev_b32 v185, 4, v2
    v_and_b32 v186, 7, v184
    v_xor_b32 v186, v186, v185
    v_lshlrev_b32 v186, 4, v186
    s_bfe_u32 s44, s28, 0x10001
    s_and_b32 s45, s28, 1
    v_lshrrev_b32 v187, 2, v184
    v_lshlrev_b32 v187, 3, v187
    v_and_b32 v188, 3, v184
    v_add_u32 v187, v187, v188
    v_lshl_add_u32 v187, v187, 7, v186
    s_lshl_b32 s46, s44, 12
    s_lshl_b32 s53, s35, 13
    s_add_u32 s46, s46, s53
    v_lshlrev_b32 v180, 4, v2
    v_add_u32 v176, s46, v187
    v_xor_b32 v177, 64, v176
    v_lshl_add_u32 v188, v184, 7, v186
    s_mul_i32 s53, s45, 12288
    s_add_u32 s53, s53, 73728
    v_add_u32 v178, s53, v188
    v_xor_b32 v179, 64, v178
    s_lshl_b32 s53, s44, 7
    s_add_u32 s53, s53, 147456
    v_lshl_add_u32 v181, v185, 5, s53
    s_lshl_b32 s46, s30, 6
    s_lshl_b32 s53, s29, 1
    s_add_u32 s46, s46, s53
    s_add_u32 s46, s46, s44
    s_mul_i32 s46, s46, 9216
    s_mul_i32 s38, s31, 12
    s_mul_i32 s53, s45, 6
    s_add_u32 s38, s38, s53
    v_mov_b32 v128, 0
    v_mov_b32 v129, 0
    v_mov_b32 v130, 0
    v_mov_b32 v131, 0
    v_mov_b32 v132, 0
    v_mov_b32 v133, 0
    v_mov_b32 v134, 0
    v_mov_b32 v135, 0
    v_mov_b32 v136, 0
    v_mov_b32 v137, 0
    v_mov_b32 v138, 0
    v_mov_b32 v139, 0
    v_mov_b32 v140, 0
    v_mov_b32 v141, 0
    v_mov_b32 v142, 0
    v_mov_b32 v143, 0
    v_mov_b32 v144, 0
    v_mov_b32 v145, 0
    v_mov_b32 v146, 0
    v_mov_b32 v147, 0
    v_mov_b32 v148, 0
    v_mov_b32 v149, 0
    v_mov_b32 v150, 0
    v_mov_b32 v151, 0
    v_mov_b32 v152, 0
    v_mov_b32 v153, 0
    v_mov_b32 v154, 0
    v_mov_b32 v155, 0
    v_mov_b32 v156, 0
    v_mov_b32 v157, 0
    v_mov_b32 v158, 0
    v_mov_b32 v159, 0
    v_mov_b32 v160, 0
    v_mov_b32 v161, 0
    v_mov_b32 v162, 0
    v_mov_b32 v163, 0
    v_mov_b32 v164, 0
    v_mov_b32 v165, 0
    v_mov_b32 v166, 0
    v_mov_b32 v167, 0
    v_mov_b32 v168, 0
    v_mov_b32 v169, 0
    v_mov_b32 v170, 0
    v_mov_b32 v171, 0
    v_mov_b32 v172, 0
    v_mov_b32 v173, 0
    v_mov_b32 v174, 0
    v_mov_b32 v175, 0
    s_add_u32 s53, s38, 0
    s_lshr_b32 s58, s53, 3
    s_and_b32 s59, s53, 7
    s_cmp_ge_u32 s53, 32
    s_cselect_b32 s58, s59, s58
    s_cselect_b32 s59, 8, s59
    s_mul_i32 s58, s58, 1179648
    s_lshl_b32 s59, s59, 10
    s_add_u32 s58, s58, s59
    s_add_u32 s80, s58, s46
    s_add_u32 s53, s38, 1
    s_lshr_b32 s58, s53, 3
    s_and_b32 s59, s53, 7
    s_cmp_ge_u32 s53, 32
    s_cselect_b32 s58, s59, s58
    s_cselect_b32 s59, 8, s59
    s_mul_i32 s58, s58, 1179648
    s_lshl_b32 s59, s59, 10
    s_add_u32 s58, s58, s59
    s_add_u32 s81, s58, s46
    s_add_u32 s53, s38, 2
    s_lshr_b32 s58, s53, 3
    s_and_b32 s59, s53, 7
    s_cmp_ge_u32 s53, 32
    s_cselect_b32 s58, s59, s58
    s_cselect_b32 s59, 8, s59
    s_mul_i32 s58, s58, 1179648
    s_lshl_b32 s59, s59, 10
    s_add_u32 s58, s58, s59
    s_add_u32 s82, s58, s46
    s_add_u32 s53, s38, 3
    s_lshr_b32 s58, s53, 3
    s_and_b32 s59, s53, 7
    s_cmp_ge_u32 s53, 32
    s_cselect_b32 s58, s59, s58
    s_cselect_b32 s59, 8, s59
    s_mul_i32 s58, s58, 1179648
    s_lshl_b32 s59, s59, 10
    s_add_u32 s58, s58, s59
    s_add_u32 s83, s58, s46
    s_add_u32 s53, s38, 4
    s_lshr_b32 s58, s53, 3
    s_and_b32 s59, s53, 7
    s_cmp_ge_u32 s53, 32
    s_cselect_b32 s58, s59, s58
    s_cselect_b32 s59, 8, s59
    s_mul_i32 s58, s58, 1179648
    s_lshl_b32 s59, s59, 10
    s_add_u32 s58, s58, s59
    s_add_u32 s84, s58, s46
    s_add_u32 s53, s38, 5
    s_lshr_b32 s58, s53, 3
    s_and_b32 s59, s53, 7
    s_cmp_ge_u32 s53, 32
    s_cselect_b32 s58, s59, s58
    s_cselect_b32 s59, 8, s59
    s_mul_i32 s58, s58, 1179648
    s_lshl_b32 s59, s59, 10
    s_add_u32 s58, s58, s59
    s_add_u32 s85, s58, s46
L_k1_nosetup:
    s_waitcnt vmcnt(9)
    v_lshlrev_b32 v44, 16, v8
    v_and_b32 v45, 0xffff0000, v8
    v_lshlrev_b32 v46, 16, v9
    v_and_b32 v47, 0xffff0000, v9
    v_lshlrev_b32 v48, 16, v10
    v_and_b32 v49, 0xffff0000, v10
    v_lshlrev_b32 v50, 16, v11
    v_and_b32 v51, 0xffff0000, v11
    v_lshlrev_b32 v52, 16, v12
    v_and_b32 v53, 0xffff0000, v12
    v_lshlrev_b32 v54, 16, v13
    v_and_b32 v55, 0xffff0000, v13
    v_lshlrev_b32 v56, 16, v14
    v_and_b32 v57, 0xffff0000, v14
    v_lshlrev_b32 v58, 16, v15
    v_and_b32 v59, 0xffff0000, v15
    v_lshlrev_b32 v60, 16, v16
    v_and_b32 v61, 0xffff0000, v16
    v_lshlrev_b32 v62, 16, v17
    v_and_b32 v63, 0xffff0000, v17
    v_lshlrev_b32 v64, 16, v18
    v_and_b32 v65, 0xffff0000, v18
    v_lshlrev_b32 v66, 16, v19
    v_and_b32 v67, 0xffff0000, v19
    v_lshlrev_b32 v68, 16, v20
    v_and_b32 v69, 0xffff0000, v20
    v_lshlrev_b32 v70, 16, v21
    v_and_b32 v71, 0xffff0000, v21
    v_lshlrev_b32 v72, 16, v22
    v_and_b32 v73, 0xffff0000, v22
    v_lshlrev_b32 v74, 16, v23
    v_and_b32 v75, 0xffff0000, v23
    v_lshlrev_b32 v76, 16, v24
    v_and_b32 v77, 0xffff0000, v24
    v_lshlrev_b32 v78, 16, v25
    v_and_b32 v79, 0xffff0000, v25
    v_lshlrev_b32 v80, 16, v26
    v_and_b32 v81, 0xffff0000, v26
    v_lshlrev_b32 v82, 16, v27
    v_and_b32 v83, 0xffff0000, v27
    v_lshlrev_b32 v84, 16, v28
    v_and_b32 v85, 0xffff0000, v28
    v_lshlrev_b32 v86, 16, v29
    v_and_b32 v87, 0xffff0000, v29
    v_lshlrev_b32 v88, 16, v30
    v_and_b32 v89, 0xffff0000, v30
    v_lshlrev_b32 v90, 16, v31
    v_and_b32 v91, 0xffff0000, v31
    v_lshlrev_b32 v92, 16, v32
    v_and_b32 v93, 0xffff0000, v32
    v_lshlrev_b32 v94, 16, v33
    v_and_b32 v95, 0xffff0000, v33
    v_lshlrev_b32 v96, 16, v34
    v_and_b32 v97, 0xffff0000, v34
    v_lshlrev_b32 v98, 16, v35
    v_and_b32 v99, 0xffff0000, v35
    v_lshlrev_b32 v100, 16, v36
    v_and_b32 v101, 0xffff0000, v36
    v_lshlrev_b32 v102, 16, v37
    v_and_b32 v103, 0xffff0000, v37
    v_lshlrev_b32 v104, 16, v38
    v_and_b32 v105, 0xffff0000, v38
    v_lshlrev_b32 v106, 16, v39
    v_and_b32 v107, 0xffff0000, v39
    v_lshlrev_b32 v108, 16, v40
    v_and_b32 v109, 0xffff0000, v40
    v_lshlrev_b32 v110, 16, v41
    v_and_b32 v111, 0xffff0000, v41
    v_lshlrev_b32 v112, 16, v42
    v_and_b32 v113, 0xffff0000, v42
    v_lshlrev_b32 v114, 16, v43
    v_and_b32 v115, 0xffff0000, v43
    v_pk_add_f32 v[116:117], v[44:45], v[52:53]
    v_pk_add_f32 v[118:119], v[46:47], v[54:55]
    v_pk_add_f32 v[120:121], v[48:49], v[56:57]
    v_pk_add_f32 v[122:123], v[50:51], v[58:59]
    v_pk_add_f32 v[116:117], v[116:117], v[60:61]
    v_pk_add_f32 v[118:119], v[118:119], v[62:63]
    v_pk_add_f32 v[120:121], v[120:121], v[64:65]
    v_pk_add_f32 v[122:123], v[122:123], v[66:67]
    v_pk_add_f32 v[116:117], v[116:117], v[68:69]
    v_pk_add_f32 v[118:119], v[118:119], v[70:71]
    v_pk_add_f32 v[120:121], v[120:121], v[72:73]
    v_pk_add_f32 v[122:123], v[122:123], v[74:75]
    v_pk_add_f32 v[116:117], v[116:117], v[76:77]
    v_pk_add_f32 v[118:119], v[118:119], v[78:79]
    v_pk_add_f32 v[120:121], v[120:121], v[80:81]
    v_pk_add_f32 v[122:123], v[122:123], v[82:83]
    v_pk_add_f32 v[116:117], v[116:117], v[84:85]
    v_pk_add_f32 v[118:119], v[118:119], v[86:87]
    v_pk_add_f32 v[120:121], v[120:121], v[88:89]
    v_pk_add_f32 v[122:123], v[122:123], v[90:91]
    v_pk_add_f32 v[116:117], v[116:117], v[92:93]
    v_pk_add_f32 v[118:119], v[118:119], v[94:95]
    v_pk_add_f32 v[120:121], v[120:121], v[96:97]
    v_pk_add_f32 v[122:123], v[122:123], v[98:99]
    v_pk_add_f32 v[116:117], v[116:117], v[100:101]
    v_pk_add_f32 v[118:119], v[118:119], v[102:103]
    v_pk_add_f32 v[120:121], v[120:121], v[104:105]
    v_pk_add_f32 v[122:123], v[122:123], v[106:107]
    v_pk_add_f32 v[116:117], v[116:117], v[108:109]
    v_pk_add_f32 v[118:119], v[118:119], v[110:111]
    v_pk_add_f32 v[120:121], v[120:121], v[112:113]
    v_pk_add_f32 v[122:123], v[122:123], v[114:115]
    v_pk_add_f32 v[116:117], v[116:117], v[118:119]
    v_pk_add_f32 v[120:121], v[120:121], v[122:123]
    v_pk_add_f32 v[116:117], v[116:117], v[120:121]
    v_add_f32 v116, v116, v117
    s_nop 1
    v_add_f32_dpp v116, v116, v116 quad_perm:[1,0,3,2] row_mask:0xf bank_mask:0xf
    s_nop 1
    v_add_f32_dpp v116, v116, v116 quad_perm:[2,3,0,1] row_mask:0xf bank_mask:0xf
    s_nop 1
    v_add_f32_dpp v116, v116, v116 row_half_mirror row_mask:0xf bank_mask:0xf
    v_mul_f32 v126, 0x3ae38e39, v116
    v_cvt_pk_bf16_f32 v124, v126, v126
    v_lshlrev_b32 v124, 16, v124
    v_sub_f32 v126, v126, v124
    v_sub_f32 v124, 0, v124
    v_mov_b32 v125, v124
    v_pk_add_f32 v[44:45], v[44:45], v[124:125]
    v_pk_add_f32 v[46:47], v[46:47], v[124:125]
    v_pk_add_f32 v[48:49], v[48:49], v[124:125]
    v_pk_add_f32 v[50:51], v[50:51], v[124:125]
    v_pk_add_f32 v[52:53], v[52:53], v[124:125]
    v_pk_add_f32 v[54:55], v[54:55], v[124:125]
    v_pk_add_f32 v[56:57], v[56:57], v[124:125]
    v_pk_add_f32 v[58:59], v[58:59], v[124:125]
    v_pk_add_f32 v[60:61], v[60:61], v[124:125]
    v_pk_add_f32 v[62:63], v[62:63], v[124:125]
    v_pk_add_f32 v[64:65], v[64:65], v[124:125]
    v_pk_add_f32 v[66:67], v[66:67], v[124:125]
    v_pk_add_f32 v[68:69], v[68:69], v[124:125]
    v_pk_add_f32 v[70:71], v[70:71], v[124:125]
    v_pk_add_f32 v[72:73], v[72:73], v[124:125]
    v_pk_add_f32 v[74:75], v[74:75], v[124:125]
    v_pk_add_f32 v[76:77], v[76:77], v[124:125]
    v_pk_add_f32 v[78:79], v[78:79], v[124:125]
    v_pk_add_f32 v[80:81], v[80:81], v[124:125]
    v_pk_add_f32 v[82:83], v[82:83], v[124:125]
    v_pk_add_f32 v[84:85], v[84:85], v[124:125]
    v_pk_add_f32 v[86:87], v[86:87], v[124:125]
    v_pk_add_f32 v[88:89], v[88:89], v[124:125]
    v_pk_add_f32 v[90:91], v[90:91], v[124:125]
    v_pk_add_f32 v[92:93], v[92:93], v[124:125]
    v_pk_add_f32 v[94:95], v[94:95], v[124:125]
    v_pk_add_f32 v[96:97], v[96:97], v[124:125]
    v_pk_add_f32 v[98:99], v[98:99], v[124:125]
    v_pk_add_f32 v[100:101], v[100:101], v[124:125]
    v_pk_add_f32 v[102:103], v[102:103], v[124:125]
    v_pk_add_f32 v[104:105], v[104:105], v[124:125]
    v_pk_add_f32 v[106:107], v[106:107], v[124:125]
    v_pk_add_f32 v[108:109], v[108:109], v[124:125]
    v_pk_add_f32 v[110:111], v[110:111], v[124:125]
    v_pk_add_f32 v[112:113], v[112:113], v[124:125]
    v_pk_add_f32 v[114:115], v[114:115], v[124:125]
    v_pk_mul_f32 v[116:117], v[44:45], v[44:45]
    v_pk_mul_f32 v[118:119], v[46:47], v[46:47]
    v_pk_mul_f32 v[120:121], v[48:49], v[48:49]
    v_pk_mul_f32 v[122:123], v[50:51], v[50:51]
    v_pk_fma_f32 v[116:117], v[52:53], v[52:53], v[116:117]
    v_pk_fma_f32 v[118:119], v[54:55], v[54:55], v[118:119]
    v_pk_fma_f32 v[120:121], v[56:57], v[56:57], v[120:121]
    v_pk_fma_f32 v[122:123], v[58:59], v[58:59], v[122:123]
    v_pk_fma_f32 v[116:117], v[60:61], v[60:61], v[116:117]
    v_pk_fma_f32 v[118:119], v[62:63], v[62:63], v[118:119]
    v_pk_fma_f32 v[120:121], v[64:65], v[64:65], v[120:121]
    v_pk_fma_f32 v[122:123], v[66:67], v[66:67], v[122:123]
    v_pk_fma_f32 v[116:117], v[68:69], v[68:69], v[116:117]
    v_pk_fma_f32 v[118:119], v[70:71], v[70:71], v[118:119]
    v_pk_fma_f32 v[120:121], v[72:73], v[72:73], v[120:121]
    v_pk_fma_f32 v[122:123], v[74:75], v[74:75], v[122:123]
    v_pk_fma_f32 v[116:117], v[76:77], v[76:77], v[116:117]
    v_pk_fma_f32 v[118:119], v[78:79], v[78:79], v[118:119]
    v_pk_fma_f32 v[120:121], v[80:81], v[80:81], v[120:121]
    v_pk_fma_f32 v[122:123], v[82:83], v[82:83], v[122:123]
    v_pk_fma_f32 v[116:117], v[84:85], v[84:85], v[116:117]
    v_pk_fma_f32 v[118:119], v[86:87], v[86:87], v[118:119]
    v_pk_fma_f32 v[120:121], v[88:89], v[88:89], v[120:121]
    v_pk_fma_f32 v[122:123], v[90:91], v[90:91], v[122:123]
    v_pk_fma_f32 v[116:117], v[92:93], v[92:93], v[116:117]
    v_pk_fma_f32 v[118:119], v[94:95], v[94:95], v[118:119]
    v_pk_fma_f32 v[120:121], v[96:97], v[96:97], v[120:121]
    v_pk_fma_f32 v[122:123], v[98:99], v[98:99], v[122:123]
    v_pk_fma_f32 v[116:117], v[100:101], v[100:101], v[116:117]
    v_pk_fma_f32 v[118:119], v[102:103], v[102:103], v[118:119]
    v_pk_fma_f32 v[120:121], v[104:105], v[104:105], v[120:121]
    v_pk_fma_f32 v[122:123], v[106:107], v[106:107], v[122:123]
    v_pk_fma_f32 v[116:117], v[108:109], v[108:109], v[116:117]
    v_pk_fma_f32 v[118:119], v[110:111], v[110:111], v[118:119]
    v_pk_fma_f32 v[120:121], v[112:113], v[112:113], v[120:121]
    v_pk_fma_f32 v[122:123], v[114:115], v[114:115], v[122:123]
    v_pk_add_f32 v[116:117], v[116:117], v[118:119]
    v_pk_add_f32 v[120:121], v[120:121], v[122:123]
    v_pk_add_f32 v[116:117], v[116:117], v[120:121]
    v_add_f32 v116, v116, v117
    s_nop 1
    v_add_f32_dpp v116, v116, v116 quad_perm:[1,0,3,2] row_mask:0xf bank_mask:0xf
    s_nop 1
    v_add_f32_dpp v116, v116, v116 quad_perm:[2,3,0,1] row_mask:0xf bank_mask:0xf
    s_nop 1
    v_add_f32_dpp v116, v116, v116 row_half_mirror row_mask:0xf bank_mask:0xf
    v_mul_f32 v116, 0x3ae38e39, v116
    v_fma_f32 v116, -v126, v126, v116
    v_max_f32 v116, 0, v116
    v_cvt_pk_bf16_f32 v116, v116, v116
    v_lshlrev_b32 v116, 16, v116
    v_add_f32 v116, 0x3727c5ac, v116
    v_cvt_pk_bf16_f32 v116, v116, v116
    v_lshlrev_b32 v116, 16, v116
    v_sqrt_f32 v116, v116
    s_nop 0
    v_cvt_pk_bf16_f32 v116, v116, v116
    v_lshlrev_b32 v116, 16, v116
    v_rcp_f32 v124, v116
    s_lshl_b32 s42, s30, 31
    s_nop 0
    v_xor_b32 v124, s42, v124
    v_mov_b32 v125, v124
    s_and_b32 s43, s28, 1
    s_lshl_b32 s43, s43, 2
    v_and_b32 v5, 3, v3
    v_or_b32 v5, s43, v5
    v_xor_b32 v5, v5, v4
    v_lshlrev_b32 v5, 4, v5
    v_lshl_add_u32 v5, v3, 7, v5
    s_lshl_b32 s43, s28, 10
    v_add_u32 v5, s43, v5
    v_add_u32 v6, 0x10000, v5
    v_cvt_pk_bf16_f32 v8, v44, v45
    v_cvt_pk_bf16_f32 v9, v46, v47
    v_cvt_pk_bf16_f32 v10, v48, v49
    v_cvt_pk_bf16_f32 v11, v50, v51
    v_lshlrev_b32 v44, 16, v8
    v_and_b32 v45, 0xffff0000, v8
    v_lshlrev_b32 v46, 16, v9
    v_and_b32 v47, 0xffff0000, v9
    v_lshlrev_b32 v48, 16, v10
    v_and_b32 v49, 0xffff0000, v10
    v_lshlrev_b32 v50, 16, v11
    v_and_b32 v51, 0xffff0000, v11
    v_pk_mul_f32 v[44:45], v[44:45], v[124:125]
    v_pk_mul_f32 v[46:47], v[46:47], v[124:125]
    v_pk_mul_f32 v[48:49], v[48:49], v[124:125]
    v_pk_mul_f32 v[50:51], v[50:51], v[124:125]
    v_cvt_pk_bf16_f32 v8, v44, v45
    v_cvt_pk_bf16_f32 v9, v46, v47
    v_cvt_pk_bf16_f32 v10, v48, v49
    v_cvt_pk_bf16_f32 v11, v50, v51
    ds_write_b128 v5, v[8:11] offset:0
    v_cvt_pk_bf16_f32 v12, v52, v53
    v_cvt_pk_bf16_f32 v13, v54, v55
    v_cvt_pk_bf16_f32 v14, v56, v57
    v_cvt_pk_bf16_f32 v15, v58, v59
    v_lshlrev_b32 v52, 16, v12
    v_and_b32 v53, 0xffff0000, v12
    v_lshlrev_b32 v54, 16, v13
    v_and_b32 v55, 0xffff0000, v13
    v_lshlrev_b32 v56, 16, v14
    v_and_b32 v57, 0xffff0000, v14
    v_lshlrev_b32 v58, 16, v15
    v_and_b32 v59, 0xffff0000, v15
    v_pk_mul_f32 v[52:53], v[52:53], v[124:125]
    v_pk_mul_f32 v[54:55], v[54:55], v[124:125]
    v_pk_mul_f32 v[56:57], v[56:57], v[124:125]
    v_pk_mul_f32 v[58:59], v[58:59], v[124:125]
    v_cvt_pk_bf16_f32 v12, v52, v53
    v_cvt_pk_bf16_f32 v13, v54, v55
    v_cvt_pk_bf16_f32 v14, v56, v57
    v_cvt_pk_bf16_f32 v15, v58, v59
    ds_write_b128 v5, v[12:15] offset:8192
    v_cvt_pk_bf16_f32 v16, v60, v61
    v_cvt_pk_bf16_f32 v17, v62, v63
    v_cvt_pk_bf16_f32 v18, v64, v65
    v_cvt_pk_bf16_f32 v19, v66, v67
    v_lshlrev_b32 v60, 16, v16
    v_and_b32 v61, 0xffff0000, v16
    v_lshlrev_b32 v62, 16, v17
    v_and_b32 v63, 0xffff0000, v17
    v_lshlrev_b32 v64, 16, v18
    v_and_b32 v65, 0xffff0000, v18
    v_lshlrev_b32 v66, 16, v19
    v_and_b32 v67, 0xffff0000, v19
    v_pk_mul_f32 v[60:61], v[60:61], v[124:125]
    v_pk_mul_f32 v[62:63], v[62:63], v[124:125]
    v_pk_mul_f32 v[64:65], v[64:65], v[124:125]
    v_pk_mul_f32 v[66:67], v[66:67], v[124:125]
    v_cvt_pk_bf16_f32 v16, v60, v61
    v_cvt_pk_bf16_f32 v17, v62, v63
    v_cvt_pk_bf16_f32 v18, v64, v65
    v_cvt_pk_bf16_f32 v19, v66, v67
    ds_write_b128 v5, v[16:19] offset:16384
    v_cvt_pk_bf16_f32 v20, v68, v69
    v_cvt_pk_bf16_f32 v21, v70, v71
    v_cvt_pk_bf16_f32 v22, v72, v73
    v_cvt_pk_bf16_f32 v23, v74, v75
    v_lshlrev_b32 v68, 16, v20
    v_and_b32 v69, 0xffff0000, v20
    v_lshlrev_b32 v70, 16, v21
    v_and_b32 v71, 0xffff0000, v21
    v_lshlrev_b32 v72, 16, v22
    v_and_b32 v73, 0xffff0000, v22
    v_lshlrev_b32 v74, 16, v23
    v_and_b32 v75, 0xffff0000, v23
    v_pk_mul_f32 v[68:69], v[68:69], v[124:125]
    v_pk_mul_f32 v[70:71], v[70:71], v[124:125]
    v_pk_mul_f32 v[72:73], v[72:73], v[124:125]
    v_pk_mul_f32 v[74:75], v[74:75], v[124:125]
    v_cvt_pk_bf16_f32 v20, v68, v69
    v_cvt_pk_bf16_f32 v21, v70, v71
    v_cvt_pk_bf16_f32 v22, v72, v73
    v_cvt_pk_bf16_f32 v23, v74, v75
    ds_write_b128 v5, v[20:23] offset:24576
    v_cvt_pk_bf16_f32 v24, v76, v77
    v_cvt_pk_bf16_f32 v25, v78, v79
    v_cvt_pk_bf16_f32 v26, v80, v81
    v_cvt_pk_bf16_f32 v27, v82, v83
    v_lshlrev_b32 v76, 16, v24
    v_and_b32 v77, 0xffff0000, v24
    v_lshlrev_b32 v78, 16, v25
    v_and_b32 v79, 0xffff0000, v25
    v_lshlrev_b32 v80, 16, v26
    v_and_b32 v81, 0xffff0000, v26
    v_lshlrev_b32 v82, 16, v27
    v_and_b32 v83, 0xffff0000, v27
    v_pk_mul_f32 v[76:77], v[76:77], v[124:125]
    v_pk_mul_f32 v[78:79], v[78:79], v[124:125]
    v_pk_mul_f32 v[80:81], v[80:81], v[124:125]
    v_pk_mul_f32 v[82:83], v[82:83], v[124:125]
    v_cvt_pk_bf16_f32 v24, v76, v77
    v_cvt_pk_bf16_f32 v25, v78, v79
    v_cvt_pk_bf16_f32 v26, v80, v81
    v_cvt_pk_bf16_f32 v27, v82, v83
    ds_write_b128 v5, v[24:27] offset:32768
    v_cvt_pk_bf16_f32 v28, v84, v85
    v_cvt_pk_bf16_f32 v29, v86, v87
    v_cvt_pk_bf16_f32 v30, v88, v89
    v_cvt_pk_bf16_f32 v31, v90, v91
    v_lshlrev_b32 v84, 16, v28
    v_and_b32 v85, 0xffff0000, v28
    v_lshlrev_b32 v86, 16, v29
    v_and_b32 v87, 0xffff0000, v29
    v_lshlrev_b32 v88, 16, v30
    v_and_b32 v89, 0xffff0000, v30
    v_lshlrev_b32 v90, 16, v31
    v_and_b32 v91, 0xffff0000, v31
    v_pk_mul_f32 v[84:85], v[84:85], v[124:125]
    v_pk_mul_f32 v[86:87], v[86:87], v[124:125]
    v_pk_mul_f32 v[88:89], v[88:89], v[124:125]
    v_pk_mul_f32 v[90:91], v[90:91], v[124:125]
    v_cvt_pk_bf16_f32 v28, v84, v85
    v_cvt_pk_bf16_f32 v29, v86, v87
    v_cvt_pk_bf16_f32 v30, v88, v89
    v_cvt_pk_bf16_f32 v31, v90, v91
    ds_write_b128 v5, v[28:31] offset:40960
    v_cvt_pk_bf16_f32 v32, v92, v93
    v_cvt_pk_bf16_f32 v33, v94, v95
    v_cvt_pk_bf16_f32 v34, v96, v97
    v_cvt_pk_bf16_f32 v35, v98, v99
    v_lshlrev_b32 v92, 16, v32
    v_and_b32 v93, 0xffff0000, v32
    v_lshlrev_b32 v94, 16, v33
    v_and_b32 v95, 0xffff0000, v33
    v_lshlrev_b32 v96, 16, v34
    v_and_b32 v97, 0xffff0000, v34
    v_lshlrev_b32 v98, 16, v35
    v_and_b32 v99, 0xffff0000, v35
    v_pk_mul_f32 v[92:93], v[92:93], v[124:125]
    v_pk_mul_f32 v[94:95], v[94:95], v[124:125]
    v_pk_mul_f32 v[96:97], v[96:97], v[124:125]
    v_pk_mul_f32 v[98:99], v[98:99], v[124:125]
    v_cvt_pk_bf16_f32 v32, v92, v93
    v_cvt_pk_bf16_f32 v33, v94, v95
    v_cvt_pk_bf16_f32 v34, v96, v97
    v_cvt_pk_bf16_f32 v35, v98, v99
    ds_write_b128 v5, v[32:35] offset:49152
    v_cvt_pk_bf16_f32 v36, v100, v101
    v_cvt_pk_bf16_f32 v37, v102, v103
    v_cvt_pk_bf16_f32 v38, v104, v105
    v_cvt_pk_bf16_f32 v39, v106, v107
    v_lshlrev_b32 v100, 16, v36
    v_and_b32 v101, 0xffff0000, v36
    v_lshlrev_b32 v102, 16, v37
    v_and_b32 v103, 0xffff0000, v37
    v_lshlrev_b32 v104, 16, v38
    v_and_b32 v105, 0xffff0000, v38
    v_lshlrev_b32 v106, 16, v39
    v_and_b32 v107, 0xffff0000, v39
    v_pk_mul_f32 v[100:101], v[100:101], v[124:125]
    v_pk_mul_f32 v[102:103], v[102:103], v[124:125]
    v_pk_mul_f32 v[104:105], v[104:105], v[124:125]
    v_pk_mul_f32 v[106:107], v[106:107], v[124:125]
    v_cvt_pk_bf16_f32 v36, v100, v101
    v_cvt_pk_bf16_f32 v37, v102, v103
    v_cvt_pk_bf16_f32 v38, v104, v105
    v_cvt_pk_bf16_f32 v39, v106, v107
    ds_write_b128 v5, v[36:39] offset:57344
    v_cvt_pk_bf16_f32 v40, v108, v109
    v_cvt_pk_bf16_f32 v41, v110, v111
    v_cvt_pk_bf16_f32 v42, v112, v113
    v_cvt_pk_bf16_f32 v43, v114, v115
    v_lshlrev_b32 v108, 16, v40
    v_and_b32 v109, 0xffff0000, v40
    v_lshlrev_b32 v110, 16, v41
    v_and_b32 v111, 0xffff0000, v41
    v_lshlrev_b32 v112, 16, v42
    v_and_b32 v113, 0xffff0000, v42
    v_lshlrev_b32 v114, 16, v43
    v_and_b32 v115, 0xffff0000, v43
    v_pk_mul_f32 v[108:109], v[108:109], v[124:125]
    v_pk_mul_f32 v[110:111], v[110:111], v[124:125]
    v_pk_mul_f32 v[112:113], v[112:113], v[124:125]
    v_pk_mul_f32 v[114:115], v[114:115], v[124:125]
    v_cvt_pk_bf16_f32 v40, v108, v109
    v_cvt_pk_bf16_f32 v41, v110, v111
    v_cvt_pk_bf16_f32 v42, v112, v113
    v_cvt_pk_bf16_f32 v43, v114, v115
    ds_write_b128 v6, v[40:43]
    s_cmp_ge_u32 s28, 4
    s_cbranch_scc1 L_k1_loader
    s_mov_b32 s48, s35
    s_mov_b32 s49, 0
    s_mov_b32 s52, 0
    s_mov_b32 s54, 0xffff0000
    s_mov_b32 s55, 8192
    s_mov_b32 s56, 24576
    s_mov_b32 s57, 0xffff4000
    s_waitcnt vmcnt(6) lgkmcnt(0)
    s_barrier
    ds_read_b128 v[0:3], v176
    ds_read_b128 v[8:11], v178
    ds_read_b128 v[4:7], v176 offset:512
    ds_read_b128 v[12:15], v178 offset:2048
    ds_read_b128 v[16:19], v178 offset:4096
    ds_read_b128 v[20:23], v178 offset:6144
    ds_read_b128 v[24:27], v178 offset:8192
    ds_read_b128 v[28:31], v178 offset:10240
    ds_read_b128 v[32:35], v177
    ds_read_b128 v[40:43], v179
    ds_read_b128 v[36:39], v177 offset:512
    ds_read_b128 v[44:47], v179 offset:2048
    ds_read_b128 v[48:51], v179 offset:4096
    ds_read_b128 v[52:55], v179 offset:6144
    ds_read_b128 v[56:59], v179 offset:8192
    ds_read_b128 v[60:63], v179 offset:10240
    s_add_u32 s48, s48, 1
    s_cmp_eq_u32 s48, 9
    s_cselect_b32 s48, 0, s48
    s_cselect_b32 s50, s54, s55
    s_add_u32 s49, s49, 1
    s_cmp_eq_u32 s49, 3
    s_cselect_b32 s49, 0, s49
    s_cselect_b32 s51, s57, s56
    v_add_u32 v176, s50, v176
    v_add_u32 v177, s50, v177
    v_add_u32 v178, s51, v178
    v_add_u32 v179, s51, v179
L_k1_loop:
    s_waitcnt vmcnt(3) lgkmcnt(0)
    s_barrier
    v_mfma_f32_16x16x32_bf16 v[128:131], v[0:3], v[8:11], v[128:131]
    ds_read_b128 v[64:67], v176
    v_mfma_f32_16x16x32_bf16 v[132:135], v[4:7], v[8:11], v[132:135]
    ds_read_b128 v[72:75], v178
    v_mfma_f32_16x16x32_bf16 v[136:139], v[0:3], v[12:15], v[136:139]
    ds_read_b128 v[68:71], v176 offset:512
    v_mfma_f32_16x16x32_bf16 v[140:143], v[4:7], v[12:15], v[140:143]
    ds_read_b128 v[76:79], v178 offset:2048
    v_mfma_f32_16x16x32_bf16 v[144:147], v[0:3], v[16:19], v[144:147]
    ds_read_b128 v[80:83], v178 offset:4096
    v_mfma_f32_16x16x32_bf16 v[148:151], v[4:7], v[16:19], v[148:151]
    ds_read_b128 v[84:87], v178 offset:6144
    v_mfma_f32_16x16x32_bf16 v[152:155], v[0:3], v[20:23], v[152:155]
    ds_read_b128 v[88:91], v178 offset:8192
    v_mfma_f32_16x16x32_bf16 v[156:159], v[4:7], v[20:23], v[156:159]
    ds_read_b128 v[92:95], v178 offset:10240
    v_mfma_f32_16x16x32_bf16 v[160:163], v[0:3], v[24:27], v[160:163]
    ds_read_b128 v[96:99], v177
    v_mfma_f32_16x16x32_bf16 v[164:167], v[4:7], v[24:27], v[164:167]
    ds_read_b128 v[104:107], v179
    v_mfma_f32_16x16x32_bf16 v[168:171], v[0:3], v[28:31], v[168:171]
    ds_read_b128 v[100:103], v177 offset:512
    v_mfma_f32_16x16x32_bf16 v[172:175], v[4:7], v[28:31], v[172:175]
    ds_read_b128 v[108:111], v179 offset:2048
    v_mfma_f32_16x16x32_bf16 v[128:131], v[32:35], v[40:43], v[128:131]
    ds_read_b128 v[112:115], v179 offset:4096
    v_mfma_f32_16x16x32_bf16 v[132:135], v[36:39], v[40:43], v[132:135]
    ds_read_b128 v[116:119], v179 offset:6144
    v_mfma_f32_16x16x32_bf16 v[136:139], v[32:35], v[44:47], v[136:139]
    ds_read_b128 v[120:123], v179 offset:8192
    v_mfma_f32_16x16x32_bf16 v[140:143], v[36:39], v[44:47], v[140:143]
    ds_read_b128 v[124:127], v179 offset:10240
    v_mfma_f32_16x16x32_bf16 v[144:147], v[32:35], v[48:51], v[144:147]
    s_add_u32 s48, s48, 1
    s_cmp_eq_u32 s48, 9
    v_mfma_f32_16x16x32_bf16 v[148:151], v[36:39], v[48:51], v[148:151]
    s_cselect_b32 s48, 0, s48
    s_cselect_b32 s50, s54, s55
    v_mfma_f32_16x16x32_bf16 v[152:155], v[32:35], v[52:55], v[152:155]
    s_add_u32 s49, s49, 1
    s_cmp_eq_u32 s49, 3
    v_mfma_f32_16x16x32_bf16 v[156:159], v[36:39], v[52:55], v[156:159]
    s_cselect_b32 s49, 0, s49
    s_cselect_b32 s51, s57, s56
    v_mfma_f32_16x16x32_bf16 v[160:163], v[32:35], v[56:59], v[160:163]
    v_add_u32 v176, s50, v176
    v_add_u32 v177, s50, v177
    v_mfma_f32_16x16x32_bf16 v[164:167], v[36:39], v[56:59], v[164:167]
    v_add_u32 v178, s51, v178
    v_add_u32 v179, s51, v179
    v_mfma_f32_16x16x32_bf16 v[168:171], v[32:35], v[60:63], v[168:171]
    v_mfma_f32_16x16x32_bf16 v[172:175], v[36:39], v[60:63], v[172:175]
    s_cmp_eq_u32 s52, 4
    s_cbranch_scc1 L_k1_epi
    s_waitcnt vmcnt(0) lgkmcnt(0)
    s_barrier
    v_mfma_f32_16x16x32_bf16 v[128:131], v[64:67], v[72:75], v[128:131]
    ds_read_b128 v[0:3], v176
    v_mfma_f32_16x16x32_bf16 v[132:135], v[68:71], v[72:75], v[132:135]
    ds_read_b128 v[8:11], v178
    v_mfma_f32_16x16x32_bf16 v[136:139], v[64:67], v[76:79], v[136:139]
    ds_read_b128 v[4:7], v176 offset:512
    v_mfma_f32_16x16x32_bf16 v[140:143], v[68:71], v[76:79], v[140:143]
    ds_read_b128 v[12:15], v178 offset:2048
    v_mfma_f32_16x16x32_bf16 v[144:147], v[64:67], v[80:83], v[144:147]
    ds_read_b128 v[16:19], v178 offset:4096
    v_mfma_f32_16x16x32_bf16 v[148:151], v[68:71], v[80:83], v[148:151]
    ds_read_b128 v[20:23], v178 offset:6144
    v_mfma_f32_16x16x32_bf16 v[152:155], v[64:67], v[84:87], v[152:155]
    ds_read_b128 v[24:27], v178 offset:8192
    v_mfma_f32_16x16x32_bf16 v[156:159], v[68:71], v[84:87], v[156:159]
    ds_read_b128 v[28:31], v178 offset:10240
    v_mfma_f32_16x16x32_bf16 v[160:163], v[64:67], v[88:91], v[160:163]
    ds_read_b128 v[32:35], v177
    v_mfma_f32_16x16x32_bf16 v[164:167], v[68:71], v[88:91], v[164:167]
    ds_read_b128 v[40:43], v179
    v_mfma_f32_16x16x32_bf16 v[168:171], v[64:67], v[92:95], v[168:171]
    ds_read_b128 v[36:39], v177 offset:512
    v_mfma_f32_16x16x32_bf16 v[172:175], v[68:71], v[92:95], v[172:175]
    ds_read_b128 v[44:47], v179 offset:2048
    v_mfma_f32_16x16x32_bf16 v[128:131], v[96:99], v[104:107], v[128:131]
    ds_read_b128 v[48:51], v179 offset:4096
    v_mfma_f32_16x16x32_bf16 v[132:135], v[100:103], v[104:107], v[132:135]
    ds_read_b128 v[52:55], v179 offset:6144
    v_mfma_f32_16x16x32_bf16 v[136:139], v[96:99], v[108:111], v[136:139]
    ds_read_b128 v[56:59], v179 offset:8192
    v_mfma_f32_16x16x32_bf16 v[140:143], v[100:103], v[108:111], v[140:143]
    ds_read_b128 v[60:63], v179 offset:10240
    v_mfma_f32_16x16x32_bf16 v[144:147], v[96:99], v[112:115], v[144:147]
    s_add_u32 s48, s48, 1
    s_cmp_eq_u32 s48, 9
    v_mfma_f32_16x16x32_bf16 v[148:151], v[100:103], v[112:115], v[148:151]
    s_cselect_b32 s48, 0, s48
    s_cselect_b32 s50, s54, s55
    v_mfma_f32_16x16x32_bf16 v[152:155], v[96:99], v[116:119], v[152:155]
    s_add_u32 s49, s49, 1
    s_cmp_eq_u32 s49, 3
    v_mfma_f32_16x16x32_bf16 v[156:159], v[100:103], v[116:119], v[156:159]
    s_cselect_b32 s49, 0, s49
    s_cselect_b32 s51, s57, s56
    v_mfma_f32_16x16x32_bf16 v[160:163], v[96:99], v[120:123], v[160:163]
    v_add_u32 v176, s50, v176
    v_add_u32 v177, s50, v177
    v_mfma_f32_16x16x32_bf16 v[164:167], v[100:103], v[120:123], v[164:167]
    v_add_u32 v178, s51, v178
    v_add_u32 v179, s51, v179
    v_mfma_f32_16x16x32_bf16 v[168:171], v[96:99], v[124:127], v[168:171]
    v_mfma_f32_16x16x32_bf16 v[172:175], v[100:103], v[124:127], v[172:175]
    s_add_u32 s52, s52, 1
    s_branch L_k1_loop
L_k1_epi:
    s_nop 7
    v_cvt_pk_bf16_f32 v0, v128, v129
    v_cvt_pk_bf16_f32 v1, v130, v131
    v_cvt_pk_bf16_f32 v2, v132, v133
    v_cvt_pk_bf16_f32 v3, v134, v135
    buffer_store_dwordx4 v[0:3], v180, s[24:27], s80 offen sc1
    v_cvt_pk_bf16_f32 v4, v136, v137
    v_cvt_pk_bf16_f32 v5, v138, v139
    v_cvt_pk_bf16_f32 v6, v140, v141
    v_cvt_pk_bf16_f32 v7, v142, v143
    buffer_store_dwordx4 v[4:7], v180, s[24:27], s81 offen sc1
    v_cvt_pk_bf16_f32 v8, v144, v145
    v_cvt_pk_bf16_f32 v9, v146, v147
    v_cvt_pk_bf16_f32 v10, v148, v149
    v_cvt_pk_bf16_f32 v11, v150, v151
    buffer_store_dwordx4 v[8:11], v180, s[24:27], s82 offen sc1
    v_cvt_pk_bf16_f32 v12, v152, v153
    v_cvt_pk_bf16_f32 v13, v154, v155
    v_cvt_pk_bf16_f32 v14, v156, v157
    v_cvt_pk_bf16_f32 v15, v158, v159
    buffer_store_dwordx4 v[12:15], v180, s[24:27], s83 offen sc1
    v_cvt_pk_bf16_f32 v16, v160, v161
    v_cvt_pk_bf16_f32 v17, v162, v163
    v_cvt_pk_bf16_f32 v18, v164, v165
    v_cvt_pk_bf16_f32 v19, v166, v167
    buffer_store_dwordx4 v[16:19], v180, s[24:27], s84 offen sc1
    v_cvt_pk_bf16_f32 v20, v168, v169
    v_cvt_pk_bf16_f32 v21, v170, v171
    v_cvt_pk_bf16_f32 v22, v172, v173
    v_cvt_pk_bf16_f32 v23, v174, v175
    buffer_store_dwordx4 v[20:23], v180, s[24:27], s85 offen sc1
    s_waitcnt vmcnt(0)
    s_barrier
    s_branch L_k2_entry
L_k1_loader:
    s_sub_u32 s44, s28, 4
    s_mul_i32 s46, s44, 55296
    s_add_u32 s46, s46, s39
    s_mul_i32 s45, s44, 6144
    s_add_u32 s45, s45, 73728
    s_waitcnt vmcnt(6) lgkmcnt(0)
    s_barrier
    s_waitcnt vmcnt(3)
    s_barrier
    s_lshl_b32 s47, s48, 7
    s_add_u32 s47, s47, s46
    s_add_u32 m0, s45, 0
    s_add_u32 s41, s47, 0
    buffer_load_dwordx4 v7, s[20:23], s41 offen lds
    s_add_u32 m0, s45, 1024
    s_add_u32 s41, s47, 9216
    buffer_load_dwordx4 v7, s[20:23], s41 offen lds
    s_add_u32 m0, s45, 2048
    s_add_u32 s41, s47, 18432
    buffer_load_dwordx4 v7, s[20:23], s41 offen lds
    s_add_u32 m0, s45, 3072
    s_add_u32 s41, s47, 27648
    buffer_load_dwordx4 v7, s[20:23], s41 offen lds
    s_add_u32 m0, s45, 4096
    s_add_u32 s41, s47, 36864
    buffer_load_dwordx4 v7, s[20:23], s41 offen lds
    s_add_u32 m0, s45, 5120
    s_add_u32 s41, s47, 46080
    buffer_load_dwordx4 v7, s[20:23], s41 offen lds
    s_add_u32 s48, s48, 1
    s_cmp_eq_u32 s48, 9
    s_cselect_b32 s48, 0, s48
    s_waitcnt vmcnt(6)
    s_barrier
    s_lshl_b32 s47, s48, 7
    s_add_u32 s47, s47, s46
    s_add_u32 m0, s45, 24576
    s_add_u32 s41, s47, 0
    buffer_load_dwordx4 v7, s[20:23], s41 offen lds
    s_add_u32 m0, s45, 25600
    s_add_u32 s41, s47, 9216
    buffer_load_dwordx4 v7, s[20:23], s41 offen lds
    s_add_u32 m0, s45, 26624
    s_add_u32 s41, s47, 18432
    buffer_load_dwordx4 v7, s[20:23], s41 offen lds
    s_add_u32 m0, s45, 27648
    s_add_u32 s41, s47, 27648
    buffer_load_dwordx4 v7, s[20:23], s41 offen lds
    s_add_u32 m0, s45, 28672
    s_add_u32 s41, s47, 36864
    buffer_load_dwordx4 v7, s[20:23], s41 offen lds
    s_add_u32 m0, s45, 29696
    s_add_u32 s41, s47, 46080
    buffer_load_dwordx4 v7, s[20:23], s41 offen lds
    s_add_u32 s48, s48, 1
    s_cmp_eq_u32 s48, 9
    s_cselect_b32 s48, 0, s48
    s_waitcnt vmcnt(6)
    s_barrier
    s_lshl_b32 s47, s48, 7
    s_add_u32 s47, s47, s46
    s_add_u32 m0, s45, 49152
    s_add_u32 s41, s47, 0
    buffer_load_dwordx4 v7, s[20:23], s41 offen lds
    s_add_u32 m0, s45, 50176
    s_add_u32 s41, s47, 9216
    buffer_load_dwordx4 v7, s[20:23], s41 offen lds
    s_add_u32 m0, s45, 51200
    s_add_u32 s41, s47, 18432
    buffer_load_dwordx4 v7, s[20:23], s41 offen lds
    s_add_u32 m0, s45, 52224
    s_add_u32 s41, s47, 27648
    buffer_load_dwordx4 v7, s[20:23], s41 offen lds
    s_add_u32 m0, s45, 53248
    s_add_u32 s41, s47, 36864
    buffer_load_dwordx4 v7, s[20:23], s41 offen lds
    s_add_u32 m0, s45, 54272
    s_add_u32 s41, s47, 46080
    buffer_load_dwordx4 v7, s[20:23], s41 offen lds
    s_add_u32 s48, s48, 1
    s_cmp_eq_u32 s48, 9
    s_cselect_b32 s48, 0, s48
    s_waitcnt vmcnt(6)
    s_barrier
    s_lshl_b32 s47, s48, 7
    s_add_u32 s47, s47, s46
    s_add_u32 m0, s45, 0
    s_add_u32 s41, s47, 0
    buffer_load_dwordx4 v7, s[20:23], s41 offen lds
    s_add_u32 m0, s45, 1024
    s_add_u32 s41, s47, 9216
    buffer_load_dwordx4 v7, s[20:23], s41 offen lds
    s_add_u32 m0, s45, 2048
    s_add_u32 s41, s47, 18432
    buffer_load_dwordx4 v7, s[20:23], s41 offen lds
    s_add_u32 m0, s45, 3072
    s_add_u32 s41, s47, 27648
    buffer_load_dwordx4 v7, s[20:23], s41 offen lds
    s_add_u32 m0, s45, 4096
    s_add_u32 s41, s47, 36864
    buffer_load_dwordx4 v7, s[20:23], s41 offen lds
    s_add_u32 m0, s45, 5120
    s_add_u32 s41, s47, 46080
    buffer_load_dwordx4 v7, s[20:23], s41 offen lds
    s_add_u32 s48, s48, 1
    s_cmp_eq_u32 s48, 9
    s_cselect_b32 s48, 0, s48
    s_waitcnt vmcnt(6)
    s_barrier
    s_lshl_b32 s47, s48, 7
    s_add_u32 s47, s47, s46
    s_add_u32 m0, s45, 24576
    s_add_u32 s41, s47, 0
    buffer_load_dwordx4 v7, s[20:23], s41 offen lds
    s_add_u32 m0, s45, 25600
    s_add_u32 s41, s47, 9216
    buffer_load_dwordx4 v7, s[20:23], s41 offen lds
    s_add_u32 m0, s45, 26624
    s_add_u32 s41, s47, 18432
    buffer_load_dwordx4 v7, s[20:23], s41 offen lds
    s_add_u32 m0, s45, 27648
    s_add_u32 s41, s47, 27648
    buffer_load_dwordx4 v7, s[20:23], s41 offen lds
    s_add_u32 m0, s45, 28672
    s_add_u32 s41, s47, 36864
    buffer_load_dwordx4 v7, s[20:23], s41 offen lds
    s_add_u32 m0, s45, 29696
    s_add_u32 s41, s47, 46080
    buffer_load_dwordx4 v7, s[20:23], s41 offen lds
    s_add_u32 s48, s48, 1
    s_cmp_eq_u32 s48, 9
    s_cselect_b32 s48, 0, s48
    s_waitcnt vmcnt(6)
    s_barrier
    s_lshl_b32 s47, s48, 7
    s_add_u32 s47, s47, s46
    s_add_u32 m0, s45, 49152
    s_add_u32 s41, s47, 0
    buffer_load_dwordx4 v7, s[20:23], s41 offen lds
    s_add_u32 m0, s45, 50176
    s_add_u32 s41, s47, 9216
    buffer_load_dwordx4 v7, s[20:23], s41 offen lds
    s_add_u32 m0, s45, 51200
    s_add_u32 s41, s47, 18432
    buffer_load_dwordx4 v7, s[20:23], s41 offen lds
    s_add_u32 m0, s45, 52224
    s_add_u32 s41, s47, 27648
    buffer_load_dwordx4 v7, s[20:23], s41 offen lds
    s_add_u32 m0, s45, 53248
    s_add_u32 s41, s47, 36864
    buffer_load_dwordx4 v7, s[20:23], s41 offen lds
    s_add_u32 m0, s45, 54272
    s_add_u32 s41, s47, 46080
    buffer_load_dwordx4 v7, s[20:23], s41 offen lds
    s_add_u32 s48, s48, 1
    s_cmp_eq_u32 s48, 9
    s_cselect_b32 s48, 0, s48
    s_waitcnt vmcnt(6)
    s_barrier
    s_waitcnt vmcnt(0)
    s_barrier
    s_lshl_b32 s97, s30, 1
    s_lshr_b32 s47, s29, 4
    s_add_u32 s97, s97, s47
    s_mul_i32 s97, s97, 48
    s_and_b32 s47, s29, 15
    s_mul_i32 s47, s47, 3
    s_add_u32 s97, s97, s47
    s_add_u32 s97, s97, s31
    s_lshl_b32 s97, s97, 7
    s_cmp_lg_u32 s28, 4
    s_cbranch_scc1 L_k1_non
    s_mov_b32 s76, s88
    s_mov_b32 s77, s89
    s_mov_b32 s78, 0x100
    s_mov_b32 s79, 0x20000
    s_mov_b64 exec, 1
    s_mov_b32 s55, 0x20000
L_sequential_preLN__spectral_fnet__glu_gated_glu__prompt_pagain_3:
    buffer_load_dword v60, off, s[76:79], 0 sc1
    s_waitcnt vmcnt(0)
    v_cmp_eq_u32 vcc, 0, v60
    s_nop 4
    s_cbranch_vccz L_sequential_preLN__spectral_fnet__glu_gated_glu__prompt_pw_4
    s_sleep 4
    s_sub_u32 s55, s55, 1
    s_cbranch_scc0 L_sequential_preLN__spectral_fnet__glu_gated_glu__prompt_pagain_3
L_sequential_preLN__spectral_fnet__glu_gated_glu__prompt_pw_4:
L_sequential_preLN__spectral_fnet__glu_gated_glu__prompt_pok_2:
    v_readfirstlane_b32 s96, v60
    s_mov_b64 exec, -1
L_k1_non:
    s_barrier
    s_branch L_k2_entry
L_k1_pf:
    s_sub_u32 s33, s33, 24
    s_lshl_b32 s33, s33, 3
    s_add_u32 s33, s33, s28
    v_lshlrev_b32 v3, 7, v2
    s_cmp_ge_u32 s33, 2
    s_cbranch_scc1 L_k1_noct
    s_getpc_b64 s[98:99]
L_sequential_preLN__spectral_fnet__glu_gated_glu__prompt_pc_5:
    s_add_u32 s98, s98, sequential_preLN__spectral_fnet__glu_gated_glu__prompt_kernel-L_sequential_preLN__spectral_fnet__glu_gated_glu__prompt_pc_5
    s_addc_u32 s99, s99, -1
    global_load_dword v20, v3, s[98:99]
    s_add_u32 s98, s98, 8192
    s_addc_u32 s99, s99, 0
    global_load_dword v20, v3, s[98:99]
    s_add_u32 s98, s98, 8192
    s_addc_u32 s99, s99, 0
    global_load_dword v20, v3, s[98:99]
    s_add_u32 s98, s98, 8192
    s_addc_u32 s99, s99, 0
    global_load_dword v20, v3, s[98:99]
    s_add_u32 s98, s98, 8192
    s_addc_u32 s99, s99, 0
    global_load_dword v20, v3, s[98:99]
L_k1_noct:
    s_waitcnt lgkmcnt(0)
    s_cmp_eq_u32 s30, 0
    s_cselect_b32 s20, s12, s14
    s_cselect_b32 s21, s13, s15
    s_mov_b32 s22, 663552
    s_mov_b32 s23, 0x20000
    s_cselect_b32 s16, s60, s62
    s_cselect_b32 s17, s61, s63
    s_mov_b32 s18, 8388608
    s_mov_b32 s19, 0x20000
    s_mov_b32 s76, s88
    s_mov_b32 s77, s89
    s_mov_b32 s78, 0x100
    s_mov_b32 s79, 0x20000
    s_add_u32 s72, s8, 0x3100000
    s_addc_u32 s73, s9, 0
    s_mov_b32 s74, 0x10000
    s_mov_b32 s75, 0x20000
    s_cmp_lg_u32 s2, 255
    s_cbranch_scc1 L_k1_notag
    s_cmp_lg_u32 s28, 0
    s_cbranch_scc1 L_k1_notag
    s_mov_b32 s70, 0xff00
    s_mov_b64 exec, 1
    buffer_load_dword v60, off, s[72:75], s70 sc1
    s_waitcnt vmcnt(0)
    v_add_u32 v60, 1, v60
    v_max_u32 v60, 1, v60
    buffer_store_dword v60, off, s[76:79], 0 sc1
    buffer_store_dword v60, off, s[72:75], s70 sc1
    s_mov_b64 exec, -1
L_k1_notag:
    s_mov_b64 s[66:67], s[88:89]
    s_add_u32 s56, s8, 0x3080000
    s_addc_u32 s57, s9, 0
    s_mov_b32 s58, 0x80000
    s_mov_b32 s59, 0x20000
    s_lshl_b32 s34, s3, 6
    s_add_u32 s34, s34, s33
    s_lshl_b32 s34, s34, 10
    v_lshlrev_b32 v24, 4, v2
    v_mov_b32 v26, 0
    v_mov_b32 v27, 0
    v_mov_b32 v28, 0
    v_mov_b32 v29, 0
    buffer_store_dwordx4 v[26:29], v24, s[56:59], s34 offen sc1
    s_mov_b32 s52, s4
    s_mov_b32 s53, s5
    s_mov_b32 s54, 0x240000
    s_mov_b32 s55, 0x20000
    s_and_b32 s34, s3, 3
    s_lshl_b32 s34, s34, 6
    s_add_u32 s34, s34, s33
    s_mul_i32 s34, s34, 9216
    buffer_load_dword v6, v3, s[52:55], s34 offen
    buffer_load_dword v7, v3, s[52:55], s34 offen offset:1024
    s_mul_i32 s34, s33, 10368
    s_add_u32 s35, s34, 2176
    v_lshrrev_b32 v4, 2, v2
    v_lshlrev_b32 v4, 12, v4
    v_and_b32 v5, 3, v2
    v_lshl_add_u32 v4, v5, 7, v4
    s_and_b32 s36, s3, 1
    s_lshl_b32 s36, s36, 6
    s_add_u32 s36, s36, s33
    s_lshl_b32 s36, s36, 16
    s_bfe_u32 s37, s3, 0x10001
    s_lshl_b32 s37, s37, 11
    s_add_u32 s36, s36, s37
    s_waitcnt vmcnt(0)
    s_mov_b64 s[60:61], s[92:93]
    s_mov_b64 s[62:63], s[94:95]
    s_mov_b64 s[58:59], s[90:91]
    v_lshlrev_b32 v3, 4, v2
    s_lshl_b32 s70, s3, 6
    s_add_u32 s70, s70, s33
    v_lshrrev_b32 v43, 4, v2
    v_mul_u32_u24 v40, 9216, v43
    v_and_b32 v41, 0xf0, v3
    v_add_u32 v40, v40, v41
    v_bfe_u32 v42, v2, 1, 3
    v_mul_u32_u24 v42, 36864, v42
    v_lshl_add_u32 v42, v43, 5, v42
    v_and_or_b32 v42, v3, 16, v42
    s_cmp_ge_u32 s70, 576
    s_cselect_b32 s72, s62, s60
    s_cselect_b32 s73, s63, s61
    s_mov_b32 s74, 5308416
    s_mov_b32 s75, 0x20000
    s_cselect_b32 s76, 576, 0
    s_cselect_b32 s77, 1024, 0
    s_sub_u32 s76, s70, s76
    s_lshr_b32 s79, s76, 2
    s_mul_i32 s78, s79, 36864
    s_and_b32 s71, s76, 3
    s_lshl_b32 s90, s71, 8
    s_add_u32 s78, s78, s90
    s_add_u32 s78, s78, 8192
    s_mul_i32 s71, s71, 294912
    s_add_u32 s77, s71, s77
    s_lshr_b32 s71, s79, 3
    s_lshl_b32 s71, s71, 11
    s_add_u32 s77, s77, s71
    s_and_b32 s71, s79, 7
    s_lshl_b32 s71, s71, 7
    s_add_u32 s77, s77, s71
    buffer_load_dwordx4 v[44:47], v40, s[72:75], s78 offen
    s_cmp_lt_u32 s70, 448
    s_cbranch_scc0 L_k1a_rpd
    s_mov_b32 s80, s62
    s_mov_b32 s81, s63
    s_mov_b32 s82, 5308416
    s_mov_b32 s83, 0x20000
    s_add_u32 s84, s8, 0x2e00000
    s_addc_u32 s85, s9, 0
    s_cmp_lt_u32 s70, 128
    s_cselect_b32 s86, 0x120000, 0
    s_mov_b32 s87, 0x20000
    s_add_u32 s76, s70, 448
    s_lshr_b32 s79, s76, 2
    s_mul_i32 s88, s79, 36864
    s_and_b32 s71, s76, 3
    s_lshl_b32 s90, s71, 8
    s_add_u32 s88, s88, s90
    s_add_u32 s88, s88, 8192
    s_mul_i32 s71, s71, 294912
    s_add_u32 s89, s71, 1024
    s_lshr_b32 s71, s79, 3
    s_lshl_b32 s71, s71, 11
    s_add_u32 s89, s89, s71
    s_and_b32 s71, s79, 7
    s_lshl_b32 s71, s71, 7
    s_add_u32 s89, s89, s71
    v_mov_b32 v41, v42
    s_branch L_k1a_rp2
L_k1a_rpd:
    s_mov_b32 s80, s58
    s_mov_b32 s81, s59
    s_mov_b32 s82, 5308416
    s_mov_b32 s83, 0x20000
    s_add_u32 s84, s8, 0x2f80000
    s_addc_u32 s85, s9, 0
    s_mov_b32 s86, 0x90000
    s_mov_b32 s87, 0x20000
    s_sub_u32 s76, s70, 448
    s_mul_i32 s88, s76, 9216
    s_add_u32 s88, s88, 1024
    s_lshr_b32 s79, s76, 2
    s_lshl_b32 s89, s79, 12
    s_and_b32 s79, s76, 3
    s_cmp_ge_u32 s76, 512
    s_cselect_b32 s90, 7, 8
    s_cselect_b32 s91, 384, 0
    s_lshl_b32 s79, s79, s90
    s_add_u32 s89, s89, s79
    v_lshrrev_b32 v40, 3, v2
    v_lshlrev_b32 v41, 5, v40
    v_lshrrev_b32 v43, 5, v2
    v_mul_u32_u24 v43, s91, v43
    v_add_u32 v41, v41, v43
    v_mul_u32_u24 v40, 1152, v40
    v_and_b32 v43, 0x70, v3
    v_add_u32 v40, v40, v43
    v_bfe_u32 v43, v2, 1, 2
    v_lshl_add_u32 v41, v43, 10, v41
    v_and_or_b32 v41, v3, 16, v41
L_k1a_rp2:
    buffer_load_dwordx4 v[48:51], v40, s[80:83], s88 offen
    s_add_u32 s24, s8, 0x2e00000
    s_addc_u32 s25, s9, 0
    s_mov_b32 s26, 0x120000
    s_mov_b32 s27, 0x20000
    s_mov_b32 s40, s77
    s_mov_b32 s41, s89
    s_mov_b32 s44, s84
    s_mov_b32 s45, s85
    s_mov_b32 s46, s86
    s_mov_b32 s47, 0x20000
    s_add_u32 s70, s70, 512
    v_lshrrev_b32 v55, 4, v2
    v_mul_u32_u24 v52, 9216, v55
    v_and_b32 v53, 0xf0, v3
    v_add_u32 v52, v52, v53
    v_bfe_u32 v54, v2, 1, 3
    v_mul_u32_u24 v54, 36864, v54
    v_lshl_add_u32 v54, v55, 5, v54
    v_and_or_b32 v54, v3, 16, v54
    s_cmp_ge_u32 s70, 576
    s_cselect_b32 s72, s62, s60
    s_cselect_b32 s73, s63, s61
    s_mov_b32 s74, 5308416
    s_mov_b32 s75, 0x20000
    s_cselect_b32 s76, 576, 0
    s_cselect_b32 s77, 1024, 0
    s_sub_u32 s76, s70, s76
    s_lshr_b32 s79, s76, 2
    s_mul_i32 s78, s79, 36864
    s_and_b32 s71, s76, 3
    s_lshl_b32 s90, s71, 8
    s_add_u32 s78, s78, s90
    s_add_u32 s78, s78, 8192
    s_mul_i32 s71, s71, 294912
    s_add_u32 s77, s71, s77
    s_lshr_b32 s71, s79, 3
    s_lshl_b32 s71, s71, 11
    s_add_u32 s77, s77, s71
    s_and_b32 s71, s79, 7
    s_lshl_b32 s71, s71, 7
    s_add_u32 s77, s77, s71
    buffer_load_dwordx4 v[56:59], v52, s[72:75], s78 offen
    s_cmp_lt_u32 s70, 448
    s_cbranch_scc0 L_k1b_rpd
    s_mov_b32 s80, s62
    s_mov_b32 s81, s63
    s_mov_b32 s82, 5308416
    s_mov_b32 s83, 0x20000
    s_add_u32 s84, s8, 0x2e00000
    s_addc_u32 s85, s9, 0
    s_cmp_lt_u32 s70, 128
    s_cselect_b32 s86, 0x120000, 0
    s_mov_b32 s87, 0x20000
    s_add_u32 s76, s70, 448
    s_lshr_b32 s79, s76, 2
    s_mul_i32 s88, s79, 36864
    s_and_b32 s71, s76, 3
    s_lshl_b32 s90, s71, 8
    s_add_u32 s88, s88, s90
    s_add_u32 s88, s88, 8192
    s_mul_i32 s71, s71, 294912
    s_add_u32 s89, s71, 1024
    s_lshr_b32 s71, s79, 3
    s_lshl_b32 s71, s71, 11
    s_add_u32 s89, s89, s71
    s_and_b32 s71, s79, 7
    s_lshl_b32 s71, s71, 7
    s_add_u32 s89, s89, s71
    v_mov_b32 v53, v54
    s_branch L_k1b_rp2
L_k1b_rpd:
    s_mov_b32 s80, s58
    s_mov_b32 s81, s59
    s_mov_b32 s82, 5308416
    s_mov_b32 s83, 0x20000
    s_add_u32 s84, s8, 0x2f80000
    s_addc_u32 s85, s9, 0
    s_mov_b32 s86, 0x90000
    s_mov_b32 s87, 0x20000
    s_sub_u32 s76, s70, 448
    s_mul_i32 s88, s76, 9216
    s_add_u32 s88, s88, 1024
    s_lshr_b32 s79, s76, 2
    s_lshl_b32 s89, s79, 12
    s_and_b32 s79, s76, 3
    s_cmp_ge_u32 s76, 512
    s_cselect_b32 s90, 7, 8
    s_cselect_b32 s91, 384, 0
    s_lshl_b32 s79, s79, s90
    s_add_u32 s89, s89, s79
    v_lshrrev_b32 v52, 3, v2
    v_lshlrev_b32 v53, 5, v52
    v_lshrrev_b32 v55, 5, v2
    v_mul_u32_u24 v55, s91, v55
    v_add_u32 v53, v53, v55
    v_mul_u32_u24 v52, 1152, v52
    v_and_b32 v55, 0x70, v3
    v_add_u32 v52, v52, v55
    v_bfe_u32 v55, v2, 1, 2
    v_lshl_add_u32 v53, v55, 10, v53
    v_and_or_b32 v53, v3, 16, v53
L_k1b_rp2:
    buffer_load_dwordx4 v[60:63], v52, s[80:83], s88 offen
    s_add_u32 s24, s8, 0x2e00000
    s_addc_u32 s25, s9, 0
    s_mov_b32 s26, 0x120000
    s_mov_b32 s27, 0x20000
    buffer_load_dword v32, v4, s[16:19], s36 offen offset:0
    buffer_load_dword v33, v4, s[16:19], s36 offen offset:512
    s_waitcnt vmcnt(2)
    buffer_store_dwordx4 v[44:47], v42, s[24:27], s40 offen sc1
    buffer_store_dwordx4 v[48:51], v41, s[44:47], s41 offen sc1
    buffer_store_dwordx4 v[56:59], v54, s[24:27], s77 offen sc1
    buffer_store_dwordx4 v[60:63], v53, s[84:87], s89 offen sc1
    s_mov_b64 s[88:89], s[66:67]
    s_lshr_b32 s97, s33, 3
    s_lshl_b32 s97, s97, 3
    s_add_u32 s97, s97, s3
    s_lshl_b32 s97, s97, 7
    s_add_u32 s97, s97, 0x8000
    s_cmp_lg_u32 s28, 4
    s_cbranch_scc1 L_k1_non2
    s_mov_b32 s76, s88
    s_mov_b32 s77, s89
    s_mov_b32 s78, 0x100
    s_mov_b32 s79, 0x20000
    s_mov_b64 exec, 1
    s_mov_b32 s55, 0x20000
L_sequential_preLN__spectral_fnet__glu_gated_glu__prompt_pagain_7:
    buffer_load_dword v60, off, s[76:79], 0 sc1
    s_waitcnt vmcnt(0)
    v_cmp_eq_u32 vcc, 0, v60
    s_nop 4
    s_cbranch_vccz L_sequential_preLN__spectral_fnet__glu_gated_glu__prompt_pw_8
    s_sleep 4
    s_sub_u32 s55, s55, 1
    s_cbranch_scc0 L_sequential_preLN__spectral_fnet__glu_gated_glu__prompt_pagain_7
L_sequential_preLN__spectral_fnet__glu_gated_glu__prompt_pw_8:
L_sequential_preLN__spectral_fnet__glu_gated_glu__prompt_pok_6:
    v_readfirstlane_b32 s96, v60
    s_mov_b64 exec, -1
L_k1_non2:
    s_waitcnt vmcnt(0)
    s_cmp_ge_u32 s28, 4
    s_cbranch_scc1 L_k2_entry
    s_barrier
    s_branch L_k2_entry
L_k1_end:
    s_endpgm
L_k2_entry:
    s_load_dwordx4 s[12:15], s[0:1], 8
    s_load_dwordx4 s[60:63], s[0:1], 48
    s_load_dwordx2 s[58:59], s[0:1], 64
    s_load_dwordx2 s[4:5], s[0:1], 0
    s_load_dwordx2 s[8:9], s[0:1], 88
    v_mbcnt_lo_u32_b32 v2, -1, 0
    v_mbcnt_hi_u32_b32 v2, -1, v2
    s_and_b32 s3, s2, 7
    s_lshr_b32 s33, s2, 3
    s_lshr_b32 s30, s3, 1
    s_and_b32 s29, s3, 1
    s_lshl_b32 s29, s29, 3
    s_lshr_b32 s34, s33, 2
    s_add_u32 s29, s29, s34
    s_and_b32 s31, s33, 3
    v_lshlrev_b32 v3, 4, v2
    s_cmp_ge_u32 s28, 4
    s_cbranch_scc1 L_k2_loader
    s_lshr_b32 s44, s28, 1
    s_and_b32 s45, s28, 1
    v_and_b32 v8, 15, v2
    v_lshrrev_b32 v9, 4, v2
    v_mov_b32 v152, v3
    s_lshl_b32 s46, s45, 12
    s_add_u32 s46, s46, 16384
    v_add_u32 v144, s46, v3
    v_add_u32 v145, 24576, v3
    v_and_b32 v10, 7, v8
    v_xor_b32 v10, v10, v9
    v_lshlrev_b32 v10, 4, v10
    v_lshl_add_u32 v10, v8, 7, v10
    s_lshl_b32 s46, s44, 13
    s_lshl_b32 s47, s45, 12
    s_add_u32 s48, s46, s47
    s_xor_b32 s47, s47, 4096
    s_add_u32 s49, s46, s47
    v_add_u32 v146, s48, v10
    v_add_u32 v147, s49, v10
    v_xor_b32 v148, 64, v146
    v_xor_b32 v149, 64, v147
    v_add_u32 v168, 69632, v144
    v_add_u32 v169, 69632, v145
    v_add_u32 v170, 69632, v146
    v_add_u32 v171, 69632, v147
    v_add_u32 v172, 69632, v148
    v_add_u32 v173, 69632, v149
    s_waitcnt lgkmcnt(0)
    s_add_u32 s24, s8, 0x500000
    s_addc_u32 s25, s9, 0
    s_mov_b32 s26, 0x900000
    s_mov_b32 s27, 0x20000
    s_mov_b32 s16, s4
    s_mov_b32 s17, s5
    s_mov_b32 s18, 0x240000
    s_mov_b32 s19, 0x20000
    s_add_u32 s20, s8, 0x3080000
    s_addc_u32 s21, s9, 0
    s_mov_b32 s22, 0x80000
    s_mov_b32 s23, 0x20000
    s_lshl_b32 s85, s45, 1
    s_xor_b32 s85, s85, s30
    s_lshl_b32 s36, s29, 3
    s_lshl_b32 s37, s44, 2
    s_add_u32 s36, s36, s37
    s_add_u32 s36, s36, s85
    s_mul_i32 s37, s36, 18432
    s_lshl_b32 s38, s31, 1
    s_add_u32 s38, s38, s45
    s_lshl_b32 s39, s38, 7
    s_add_u32 s39, s39, s37
    v_mul_u32_u24 v10, 1152, v8
    v_lshl_add_u32 v12, v9, 3, v10
    v_and_b32 v11, 1, v9
    v_lshl_add_u32 v10, v11, 5, v10
    v_lshrrev_b32 v11, 1, v9
    v_lshl_add_u32 v10, v11, 4, v10
    buffer_load_dwordx4 v[154:157], v10, s[16:19], s39 offen
    buffer_load_dwordx4 v[158:161], v10, s[16:19], s39 offen offset:64
    s_lshl_b32 s39, s31, 5
    s_add_u32 s39, s39, s37
    buffer_load_dwordx2 v[162:163], v12, s[16:19], s39 offen offset:1024
    s_lshl_b32 s80, s38, 11
    s_add_u32 s80, s80, s37
    s_lshr_b32 s81, s31, 1
    s_lshl_b32 s81, s81, 10
    s_and_b32 s40, s31, 1
    s_lshl_b32 s40, s40, 3
    s_add_u32 s81, s81, s40
    s_add_u32 s81, s81, s37
    s_add_u32 s81, s81, 16384
    s_lshl_b32 s82, s36, 10
    s_add_u32 s82, s82, 65536
    s_lshl_b32 s83, s38, 7
    s_add_u32 s83, s83, s82
    v_lshlrev_b32 v164, 7, v2
    v_lshlrev_b32 v165, 3, v8
    v_lshl_add_u32 v166, v9, 8, v165
    s_lshl_b32 s40, s29, 2
    s_add_u32 s40, s40, s31
    s_lshl_b32 s41, s40, 1
    s_add_u32 s41, s41, s44
    s_lshl_b32 s41, s41, 10
    s_add_u32 s41, s41, 196608
    s_lshl_b32 s40, s40, 17
    s_lshl_b32 s43, s28, 13
    s_add_u32 s43, s43, s40
    s_lshl_b32 s46, s30, 15
    s_add_u32 s46, s46, s43
    s_lshl_b32 s47, s30, 1
    s_add_u32 s47, s47, s45
    s_lshl_b32 s47, s47, 7
    s_add_u32 s47, s47, s41
    s_add_u32 s48, s46, 4096
    s_xor_b32 s49, s30, 1
    s_lshl_b32 s49, s49, 15
    s_add_u32 s49, s49, s43
    s_add_u32 s86, s49, 2048
    s_add_u32 s89, s49, 8
    s_xor_b32 s49, s30, 2
    s_lshl_b32 s49, s49, 15
    s_add_u32 s49, s49, s43
    s_add_u32 s87, s49, 4096
    s_add_u32 s90, s49, 8192
    s_xor_b32 s49, s30, 3
    s_lshl_b32 s49, s49, 15
    s_add_u32 s49, s49, s43
    s_add_u32 s88, s49, 6144
    s_add_u32 s91, s49, 8200
    s_add_u32 s16, s8, 0xe00000
    s_addc_u32 s17, s9, 0
    s_mov_b32 s18, 0x240000
    s_mov_b32 s19, 0x20000
    s_add_u32 s12, s8, 0x1080000
    s_addc_u32 s13, s9, 0
    s_mov_b32 s14, 0x240000
    s_mov_b32 s15, 0x20000
    v_mov_b32 v0, 0
    v_mov_b32 v1, 0
    v_mov_b32 v2, 0
    v_mov_b32 v3, 0
    v_mov_b32 v4, 0
    v_mov_b32 v5, 0
    v_mov_b32 v6, 0
    v_mov_b32 v7, 0
    v_mov_b32 v8, 0
    v_mov_b32 v9, 0
    v_mov_b32 v10, 0
    v_mov_b32 v11, 0
    v_mov_b32 v12, 0
    v_mov_b32 v13, 0
    v_mov_b32 v14, 0
    v_mov_b32 v15, 0
    v_mov_b32 v16, 0
    v_mov_b32 v17, 0
    v_mov_b32 v18, 0
    v_mov_b32 v19, 0
    v_mov_b32 v20, 0
    v_mov_b32 v21, 0
    v_mov_b32 v22, 0
    v_mov_b32 v23, 0
    v_mov_b32 v24, 0
    v_mov_b32 v25, 0
    v_mov_b32 v26, 0
    v_mov_b32 v27, 0
    v_mov_b32 v28, 0
    v_mov_b32 v29, 0
    v_mov_b32 v30, 0
    v_mov_b32 v31, 0
    v_mov_b32 v32, 0
    v_mov_b32 v33, 0
    v_mov_b32 v34, 0
    v_mov_b32 v35, 0
    v_mov_b32 v36, 0
    v_mov_b32 v37, 0
    v_mov_b32 v38, 0
    v_mov_b32 v39, 0
    v_mov_b32 v40, 0
    v_mov_b32 v41, 0
    v_mov_b32 v42, 0
    v_mov_b32 v43, 0
    v_mov_b32 v44, 0
    v_mov_b32 v45, 0
    v_mov_b32 v46, 0
    v_mov_b32 v47, 0
    v_mov_b32 v48, 0
    v_mov_b32 v49, 0
    v_mov_b32 v50, 0
    v_mov_b32 v51, 0
    v_mov_b32 v52, 0
    v_mov_b32 v53, 0
    v_mov_b32 v54, 0
    v_mov_b32 v55, 0
    v_mov_b32 v56, 0
    v_mov_b32 v57, 0
    v_mov_b32 v58, 0
    v_mov_b32 v59, 0
    v_mov_b32 v60, 0
    v_mov_b32 v61, 0
    v_mov_b32 v62, 0
    v_mov_b32 v63, 0
    v_mov_b32 v64, 0
    v_mov_b32 v65, 0
    v_mov_b32 v66, 0
    v_mov_b32 v67, 0
    v_mov_b32 v68, 0
    v_mov_b32 v69, 0
    v_mov_b32 v70, 0
    v_mov_b32 v71, 0
    s_mov_b32 s49, 0
    s_mov_b32 s52, 16
    s_mov_b32 s56, 34816
    s_mov_b32 s57, 0xfffe6800
    s_barrier
    s_barrier
    ds_read_b128 v[72:75], v144 offset:0
    ds_read_b128 v[92:95], v146 offset:0
    ds_read_b128 v[96:99], v146 offset:2048
    ds_read_b128 v[100:103], v147 offset:0
    ds_read_b128 v[104:107], v147 offset:2048
    ds_read_b128 v[76:79], v144 offset:1024
    ds_read_b128 v[80:83], v144 offset:2048
    ds_read_b128 v[84:87], v144 offset:3072
    ds_read_b128 v[88:91], v145 offset:0
L_k2_loop:
    s_waitcnt lgkmcnt(0)
    v_mfma_f32_16x16x32_bf16 v[0:3], v[72:75], v[92:95], v[0:3]
    ds_read_b128 v[108:111], v144 offset:9216
    v_mfma_f32_16x16x32_bf16 v[4:7], v[72:75], v[96:99], v[4:7]
    ds_read_b128 v[128:131], v148 offset:0
    v_mfma_f32_16x16x32_bf16 v[8:11], v[72:75], v[100:103], v[8:11]
    ds_read_b128 v[132:135], v148 offset:2048
    v_mfma_f32_16x16x32_bf16 v[12:15], v[72:75], v[104:107], v[12:15]
    ds_read_b128 v[136:139], v149 offset:0
    v_mfma_f32_16x16x32_bf16 v[16:19], v[76:79], v[92:95], v[16:19]
    ds_read_b128 v[140:143], v149 offset:2048
    v_mfma_f32_16x16x32_bf16 v[20:23], v[76:79], v[96:99], v[20:23]
    ds_read_b128 v[112:115], v144 offset:10240
    v_mfma_f32_16x16x32_bf16 v[24:27], v[76:79], v[100:103], v[24:27]
    ds_read_b128 v[116:119], v144 offset:11264
    v_mfma_f32_16x16x32_bf16 v[28:31], v[76:79], v[104:107], v[28:31]
    ds_read_b128 v[120:123], v144 offset:12288
    v_mfma_f32_16x16x32_bf16 v[32:35], v[80:83], v[92:95], v[32:35]
    ds_read_b128 v[124:127], v145 offset:9216
    v_mfma_f32_16x16x32_bf16 v[36:39], v[80:83], v[96:99], v[36:39]
    v_mfma_f32_16x16x32_bf16 v[40:43], v[80:83], v[100:103], v[40:43]
    v_mfma_f32_16x16x32_bf16 v[44:47], v[80:83], v[104:107], v[44:47]
    v_mfma_f32_16x16x32_bf16 v[48:51], v[84:87], v[92:95], v[48:51]
    v_mfma_f32_16x16x32_bf16 v[52:55], v[84:87], v[96:99], v[52:55]
    v_mfma_f32_16x16x32_bf16 v[56:59], v[84:87], v[100:103], v[56:59]
    v_mfma_f32_16x16x32_bf16 v[60:63], v[84:87], v[104:107], v[60:63]
    v_mfma_f32_16x16x32_bf16 v[64:67], v[88:91], v[92:95], v[64:67]
    v_mfma_f32_16x16x32_bf16 v[68:71], v[88:91], v[96:99], v[68:71]
    s_waitcnt lgkmcnt(0)
    s_barrier
    v_mfma_f32_16x16x32_bf16 v[0:3], v[108:111], v[128:131], v[0:3]
    ds_read_b128 v[72:75], v144 offset:34816
    v_mfma_f32_16x16x32_bf16 v[4:7], v[108:111], v[132:135], v[4:7]
    ds_read_b128 v[92:95], v146 offset:34816
    v_mfma_f32_16x16x32_bf16 v[8:11], v[108:111], v[136:139], v[8:11]
    ds_read_b128 v[96:99], v146 offset:36864
    v_mfma_f32_16x16x32_bf16 v[12:15], v[108:111], v[140:143], v[12:15]
    ds_read_b128 v[100:103], v147 offset:34816
    v_mfma_f32_16x16x32_bf16 v[16:19], v[112:115], v[128:131], v[16:19]
    ds_read_b128 v[104:107], v147 offset:36864
    v_mfma_f32_16x16x32_bf16 v[20:23], v[112:115], v[132:135], v[20:23]
    ds_read_b128 v[76:79], v144 offset:35840
    v_mfma_f32_16x16x32_bf16 v[24:27], v[112:115], v[136:139], v[24:27]
    ds_read_b128 v[80:83], v144 offset:36864
    v_mfma_f32_16x16x32_bf16 v[28:31], v[112:115], v[140:143], v[28:31]
    ds_read_b128 v[84:87], v144 offset:37888
    v_mfma_f32_16x16x32_bf16 v[32:35], v[116:119], v[128:131], v[32:35]
    ds_read_b128 v[88:91], v145 offset:34816
    v_mfma_f32_16x16x32_bf16 v[36:39], v[116:119], v[132:135], v[36:39]
    v_mfma_f32_16x16x32_bf16 v[40:43], v[116:119], v[136:139], v[40:43]
    v_mfma_f32_16x16x32_bf16 v[44:47], v[116:119], v[140:143], v[44:47]
    v_mfma_f32_16x16x32_bf16 v[48:51], v[120:123], v[128:131], v[48:51]
    v_mfma_f32_16x16x32_bf16 v[52:55], v[120:123], v[132:135], v[52:55]
    v_mfma_f32_16x16x32_bf16 v[56:59], v[120:123], v[136:139], v[56:59]
    v_mfma_f32_16x16x32_bf16 v[60:63], v[120:123], v[140:143], v[60:63]
    v_mfma_f32_16x16x32_bf16 v[64:67], v[124:127], v[128:131], v[64:67]
    v_mfma_f32_16x16x32_bf16 v[68:71], v[124:127], v[132:135], v[68:71]
    s_waitcnt lgkmcnt(0)
    v_mfma_f32_16x16x32_bf16 v[0:3], v[72:75], v[92:95], v[0:3]
    ds_read_b128 v[108:111], v144 offset:44032
    v_mfma_f32_16x16x32_bf16 v[4:7], v[72:75], v[96:99], v[4:7]
    ds_read_b128 v[128:131], v148 offset:34816
    v_mfma_f32_16x16x32_bf16 v[8:11], v[72:75], v[100:103], v[8:11]
    ds_read_b128 v[132:135], v148 offset:36864
    v_mfma_f32_16x16x32_bf16 v[12:15], v[72:75], v[104:107], v[12:15]
    ds_read_b128 v[136:139], v149 offset:34816
    v_mfma_f32_16x16x32_bf16 v[16:19], v[76:79], v[92:95], v[16:19]
    ds_read_b128 v[140:143], v149 offset:36864
    v_mfma_f32_16x16x32_bf16 v[20:23], v[76:79], v[96:99], v[20:23]
    ds_read_b128 v[112:115], v144 offset:45056
    v_mfma_f32_16x16x32_bf16 v[24:27], v[76:79], v[100:103], v[24:27]
    ds_read_b128 v[116:119], v144 offset:46080
    v_mfma_f32_16x16x32_bf16 v[28:31], v[76:79], v[104:107], v[28:31]
    ds_read_b128 v[120:123], v144 offset:47104
    v_mfma_f32_16x16x32_bf16 v[32:35], v[80:83], v[92:95], v[32:35]
    ds_read_b128 v[124:127], v145 offset:44032
    v_mfma_f32_16x16x32_bf16 v[36:39], v[80:83], v[96:99], v[36:39]
    v_mfma_f32_16x16x32_bf16 v[40:43], v[80:83], v[100:103], v[40:43]
    v_mfma_f32_16x16x32_bf16 v[44:47], v[80:83], v[104:107], v[44:47]
    v_mfma_f32_16x16x32_bf16 v[48:51], v[84:87], v[92:95], v[48:51]
    v_mfma_f32_16x16x32_bf16 v[52:55], v[84:87], v[96:99], v[52:55]
    v_mfma_f32_16x16x32_bf16 v[56:59], v[84:87], v[100:103], v[56:59]
    v_mfma_f32_16x16x32_bf16 v[60:63], v[84:87], v[104:107], v[60:63]
    v_mfma_f32_16x16x32_bf16 v[64:67], v[88:91], v[92:95], v[64:67]
    v_mfma_f32_16x16x32_bf16 v[68:71], v[88:91], v[96:99], v[68:71]
    s_waitcnt lgkmcnt(0)
    s_barrier
    v_mfma_f32_16x16x32_bf16 v[0:3], v[108:111], v[128:131], v[0:3]
    ds_read_b128 v[72:75], v168 offset:0
    v_mfma_f32_16x16x32_bf16 v[4:7], v[108:111], v[132:135], v[4:7]
    ds_read_b128 v[92:95], v170 offset:0
    v_mfma_f32_16x16x32_bf16 v[8:11], v[108:111], v[136:139], v[8:11]
    ds_read_b128 v[96:99], v170 offset:2048
    v_mfma_f32_16x16x32_bf16 v[12:15], v[108:111], v[140:143], v[12:15]
    ds_read_b128 v[100:103], v171 offset:0
    v_mfma_f32_16x16x32_bf16 v[16:19], v[112:115], v[128:131], v[16:19]
    ds_read_b128 v[104:107], v171 offset:2048
    v_mfma_f32_16x16x32_bf16 v[20:23], v[112:115], v[132:135], v[20:23]
    ds_read_b128 v[76:79], v168 offset:1024
    v_mfma_f32_16x16x32_bf16 v[24:27], v[112:115], v[136:139], v[24:27]
    ds_read_b128 v[80:83], v168 offset:2048
    v_mfma_f32_16x16x32_bf16 v[28:31], v[112:115], v[140:143], v[28:31]
    ds_read_b128 v[84:87], v168 offset:3072
    v_mfma_f32_16x16x32_bf16 v[32:35], v[116:119], v[128:131], v[32:35]
    ds_read_b128 v[88:91], v169 offset:0
    v_mfma_f32_16x16x32_bf16 v[36:39], v[116:119], v[132:135], v[36:39]
    v_mfma_f32_16x16x32_bf16 v[40:43], v[116:119], v[136:139], v[40:43]
    v_mfma_f32_16x16x32_bf16 v[44:47], v[116:119], v[140:143], v[44:47]
    v_mfma_f32_16x16x32_bf16 v[48:51], v[120:123], v[128:131], v[48:51]
    v_mfma_f32_16x16x32_bf16 v[52:55], v[120:123], v[132:135], v[52:55]
    v_mfma_f32_16x16x32_bf16 v[56:59], v[120:123], v[136:139], v[56:59]
    v_mfma_f32_16x16x32_bf16 v[60:63], v[120:123], v[140:143], v[60:63]
    v_mfma_f32_16x16x32_bf16 v[64:67], v[124:127], v[128:131], v[64:67]
    v_mfma_f32_16x16x32_bf16 v[68:71], v[124:127], v[132:135], v[68:71]
    s_waitcnt lgkmcnt(0)
    v_mfma_f32_16x16x32_bf16 v[0:3], v[72:75], v[92:95], v[0:3]
    ds_read_b128 v[108:111], v168 offset:9216
    v_mfma_f32_16x16x32_bf16 v[4:7], v[72:75], v[96:99], v[4:7]
    ds_read_b128 v[128:131], v172 offset:0
    v_mfma_f32_16x16x32_bf16 v[8:11], v[72:75], v[100:103], v[8:11]
    ds_read_b128 v[132:135], v172 offset:2048
    v_mfma_f32_16x16x32_bf16 v[12:15], v[72:75], v[104:107], v[12:15]
    ds_read_b128 v[136:139], v173 offset:0
    v_mfma_f32_16x16x32_bf16 v[16:19], v[76:79], v[92:95], v[16:19]
    ds_read_b128 v[140:143], v173 offset:2048
    v_mfma_f32_16x16x32_bf16 v[20:23], v[76:79], v[96:99], v[20:23]
    ds_read_b128 v[112:115], v168 offset:10240
    v_mfma_f32_16x16x32_bf16 v[24:27], v[76:79], v[100:103], v[24:27]
    ds_read_b128 v[116:119], v168 offset:11264
    v_mfma_f32_16x16x32_bf16 v[28:31], v[76:79], v[104:107], v[28:31]
    ds_read_b128 v[120:123], v168 offset:12288
    v_mfma_f32_16x16x32_bf16 v[32:35], v[80:83], v[92:95], v[32:35]
    ds_read_b128 v[124:127], v169 offset:9216
    v_mfma_f32_16x16x32_bf16 v[36:39], v[80:83], v[96:99], v[36:39]
    v_mfma_f32_16x16x32_bf16 v[40:43], v[80:83], v[100:103], v[40:43]
    v_mfma_f32_16x16x32_bf16 v[44:47], v[80:83], v[104:107], v[44:47]
    v_mfma_f32_16x16x32_bf16 v[48:51], v[84:87], v[92:95], v[48:51]
    v_mfma_f32_16x16x32_bf16 v[52:55], v[84:87], v[96:99], v[52:55]
    v_mfma_f32_16x16x32_bf16 v[56:59], v[84:87], v[100:103], v[56:59]
    v_mfma_f32_16x16x32_bf16 v[60:63], v[84:87], v[104:107], v[60:63]
    v_mfma_f32_16x16x32_bf16 v[64:67], v[88:91], v[92:95], v[64:67]
    v_mfma_f32_16x16x32_bf16 v[68:71], v[88:91], v[96:99], v[68:71]
    s_waitcnt lgkmcnt(0)
    s_barrier
    v_mfma_f32_16x16x32_bf16 v[0:3], v[108:111], v[128:131], v[0:3]
    ds_read_b128 v[72:75], v168 offset:34816
    v_mfma_f32_16x16x32_bf16 v[4:7], v[108:111], v[132:135], v[4:7]
    ds_read_b128 v[92:95], v170 offset:34816
    v_mfma_f32_16x16x32_bf16 v[8:11], v[108:111], v[136:139], v[8:11]
    ds_read_b128 v[96:99], v170 offset:36864
    v_mfma_f32_16x16x32_bf16 v[12:15], v[108:111], v[140:143], v[12:15]
    ds_read_b128 v[100:103], v171 offset:34816
    v_mfma_f32_16x16x32_bf16 v[16:19], v[112:115], v[128:131], v[16:19]
    ds_read_b128 v[104:107], v171 offset:36864
    v_mfma_f32_16x16x32_bf16 v[20:23], v[112:115], v[132:135], v[20:23]
    ds_read_b128 v[76:79], v168 offset:35840
    v_mfma_f32_16x16x32_bf16 v[24:27], v[112:115], v[136:139], v[24:27]
    ds_read_b128 v[80:83], v168 offset:36864
    v_mfma_f32_16x16x32_bf16 v[28:31], v[112:115], v[140:143], v[28:31]
    ds_read_b128 v[84:87], v168 offset:37888
    v_mfma_f32_16x16x32_bf16 v[32:35], v[116:119], v[128:131], v[32:35]
    ds_read_b128 v[88:91], v169 offset:34816
    v_mfma_f32_16x16x32_bf16 v[36:39], v[116:119], v[132:135], v[36:39]
    v_mfma_f32_16x16x32_bf16 v[40:43], v[116:119], v[136:139], v[40:43]
    v_mfma_f32_16x16x32_bf16 v[44:47], v[116:119], v[140:143], v[44:47]
    v_mfma_f32_16x16x32_bf16 v[48:51], v[120:123], v[128:131], v[48:51]
    v_mfma_f32_16x16x32_bf16 v[52:55], v[120:123], v[132:135], v[52:55]
    v_mfma_f32_16x16x32_bf16 v[56:59], v[120:123], v[136:139], v[56:59]
    v_mfma_f32_16x16x32_bf16 v[60:63], v[120:123], v[140:143], v[60:63]
    v_mfma_f32_16x16x32_bf16 v[64:67], v[124:127], v[128:131], v[64:67]
    v_mfma_f32_16x16x32_bf16 v[68:71], v[124:127], v[132:135], v[68:71]
    s_waitcnt lgkmcnt(0)
    v_mfma_f32_16x16x32_bf16 v[0:3], v[72:75], v[92:95], v[0:3]
    ds_read_b128 v[108:111], v168 offset:44032
    v_mfma_f32_16x16x32_bf16 v[4:7], v[72:75], v[96:99], v[4:7]
    ds_read_b128 v[128:131], v172 offset:34816
    v_mfma_f32_16x16x32_bf16 v[8:11], v[72:75], v[100:103], v[8:11]
    ds_read_b128 v[132:135], v172 offset:36864
    v_mfma_f32_16x16x32_bf16 v[12:15], v[72:75], v[104:107], v[12:15]
    ds_read_b128 v[136:139], v173 offset:34816
    v_mfma_f32_16x16x32_bf16 v[16:19], v[76:79], v[92:95], v[16:19]
    ds_read_b128 v[140:143], v173 offset:36864
    v_mfma_f32_16x16x32_bf16 v[20:23], v[76:79], v[96:99], v[20:23]
    ds_read_b128 v[112:115], v168 offset:45056
    v_mfma_f32_16x16x32_bf16 v[24:27], v[76:79], v[100:103], v[24:27]
    ds_read_b128 v[116:119], v168 offset:46080
    v_mfma_f32_16x16x32_bf16 v[28:31], v[76:79], v[104:107], v[28:31]
    ds_read_b128 v[120:123], v168 offset:47104
    v_mfma_f32_16x16x32_bf16 v[32:35], v[80:83], v[92:95], v[32:35]
    ds_read_b128 v[124:127], v169 offset:44032
    v_mfma_f32_16x16x32_bf16 v[36:39], v[80:83], v[96:99], v[36:39]
    v_mfma_f32_16x16x32_bf16 v[40:43], v[80:83], v[100:103], v[40:43]
    v_mfma_f32_16x16x32_bf16 v[44:47], v[80:83], v[104:107], v[44:47]
    v_mfma_f32_16x16x32_bf16 v[48:51], v[84:87], v[92:95], v[48:51]
    v_mfma_f32_16x16x32_bf16 v[52:55], v[84:87], v[96:99], v[52:55]
    v_mfma_f32_16x16x32_bf16 v[56:59], v[84:87], v[100:103], v[56:59]
    v_mfma_f32_16x16x32_bf16 v[60:63], v[84:87], v[104:107], v[60:63]
    v_mfma_f32_16x16x32_bf16 v[64:67], v[88:91], v[92:95], v[64:67]
    v_mfma_f32_16x16x32_bf16 v[68:71], v[88:91], v[96:99], v[68:71]
    s_waitcnt lgkmcnt(0)
    s_barrier
    v_mfma_f32_16x16x32_bf16 v[0:3], v[108:111], v[128:131], v[0:3]
    ds_read_b128 v[72:75], v144 offset:0
    v_mfma_f32_16x16x32_bf16 v[4:7], v[108:111], v[132:135], v[4:7]
    ds_read_b128 v[92:95], v146 offset:0
    v_mfma_f32_16x16x32_bf16 v[8:11], v[108:111], v[136:139], v[8:11]
    ds_read_b128 v[96:99], v146 offset:2048
    v_mfma_f32_16x16x32_bf16 v[12:15], v[108:111], v[140:143], v[12:15]
    ds_read_b128 v[100:103], v147 offset:0
    v_mfma_f32_16x16x32_bf16 v[16:19], v[112:115], v[128:131], v[16:19]
    ds_read_b128 v[104:107], v147 offset:2048
    v_mfma_f32_16x16x32_bf16 v[20:23], v[112:115], v[132:135], v[20:23]
    ds_read_b128 v[76:79], v144 offset:1024
    v_mfma_f32_16x16x32_bf16 v[24:27], v[112:115], v[136:139], v[24:27]
    ds_read_b128 v[80:83], v144 offset:2048
    v_mfma_f32_16x16x32_bf16 v[28:31], v[112:115], v[140:143], v[28:31]
    ds_read_b128 v[84:87], v144 offset:3072
    v_mfma_f32_16x16x32_bf16 v[32:35], v[116:119], v[128:131], v[32:35]
    ds_read_b128 v[88:91], v145 offset:0
    v_mfma_f32_16x16x32_bf16 v[36:39], v[116:119], v[132:135], v[36:39]
    s_sub_u32 s52, s52, 4
    v_mfma_f32_16x16x32_bf16 v[40:43], v[116:119], v[136:139], v[40:43]
    s_cmp_lg_u32 s52, 0
    v_mfma_f32_16x16x32_bf16 v[44:47], v[116:119], v[140:143], v[44:47]
    v_mfma_f32_16x16x32_bf16 v[48:51], v[120:123], v[128:131], v[48:51]
    v_mfma_f32_16x16x32_bf16 v[52:55], v[120:123], v[132:135], v[52:55]
    v_mfma_f32_16x16x32_bf16 v[56:59], v[120:123], v[136:139], v[56:59]
    v_mfma_f32_16x16x32_bf16 v[60:63], v[120:123], v[140:143], v[60:63]
    v_mfma_f32_16x16x32_bf16 v[64:67], v[124:127], v[128:131], v[64:67]
    v_mfma_f32_16x16x32_bf16 v[68:71], v[124:127], v[132:135], v[68:71]
    s_cbranch_scc1 L_k2_loop
    s_waitcnt lgkmcnt(0)
    s_nop 7
    v_cvt_pk_bf16_f32 v72, v4, v5
    v_cvt_pk_bf16_f32 v73, v6, v7
    v_cvt_pk_bf16_f32 v74, v20, v21
    v_cvt_pk_bf16_f32 v75, v22, v23
    buffer_store_dwordx4 v[72:75], v152, s[24:27], s46 offen offset:2048 sc1
    v_cvt_pk_bf16_f32 v76, v36, v37
    v_cvt_pk_bf16_f32 v77, v38, v39
    v_cvt_pk_bf16_f32 v78, v52, v53
    v_cvt_pk_bf16_f32 v79, v54, v55
    buffer_store_dwordx4 v[76:79], v152, s[24:27], s46 offen offset:3072 sc1
    v_cvt_pk_bf16_f32 v80, v8, v9
    v_cvt_pk_bf16_f32 v81, v10, v11
    v_cvt_pk_bf16_f32 v82, v24, v25
    v_cvt_pk_bf16_f32 v83, v26, v27
    buffer_store_dwordx4 v[80:83], v152, s[24:27], s48 offen offset:0 sc1
    v_cvt_pk_bf16_f32 v84, v40, v41
    v_cvt_pk_bf16_f32 v85, v42, v43
    v_cvt_pk_bf16_f32 v86, v56, v57
    v_cvt_pk_bf16_f32 v87, v58, v59
    buffer_store_dwordx4 v[84:87], v152, s[24:27], s48 offen offset:1024 sc1
    v_cvt_pk_bf16_f32 v88, v12, v13
    v_cvt_pk_bf16_f32 v89, v14, v15
    v_cvt_pk_bf16_f32 v90, v28, v29
    v_cvt_pk_bf16_f32 v91, v30, v31
    buffer_store_dwordx4 v[88:91], v152, s[24:27], s48 offen offset:2048 sc1
    v_cvt_pk_bf16_f32 v92, v44, v45
    v_cvt_pk_bf16_f32 v93, v46, v47
    v_cvt_pk_bf16_f32 v94, v60, v61
    v_cvt_pk_bf16_f32 v95, v62, v63
    buffer_store_dwordx4 v[92:95], v152, s[24:27], s48 offen offset:3072 sc1
    v_cvt_pk_bf16_f32 v96, v64, v65
    v_cvt_pk_bf16_f32 v97, v66, v67
    v_cvt_pk_bf16_f32 v98, v68, v69
    v_cvt_pk_bf16_f32 v99, v70, v71
    buffer_store_dwordx4 v[96:99], v152, s[24:27], s46 offen sc1
    s_waitcnt vmcnt(7)
    v_permlane16_swap_b32 v154, v156
    v_permlane16_swap_b32 v155, v157
    v_permlane16_swap_b32 v158, v160
    v_permlane16_swap_b32 v159, v161
    s_nop 1
    v_lshlrev_b32 v108, 16, v154
    v_and_b32 v109, 0xffff0000, v154
    v_pk_add_f32 v[0:1], v[0:1], v[108:109]
    v_lshlrev_b32 v108, 16, v155
    v_and_b32 v109, 0xffff0000, v155
    v_pk_add_f32 v[2:3], v[2:3], v[108:109]
    v_lshlrev_b32 v108, 16, v156
    v_and_b32 v109, 0xffff0000, v156
    v_pk_add_f32 v[16:17], v[16:17], v[108:109]
    v_lshlrev_b32 v108, 16, v157
    v_and_b32 v109, 0xffff0000, v157
    v_pk_add_f32 v[18:19], v[18:19], v[108:109]
    v_lshlrev_b32 v108, 16, v158
    v_and_b32 v109, 0xffff0000, v158
    v_pk_add_f32 v[32:33], v[32:33], v[108:109]
    v_lshlrev_b32 v108, 16, v159
    v_and_b32 v109, 0xffff0000, v159
    v_pk_add_f32 v[34:35], v[34:35], v[108:109]
    v_lshlrev_b32 v108, 16, v160
    v_and_b32 v109, 0xffff0000, v160
    v_pk_add_f32 v[48:49], v[48:49], v[108:109]
    v_lshlrev_b32 v108, 16, v161
    v_and_b32 v109, 0xffff0000, v161
    v_pk_add_f32 v[50:51], v[50:51], v[108:109]
    v_lshlrev_b32 v108, 16, v162
    v_and_b32 v109, 0xffff0000, v162
    v_pk_add_f32 v[64:65], v[64:65], v[108:109]
    v_lshlrev_b32 v108, 16, v163
    v_and_b32 v109, 0xffff0000, v163
    v_pk_add_f32 v[66:67], v[66:67], v[108:109]
    v_mov_b32 v110, 1
    s_waitcnt vmcnt(0)
    s_mov_b64 exec, 1
    buffer_store_dword v110, off, s[20:23], s47 sc1
    s_barrier
    s_mov_b64 exec, 0xff
    s_mov_b32 s55, 0x40000
L_sequential_preLN__spectral_fnet__glu_gated_glu__prompt_tagain_10:
    buffer_load_dword v111, v164, s[20:23], s41 offen sc1
    s_waitcnt vmcnt(0)
    v_cmp_ne_u32 vcc, 1, v111
    s_nop 4
    s_cbranch_vccz L_sequential_preLN__spectral_fnet__glu_gated_glu__prompt_tok_9
    s_sub_u32 s55, s55, 1
    s_cbranch_scc1 L_sequential_preLN__spectral_fnet__glu_gated_glu__prompt_tok_9
    s_sleep 2
    s_branch L_sequential_preLN__spectral_fnet__glu_gated_glu__prompt_tagain_10
L_sequential_preLN__spectral_fnet__glu_gated_glu__prompt_tok_9:
    s_mov_b64 exec, -1
    buffer_load_dwordx4 v[112:115], v152, s[24:27], s86 offen sc1
    buffer_load_dwordx4 v[116:119], v152, s[24:27], s86 offen offset:1024 sc1
    buffer_load_dwordx2 v[120:121], v152, s[24:27], s89 offen sc1
    buffer_load_dwordx4 v[122:125], v152, s[24:27], s87 offen sc1
    buffer_load_dwordx4 v[126:129], v152, s[24:27], s87 offen offset:1024 sc1
    buffer_load_dwordx2 v[130:131], v152, s[24:27], s90 offen sc1
    buffer_load_dwordx4 v[132:135], v152, s[24:27], s88 offen sc1
    buffer_load_dwordx4 v[136:139], v152, s[24:27], s88 offen offset:1024 sc1
    buffer_load_dwordx2 v[140:141], v152, s[24:27], s91 offen sc1
    s_sub_u32 s49, s45, 1
    s_cmp_eq_u32 s45, 0
    s_mov_b32 s50, 0x3c800000
    s_cselect_b32 s50, 0x3c4ccccd, s50
    s_waitcnt vmcnt(6)
    v_lshlrev_b32 v108, 16, v112
    v_and_b32 v109, 0xffff0000, v112
    v_pk_add_f32 v[0:1], v[0:1], v[108:109]
    v_lshlrev_b32 v108, 16, v113
    v_and_b32 v109, 0xffff0000, v113
    v_pk_add_f32 v[2:3], v[2:3], v[108:109]
    v_lshlrev_b32 v108, 16, v114
    v_and_b32 v109, 0xffff0000, v114
    v_pk_add_f32 v[16:17], v[16:17], v[108:109]
    v_lshlrev_b32 v108, 16, v115
    v_and_b32 v109, 0xffff0000, v115
    v_pk_add_f32 v[18:19], v[18:19], v[108:109]
    v_lshlrev_b32 v108, 16, v116
    v_and_b32 v109, 0xffff0000, v116
    v_pk_add_f32 v[32:33], v[32:33], v[108:109]
    v_lshlrev_b32 v108, 16, v117
    v_and_b32 v109, 0xffff0000, v117
    v_pk_add_f32 v[34:35], v[34:35], v[108:109]
    v_lshlrev_b32 v108, 16, v118
    v_and_b32 v109, 0xffff0000, v118
    v_pk_add_f32 v[48:49], v[48:49], v[108:109]
    v_lshlrev_b32 v108, 16, v119
    v_and_b32 v109, 0xffff0000, v119
    v_pk_add_f32 v[50:51], v[50:51], v[108:109]
    v_lshlrev_b32 v108, 16, v120
    v_and_b32 v109, 0xffff0000, v120
    v_pk_add_f32 v[64:65], v[64:65], v[108:109]
    v_lshlrev_b32 v108, 16, v121
    v_and_b32 v109, 0xffff0000, v121
    v_pk_add_f32 v[66:67], v[66:67], v[108:109]
    s_waitcnt vmcnt(3)
    v_lshlrev_b32 v108, 16, v122
    v_and_b32 v109, 0xffff0000, v122
    v_pk_add_f32 v[0:1], v[0:1], v[108:109]
    v_lshlrev_b32 v108, 16, v123
    v_and_b32 v109, 0xffff0000, v123
    v_pk_add_f32 v[2:3], v[2:3], v[108:109]
    v_lshlrev_b32 v108, 16, v124
    v_and_b32 v109, 0xffff0000, v124
    v_pk_add_f32 v[16:17], v[16:17], v[108:109]
    v_lshlrev_b32 v108, 16, v125
    v_and_b32 v109, 0xffff0000, v125
    v_pk_add_f32 v[18:19], v[18:19], v[108:109]
    v_lshlrev_b32 v108, 16, v126
    v_and_b32 v109, 0xffff0000, v126
    v_pk_add_f32 v[32:33], v[32:33], v[108:109]
    v_lshlrev_b32 v108, 16, v127
    v_and_b32 v109, 0xffff0000, v127
    v_pk_add_f32 v[34:35], v[34:35], v[108:109]
    v_lshlrev_b32 v108, 16, v128
    v_and_b32 v109, 0xffff0000, v128
    v_pk_add_f32 v[48:49], v[48:49], v[108:109]
    v_lshlrev_b32 v108, 16, v129
    v_and_b32 v109, 0xffff0000, v129
    v_pk_add_f32 v[50:51], v[50:51], v[108:109]
    v_lshlrev_b32 v108, 16, v130
    v_and_b32 v109, 0xffff0000, v130
    v_pk_add_f32 v[64:65], v[64:65], v[108:109]
    v_lshlrev_b32 v108, 16, v131
    v_and_b32 v109, 0xffff0000, v131
    v_pk_add_f32 v[66:67], v[66:67], v[108:109]
    s_waitcnt vmcnt(0)
    v_lshlrev_b32 v108, 16, v132
    v_and_b32 v109, 0xffff0000, v132
    v_pk_add_f32 v[0:1], v[0:1], v[108:109]
    v_lshlrev_b32 v108, 16, v133
    v_and_b32 v109, 0xffff0000, v133
    v_pk_add_f32 v[2:3], v[2:3], v[108:109]
    v_lshlrev_b32 v108, 16, v134
    v_and_b32 v109, 0xffff0000, v134
    v_pk_add_f32 v[16:17], v[16:17], v[108:109]
    v_lshlrev_b32 v108, 16, v135
    v_and_b32 v109, 0xffff0000, v135
    v_pk_add_f32 v[18:19], v[18:19], v[108:109]
    v_lshlrev_b32 v108, 16, v136
    v_and_b32 v109, 0xffff0000, v136
    v_pk_add_f32 v[32:33], v[32:33], v[108:109]
    v_lshlrev_b32 v108, 16, v137
    v_and_b32 v109, 0xffff0000, v137
    v_pk_add_f32 v[34:35], v[34:35], v[108:109]
    v_lshlrev_b32 v108, 16, v138
    v_and_b32 v109, 0xffff0000, v138
    v_pk_add_f32 v[48:49], v[48:49], v[108:109]
    v_lshlrev_b32 v108, 16, v139
    v_and_b32 v109, 0xffff0000, v139
    v_pk_add_f32 v[50:51], v[50:51], v[108:109]
    v_lshlrev_b32 v108, 16, v140
    v_and_b32 v109, 0xffff0000, v140
    v_pk_add_f32 v[64:65], v[64:65], v[108:109]
    v_lshlrev_b32 v108, 16, v141
    v_and_b32 v109, 0xffff0000, v141
    v_pk_add_f32 v[66:67], v[66:67], v[108:109]
    v_cvt_pk_bf16_f32 v72, v0, v1
    v_cvt_pk_bf16_f32 v73, v2, v3
    v_cvt_pk_bf16_f32 v74, v16, v17
    v_cvt_pk_bf16_f32 v75, v18, v19
    v_cvt_pk_bf16_f32 v76, v32, v33
    v_cvt_pk_bf16_f32 v77, v34, v35
    v_cvt_pk_bf16_f32 v78, v48, v49
    v_cvt_pk_bf16_f32 v79, v50, v51
    v_cvt_pk_bf16_f32 v80, v64, v65
    v_cvt_pk_bf16_f32 v81, v66, v67
    v_and_b32 v80, s49, v80
    v_and_b32 v81, s49, v81
    v_lshlrev_b32 v112, 16, v72
    v_and_b32 v113, 0xffff0000, v72
    v_lshlrev_b32 v114, 16, v73
    v_and_b32 v115, 0xffff0000, v73
    v_lshlrev_b32 v116, 16, v74
    v_and_b32 v117, 0xffff0000, v74
    v_lshlrev_b32 v118, 16, v75
    v_and_b32 v119, 0xffff0000, v75
    v_lshlrev_b32 v120, 16, v76
    v_and_b32 v121, 0xffff0000, v76
    v_lshlrev_b32 v122, 16, v77
    v_and_b32 v123, 0xffff0000, v77
    v_lshlrev_b32 v124, 16, v78
    v_and_b32 v125, 0xffff0000, v78
    v_lshlrev_b32 v126, 16, v79
    v_and_b32 v127, 0xffff0000, v79
    v_lshlrev_b32 v128, 16, v80
    v_and_b32 v129, 0xffff0000, v80
    v_lshlrev_b32 v130, 16, v81
    v_and_b32 v131, 0xffff0000, v81
    v_pk_add_f32 v[4:5], v[112:113], v[114:115]
    v_pk_add_f32 v[6:7], v[116:117], v[118:119]
    v_pk_add_f32 v[4:5], v[4:5], v[120:121]
    v_pk_add_f32 v[6:7], v[6:7], v[122:123]
    v_pk_add_f32 v[4:5], v[4:5], v[124:125]
    v_pk_add_f32 v[6:7], v[6:7], v[126:127]
    v_pk_add_f32 v[4:5], v[4:5], v[128:129]
    v_pk_add_f32 v[6:7], v[6:7], v[130:131]
    v_pk_add_f32 v[4:5], v[4:5], v[6:7]
    v_add_f32 v4, v4, v5
    v_mov_b32 v5, v4
    s_nop 1
    v_permlane16_swap_b32 v4, v5
    s_nop 1
    v_add_f32 v4, v4, v5
    v_mov_b32 v5, v4
    s_nop 1
    v_permlane32_swap_b32 v4, v5
    s_nop 1
    v_add_f32 v4, v4, v5
    v_mul_f32 v8, s50, v4
    v_sub_f32 v10, 0, v8
    v_mov_b32 v11, v10
    v_pk_add_f32 v[20:21], v[112:113], v[10:11]
    v_pk_add_f32 v[22:23], v[114:115], v[10:11]
    v_pk_add_f32 v[24:25], v[116:117], v[10:11]
    v_pk_add_f32 v[26:27], v[118:119], v[10:11]
    v_pk_add_f32 v[28:29], v[120:121], v[10:11]
    v_pk_add_f32 v[30:31], v[122:123], v[10:11]
    v_pk_add_f32 v[32:33], v[124:125], v[10:11]
    v_pk_add_f32 v[34:35], v[126:127], v[10:11]
    v_pk_add_f32 v[36:37], v[128:129], v[10:11]
    v_pk_add_f32 v[38:39], v[130:131], v[10:11]
    v_and_b32 v36, s49, v36
    v_and_b32 v37, s49, v37
    v_and_b32 v38, s49, v38
    v_and_b32 v39, s49, v39
    v_pk_mul_f32 v[4:5], v[20:21], v[20:21]
    v_pk_mul_f32 v[6:7], v[22:23], v[22:23]
    v_pk_fma_f32 v[4:5], v[24:25], v[24:25], v[4:5]
    v_pk_fma_f32 v[6:7], v[26:27], v[26:27], v[6:7]
    v_pk_fma_f32 v[4:5], v[28:29], v[28:29], v[4:5]
    v_pk_fma_f32 v[6:7], v[30:31], v[30:31], v[6:7]
    v_pk_fma_f32 v[4:5], v[32:33], v[32:33], v[4:5]
    v_pk_fma_f32 v[6:7], v[34:35], v[34:35], v[6:7]
    v_pk_fma_f32 v[4:5], v[36:37], v[36:37], v[4:5]
    v_pk_fma_f32 v[6:7], v[38:39], v[38:39], v[6:7]
    v_pk_add_f32 v[4:5], v[4:5], v[6:7]
    v_add_f32 v9, v4, v5
    v_mov_b32 v5, v9
    s_nop 1
    v_permlane16_swap_b32 v9, v5
    s_nop 1
    v_add_f32 v9, v9, v5
    v_mov_b32 v5, v9
    s_nop 1
    v_permlane32_swap_b32 v9, v5
    s_nop 1
    v_add_f32 v9, v9, v5
    v_or_b32 v9, 0x80000000, v9
    s_mov_b64 exec, 0xffff
    buffer_store_dwordx2 v[8:9], v165, s[20:23], s83 offen sc1
    s_barrier
    s_mov_b64 exec, -1
    s_mov_b32 s55, 0x40000
L_sequential_preLN__spectral_fnet__glu_gated_glu__prompt_tagain_12:
    buffer_load_dwordx2 v[40:41], v166, s[20:23], s82 offen sc1
    buffer_load_dwordx2 v[42:43], v166, s[20:23], s82 offen offset:128 sc1
    s_waitcnt vmcnt(0)
    v_and_b32 v44, v41, v43
    v_cmp_le_i32 vcc, 0, v44
    s_nop 4
    s_cbranch_vccz L_sequential_preLN__spectral_fnet__glu_gated_glu__prompt_tok_11
    s_sub_u32 s55, s55, 1
    s_cbranch_scc1 L_sequential_preLN__spectral_fnet__glu_gated_glu__prompt_tok_11
    s_sleep 2
    s_branch L_sequential_preLN__spectral_fnet__glu_gated_glu__prompt_tagain_12
L_sequential_preLN__spectral_fnet__glu_gated_glu__prompt_tok_11:
    v_mul_f32 v4, 0x42a00000, v40
    v_fmac_f32 v4, 0x42800000, v42
    v_mov_b32 v5, v4
    s_nop 1
    v_permlane16_swap_b32 v4, v5
    s_nop 1
    v_add_f32 v4, v4, v5
    v_mov_b32 v5, v4
    s_nop 1
    v_permlane32_swap_b32 v4, v5
    s_nop 1
    v_add_f32 v4, v4, v5
    v_mul_f32 v4, 0x3ae38e39, v4
    v_sub_f32 v40, v40, v4
    v_sub_f32 v42, v42, v4
    v_mul_f32 v40, v40, v40
    v_mul_f32 v42, v42, v42
    v_add_f32 v6, abs(v41), abs(v43)
    v_fmac_f32 v6, 0x42a00000, v40
    v_fmac_f32 v6, 0x42800000, v42
    v_mov_b32 v5, v6
    s_nop 1
    v_permlane16_swap_b32 v6, v5
    s_nop 1
    v_add_f32 v6, v6, v5
    v_mov_b32 v5, v6
    s_nop 1
    v_permlane32_swap_b32 v6, v5
    s_nop 1
    v_add_f32 v6, v6, v5
    v_mul_f32 v5, 0x3ae38e39, v6
    v_cvt_pk_bf16_f32 v4, v4, v4
    v_lshlrev_b32 v4, 16, v4
    v_cvt_pk_bf16_f32 v5, v5, v5
    v_lshlrev_b32 v5, 16, v5
    v_add_f32 v5, 0x3727c5ac, v5
    v_cvt_pk_bf16_f32 v5, v5, v5
    v_lshlrev_b32 v5, 16, v5
    v_sqrt_f32 v5, v5
    v_sub_f32 v6, 0, v4
    v_cvt_pk_bf16_f32 v5, v5, v5
    v_lshlrev_b32 v5, 16, v5
    v_rcp_f32 v8, v5
    v_mov_b32 v7, v6
    v_pk_add_f32 v[112:113], v[112:113], v[6:7]
    v_pk_add_f32 v[114:115], v[114:115], v[6:7]
    v_pk_add_f32 v[116:117], v[116:117], v[6:7]
    v_pk_add_f32 v[118:119], v[118:119], v[6:7]
    v_pk_add_f32 v[120:121], v[120:121], v[6:7]
    v_pk_add_f32 v[122:123], v[122:123], v[6:7]
    v_pk_add_f32 v[124:125], v[124:125], v[6:7]
    v_pk_add_f32 v[126:127], v[126:127], v[6:7]
    v_pk_add_f32 v[128:129], v[128:129], v[6:7]
    v_pk_add_f32 v[130:131], v[130:131], v[6:7]
    v_mov_b32 v9, v8
    v_cvt_pk_bf16_f32 v20, v112, v113
    v_cvt_pk_bf16_f32 v21, v114, v115
    v_cvt_pk_bf16_f32 v22, v116, v117
    v_cvt_pk_bf16_f32 v23, v118, v119
    v_cvt_pk_bf16_f32 v24, v120, v121
    v_cvt_pk_bf16_f32 v25, v122, v123
    v_cvt_pk_bf16_f32 v26, v124, v125
    v_cvt_pk_bf16_f32 v27, v126, v127
    v_cvt_pk_bf16_f32 v28, v128, v129
    v_cvt_pk_bf16_f32 v29, v130, v131
    v_lshlrev_b32 v112, 16, v20
    v_and_b32 v113, 0xffff0000, v20
    v_lshlrev_b32 v114, 16, v21
    v_and_b32 v115, 0xffff0000, v21
    v_lshlrev_b32 v116, 16, v22
    v_and_b32 v117, 0xffff0000, v22
    v_lshlrev_b32 v118, 16, v23
    v_and_b32 v119, 0xffff0000, v23
    v_lshlrev_b32 v120, 16, v24
    v_and_b32 v121, 0xffff0000, v24
    v_lshlrev_b32 v122, 16, v25
    v_and_b32 v123, 0xffff0000, v25
    v_lshlrev_b32 v124, 16, v26
    v_and_b32 v125, 0xffff0000, v26
    v_lshlrev_b32 v126, 16, v27
    v_and_b32 v127, 0xffff0000, v27
    v_lshlrev_b32 v128, 16, v28
    v_and_b32 v129, 0xffff0000, v28
    v_lshlrev_b32 v130, 16, v29
    v_and_b32 v131, 0xffff0000, v29
    v_pk_mul_f32 v[112:113], v[112:113], v[8:9]
    v_pk_mul_f32 v[114:115], v[114:115], v[8:9]
    v_pk_mul_f32 v[116:117], v[116:117], v[8:9]
    v_pk_mul_f32 v[118:119], v[118:119], v[8:9]
    v_pk_mul_f32 v[120:121], v[120:121], v[8:9]
    v_pk_mul_f32 v[122:123], v[122:123], v[8:9]
    v_pk_mul_f32 v[124:125], v[124:125], v[8:9]
    v_pk_mul_f32 v[126:127], v[126:127], v[8:9]
    v_pk_mul_f32 v[128:129], v[128:129], v[8:9]
    v_pk_mul_f32 v[130:131], v[130:131], v[8:9]
    v_cvt_pk_bf16_f32 v20, v112, v113
    v_cvt_pk_bf16_f32 v21, v114, v115
    v_cvt_pk_bf16_f32 v22, v116, v117
    v_cvt_pk_bf16_f32 v23, v118, v119
    v_cvt_pk_bf16_f32 v24, v120, v121
    v_cvt_pk_bf16_f32 v25, v122, v123
    v_cvt_pk_bf16_f32 v26, v124, v125
    v_cvt_pk_bf16_f32 v27, v126, v127
    v_cvt_pk_bf16_f32 v28, v128, v129
    v_cvt_pk_bf16_f32 v29, v130, v131
    buffer_store_dwordx4 v[20:23], v152, s[12:15], s80 offen sc1
    buffer_store_dwordx4 v[24:27], v152, s[12:15], s80 offen offset:1024 sc1
    s_cmp_lg_u32 s45, 0
    s_cbranch_scc1 L_k2_nohn
    buffer_store_dwordx2 v[28:29], v152, s[12:15], s81 offen sc1
L_k2_nohn:
    s_waitcnt vmcnt(0)
    s_mov_b64 exec, 1
    buffer_store_dword v110, off, s[20:23], s47 offset:4 sc1
    s_mov_b64 exec, -1
    buffer_store_dwordx4 v[72:75], v152, s[16:19], s80 offen
    buffer_store_dwordx4 v[76:79], v152, s[16:19], s80 offen offset:1024
    s_cmp_lg_u32 s45, 0
    s_cbranch_scc1 L_k2_noh
    buffer_store_dwordx2 v[80:81], v152, s[16:19], s81 offen
L_k2_noh:
    s_branch L_k3_entry
L_k2_loader:
    s_sub_u32 s44, s28, 4
    v_lshrrev_b32 v4, 3, v2
    v_and_b32 v5, 7, v2
    v_xor_b32 v5, v5, v4
    v_lshlrev_b32 v5, 4, v5
    v_lshl_add_u32 v8, v4, 12, v5
    v_add_u32 v9, 31744, v8
    v_add_u32 v10, 65536, v8
    v_add_u32 v11, 97280, v8
    s_lshl_b32 s45, s29, 2
    s_add_u32 s45, s45, s44
    s_lshl_b32 s45, s45, 17
    s_and_b32 s46, s30, 1
    s_lshl_b32 s46, s46, 11
    s_add_u32 s45, s45, s46
    s_lshl_b32 s46, s31, 7
    s_lshl_b32 s47, s30, 5
    s_add_u32 s46, s46, s47
    s_mul_i32 s46, s46, 9216
    s_mul_i32 s47, s44, 4608
    s_add_u32 s46, s46, s47
    s_lshl_b32 s48, s44, 12
    s_lshl_b32 s38, s30, 11
    s_xor_b32 s48, s48, s38
    s_xor_b32 s38, s48, 2048
    s_add_u32 s49, s47, 16384
    s_waitcnt lgkmcnt(0)
    s_cmp_lt_u32 s30, 2
    s_cselect_b32 s16, s12, s14
    s_cselect_b32 s17, s13, s15
    s_mov_b32 s18, 8388608
    s_mov_b32 s19, 0x20000
    s_add_u32 s20, s8, 0x0
    s_addc_u32 s21, s9, 0
    s_mov_b32 s22, 0x480000
    s_mov_b32 s23, 0x20000
    s_mov_b32 s40, -1
    s_mov_b32 s41, 0
    s_mul_i32 s50, s31, 0
    s_add_u32 s42, s31, s29
    s_and_b32 s50, s42, 3
    s_mov_b32 s43, 0
    s_add_u32 s50, s42, 0
    s_and_b32 s50, s50, 3
    s_lshl_b32 s51, s50, 7
    s_add_u32 s66, s51, s45
    s_mul_i32 s53, s50, 18432
    s_add_u32 s67, s53, s46
    s_add_u32 s50, s42, 1
    s_and_b32 s50, s50, 3
    s_lshl_b32 s51, s50, 7
    s_add_u32 s68, s51, s45
    s_mul_i32 s53, s50, 18432
    s_add_u32 s69, s53, s46
    s_add_u32 s50, s42, 2
    s_and_b32 s50, s50, 3
    s_lshl_b32 s51, s50, 7
    s_add_u32 s70, s51, s45
    s_mul_i32 s53, s50, 18432
    s_add_u32 s71, s53, s46
    s_add_u32 s50, s42, 3
    s_and_b32 s50, s50, 3
    s_lshl_b32 s51, s50, 7
    s_add_u32 s72, s51, s45
    s_mul_i32 s53, s50, 18432
    s_add_u32 s73, s53, s46
    s_add_u32 s76, s8, 0x3100000
    s_addc_u32 s77, s9, 0
    s_mov_b32 s78, 0x10000
    s_mov_b32 s79, 0x20000
    v_lshlrev_b32 v30, 7, v2
    v_mov_b32 v31, s96
    s_mul_i32 s74, s30, 6144
    s_mov_b32 m0, s48
    s_mov_b32 s52, 2
    s_barrier
    s_cmp_lg_u32 s28, 4
    s_cbranch_scc1 L_k2_nof
    s_mov_b64 exec, 1
    buffer_store_dword v31, off, s[76:79], s97 sc1
    s_mov_b64 exec, -1
L_k2_nof:
    buffer_load_dwordx4 v8, s[16:19], s66 offen lds
    buffer_load_dwordx4 v9, s[16:19], s66 offen offset:1024 lds
    s_add_u32 m0, s38, 0
    s_nop 0
    buffer_load_dwordx4 v10, s[16:19], s66 offen lds
    buffer_load_dwordx4 v11, s[16:19], s66 offen offset:1024 lds
    s_add_u32 m0, s48, 34816
    s_nop 0
    buffer_load_dwordx4 v8, s[16:19], s68 offen lds
    buffer_load_dwordx4 v9, s[16:19], s68 offen offset:1024 lds
    s_add_u32 m0, s38, 34816
    s_nop 0
    buffer_load_dwordx4 v10, s[16:19], s68 offen lds
    buffer_load_dwordx4 v11, s[16:19], s68 offen offset:1024 lds
    s_add_u32 m0, s48, 69632
    s_nop 0
    buffer_load_dwordx4 v8, s[16:19], s70 offen lds
    buffer_load_dwordx4 v9, s[16:19], s70 offen offset:1024 lds
    s_add_u32 m0, s38, 69632
    s_nop 0
    buffer_load_dwordx4 v10, s[16:19], s70 offen lds
    buffer_load_dwordx4 v11, s[16:19], s70 offen offset:1024 lds
    s_add_u32 m0, s48, 104448
    s_nop 0
    buffer_load_dwordx4 v8, s[16:19], s72 offen lds
    buffer_load_dwordx4 v9, s[16:19], s72 offen offset:1024 lds
    s_add_u32 m0, s38, 104448
    s_nop 0
    buffer_load_dwordx4 v10, s[16:19], s72 offen lds
    buffer_load_dwordx4 v11, s[16:19], s72 offen offset:1024 lds
    s_add_u32 m0, s48, 0
    s_nop 0
    s_cmp_lg_u32 s28, 4
    s_cbranch_scc1 L_k2_nop1
    s_mov_b32 exec_hi, 0xffff
    s_mov_b32 s55, 0x20000
L_sequential_preLN__spectral_fnet__glu_gated_glu__prompt_pagain_14:
    buffer_load_dword v32, v30, s[76:79], s74 offen sc1
    s_waitcnt vmcnt(0)
    v_cmp_ne_u32 vcc, v31, v32
    s_nop 4
    s_cbranch_vccz L_sequential_preLN__spectral_fnet__glu_gated_glu__prompt_pw_15
    s_sleep 2
    s_sub_u32 s55, s55, 1
    s_cbranch_scc0 L_sequential_preLN__spectral_fnet__glu_gated_glu__prompt_pagain_14
L_sequential_preLN__spectral_fnet__glu_gated_glu__prompt_pw_15:
L_sequential_preLN__spectral_fnet__glu_gated_glu__prompt_pok_13:
    s_mov_b64 exec, -1
L_k2_nop1:
    s_barrier
    s_add_u32 m0, s49, 0
    s_mov_b64 exec, s[40:41]
    buffer_load_dwordx4 v3, s[20:23], s67 offen sc1 lds
    s_mov_b64 exec, -1
    s_add_u32 s66, s66, 512
    buffer_load_dwordx4 v3, s[20:23], s67 offen offset:512 sc1 lds
    buffer_load_dwordx4 v3, s[20:23], s67 offen offset:1536 sc1 lds
    buffer_load_dwordx4 v3, s[20:23], s67 offen offset:2560 sc1 lds
    buffer_load_dwordx4 v3, s[20:23], s67 offen offset:3584 sc1 lds
    s_add_u32 s67, s67, 73728
    s_add_u32 m0, s48, 34816
    s_nop 0
    s_add_u32 m0, s49, 34816
    s_mov_b64 exec, s[40:41]
    buffer_load_dwordx4 v3, s[20:23], s69 offen sc1 lds
    s_mov_b64 exec, -1
    s_add_u32 s68, s68, 512
    buffer_load_dwordx4 v3, s[20:23], s69 offen offset:512 sc1 lds
    buffer_load_dwordx4 v3, s[20:23], s69 offen offset:1536 sc1 lds
    buffer_load_dwordx4 v3, s[20:23], s69 offen offset:2560 sc1 lds
    buffer_load_dwordx4 v3, s[20:23], s69 offen offset:3584 sc1 lds
    s_add_u32 s69, s69, 73728
    s_add_u32 m0, s48, 69632
    s_nop 0
    s_waitcnt vmcnt(5)
    s_barrier
    s_add_u32 m0, s49, 69632
    s_mov_b64 exec, s[40:41]
    buffer_load_dwordx4 v3, s[20:23], s71 offen sc1 lds
    s_mov_b64 exec, -1
    s_add_u32 s70, s70, 512
    buffer_load_dwordx4 v3, s[20:23], s71 offen offset:512 sc1 lds
    buffer_load_dwordx4 v3, s[20:23], s71 offen offset:1536 sc1 lds
    buffer_load_dwordx4 v3, s[20:23], s71 offen offset:2560 sc1 lds
    buffer_load_dwordx4 v3, s[20:23], s71 offen offset:3584 sc1 lds
    s_add_u32 s71, s71, 73728
    s_add_u32 m0, s48, 104448
    s_nop 0
    s_add_u32 m0, s49, 104448
    s_mov_b64 exec, s[40:41]
    buffer_load_dwordx4 v3, s[20:23], s73 offen sc1 lds
    s_mov_b64 exec, -1
    s_add_u32 s72, s72, 512
    buffer_load_dwordx4 v3, s[20:23], s73 offen offset:512 sc1 lds
    buffer_load_dwordx4 v3, s[20:23], s73 offen offset:1536 sc1 lds
    buffer_load_dwordx4 v3, s[20:23], s73 offen offset:2560 sc1 lds
    buffer_load_dwordx4 v3, s[20:23], s73 offen offset:3584 sc1 lds
    s_add_u32 s73, s73, 73728
    s_add_u32 m0, s48, 0
    s_nop 0
    s_waitcnt vmcnt(10)
    s_barrier
    buffer_load_dwordx4 v8, s[16:19], s66 offen lds
    buffer_load_dwordx4 v9, s[16:19], s66 offen offset:1024 lds
    s_add_u32 m0, s38, 0
    s_nop 0
    buffer_load_dwordx4 v10, s[16:19], s66 offen lds
    buffer_load_dwordx4 v11, s[16:19], s66 offen offset:1024 lds
    s_add_u32 m0, s49, 0
    s_mov_b64 exec, s[40:41]
    buffer_load_dwordx4 v3, s[20:23], s67 offen sc1 lds
    s_mov_b64 exec, -1
    s_add_u32 s66, s66, 512
    buffer_load_dwordx4 v3, s[20:23], s67 offen offset:512 sc1 lds
    buffer_load_dwordx4 v3, s[20:23], s67 offen offset:1536 sc1 lds
    buffer_load_dwordx4 v3, s[20:23], s67 offen offset:2560 sc1 lds
    buffer_load_dwordx4 v3, s[20:23], s67 offen offset:3584 sc1 lds
    s_add_u32 s67, s67, 73728
    s_add_u32 m0, s48, 34816
    s_nop 0
    s_waitcnt vmcnt(14)
    s_barrier
    buffer_load_dwordx4 v8, s[16:19], s68 offen lds
    buffer_load_dwordx4 v9, s[16:19], s68 offen offset:1024 lds
    s_add_u32 m0, s38, 34816
    s_nop 0
    buffer_load_dwordx4 v10, s[16:19], s68 offen lds
    buffer_load_dwordx4 v11, s[16:19], s68 offen offset:1024 lds
    s_add_u32 m0, s49, 34816
    s_mov_b64 exec, s[40:41]
    buffer_load_dwordx4 v3, s[20:23], s69 offen sc1 lds
    s_mov_b64 exec, -1
    s_add_u32 s68, s68, 512
    buffer_load_dwordx4 v3, s[20:23], s69 offen offset:512 sc1 lds
    buffer_load_dwordx4 v3, s[20:23], s69 offen offset:1536 sc1 lds
    buffer_load_dwordx4 v3, s[20:23], s69 offen offset:2560 sc1 lds
    buffer_load_dwordx4 v3, s[20:23], s69 offen offset:3584 sc1 lds
    s_add_u32 s69, s69, 73728
    s_add_u32 m0, s48, 69632
    s_nop 0
    s_waitcnt vmcnt(18)
    s_barrier
    buffer_load_dwordx4 v8, s[16:19], s70 offen lds
    buffer_load_dwordx4 v9, s[16:19], s70 offen offset:1024 lds
    s_add_u32 m0, s38, 69632
    s_nop 0
    buffer_load_dwordx4 v10, s[16:19], s70 offen lds
    buffer_load_dwordx4 v11, s[16:19], s70 offen offset:1024 lds
    s_add_u32 m0, s49, 69632
    s_mov_b64 exec, s[40:41]
    buffer_load_dwordx4 v3, s[20:23], s71 offen sc1 lds
    s_mov_b64 exec, -1
    s_add_u32 s70, s70, 512
    buffer_load_dwordx4 v3, s[20:23], s71 offen offset:512 sc1 lds
    buffer_load_dwordx4 v3, s[20:23], s71 offen offset:1536 sc1 lds
    buffer_load_dwordx4 v3, s[20:23], s71 offen offset:2560 sc1 lds
    buffer_load_dwordx4 v3, s[20:23], s71 offen offset:3584 sc1 lds
    s_add_u32 s71, s71, 73728
    s_add_u32 m0, s48, 104448
    s_nop 0
    s_waitcnt vmcnt(18)
    s_barrier
    buffer_load_dwordx4 v8, s[16:19], s72 offen lds
    buffer_load_dwordx4 v9, s[16:19], s72 offen offset:1024 lds
    s_add_u32 m0, s38, 104448
    s_nop 0
    buffer_load_dwordx4 v10, s[16:19], s72 offen lds
    buffer_load_dwordx4 v11, s[16:19], s72 offen offset:1024 lds
    s_add_u32 m0, s49, 104448
    s_mov_b64 exec, s[40:41]
    buffer_load_dwordx4 v3, s[20:23], s73 offen sc1 lds
    s_mov_b64 exec, -1
    s_add_u32 s72, s72, 512
    buffer_load_dwordx4 v3, s[20:23], s73 offen offset:512 sc1 lds
    buffer_load_dwordx4 v3, s[20:23], s73 offen offset:1536 sc1 lds
    buffer_load_dwordx4 v3, s[20:23], s73 offen offset:2560 sc1 lds
    buffer_load_dwordx4 v3, s[20:23], s73 offen offset:3584 sc1 lds
    s_add_u32 s73, s73, 73728
    s_add_u32 m0, s48, 0
    s_nop 0
L_k2_lloop:
    s_waitcnt vmcnt(18)
    s_barrier
    buffer_load_dwordx4 v8, s[16:19], s66 offen lds
    buffer_load_dwordx4 v9, s[16:19], s66 offen offset:1024 lds
    s_add_u32 m0, s38, 0
    s_nop 0
    buffer_load_dwordx4 v10, s[16:19], s66 offen lds
    buffer_load_dwordx4 v11, s[16:19], s66 offen offset:1024 lds
    s_add_u32 m0, s49, 0
    s_mov_b64 exec, s[40:41]
    buffer_load_dwordx4 v3, s[20:23], s67 offen sc1 lds
    s_mov_b64 exec, -1
    s_add_u32 s66, s66, 512
    buffer_load_dwordx4 v3, s[20:23], s67 offen offset:512 sc1 lds
    buffer_load_dwordx4 v3, s[20:23], s67 offen offset:1536 sc1 lds
    buffer_load_dwordx4 v3, s[20:23], s67 offen offset:2560 sc1 lds
    buffer_load_dwordx4 v3, s[20:23], s67 offen offset:3584 sc1 lds
    s_add_u32 s67, s67, 73728
    s_add_u32 m0, s48, 34816
    s_nop 0
    s_waitcnt vmcnt(18)
    s_barrier
    buffer_load_dwordx4 v8, s[16:19], s68 offen lds
    buffer_load_dwordx4 v9, s[16:19], s68 offen offset:1024 lds
    s_add_u32 m0, s38, 34816
    s_nop 0
    buffer_load_dwordx4 v10, s[16:19], s68 offen lds
    buffer_load_dwordx4 v11, s[16:19], s68 offen offset:1024 lds
    s_add_u32 m0, s49, 34816
    s_mov_b64 exec, s[40:41]
    buffer_load_dwordx4 v3, s[20:23], s69 offen sc1 lds
    s_mov_b64 exec, -1
    s_add_u32 s68, s68, 512
    buffer_load_dwordx4 v3, s[20:23], s69 offen offset:512 sc1 lds
    buffer_load_dwordx4 v3, s[20:23], s69 offen offset:1536 sc1 lds
    buffer_load_dwordx4 v3, s[20:23], s69 offen offset:2560 sc1 lds
    buffer_load_dwordx4 v3, s[20:23], s69 offen offset:3584 sc1 lds
    s_add_u32 s69, s69, 73728
    s_add_u32 m0, s48, 69632
    s_nop 0
    s_waitcnt vmcnt(18)
    s_barrier
    buffer_load_dwordx4 v8, s[16:19], s70 offen lds
    buffer_load_dwordx4 v9, s[16:19], s70 offen offset:1024 lds
    s_add_u32 m0, s38, 69632
    s_nop 0
    buffer_load_dwordx4 v10, s[16:19], s70 offen lds
    buffer_load_dwordx4 v11, s[16:19], s70 offen offset:1024 lds
    s_add_u32 m0, s49, 69632
    s_mov_b64 exec, s[40:41]
    buffer_load_dwordx4 v3, s[20:23], s71 offen sc1 lds
    s_mov_b64 exec, -1
    s_add_u32 s70, s70, 512
    buffer_load_dwordx4 v3, s[20:23], s71 offen offset:512 sc1 lds
    buffer_load_dwordx4 v3, s[20:23], s71 offen offset:1536 sc1 lds
    buffer_load_dwordx4 v3, s[20:23], s71 offen offset:2560 sc1 lds
    buffer_load_dwordx4 v3, s[20:23], s71 offen offset:3584 sc1 lds
    s_add_u32 s71, s71, 73728
    s_add_u32 m0, s48, 104448
    s_nop 0
    s_sub_u32 s52, s52, 1
    s_waitcnt vmcnt(18)
    s_barrier
    buffer_load_dwordx4 v8, s[16:19], s72 offen lds
    buffer_load_dwordx4 v9, s[16:19], s72 offen offset:1024 lds
    s_add_u32 m0, s38, 104448
    s_nop 0
    buffer_load_dwordx4 v10, s[16:19], s72 offen lds
    buffer_load_dwordx4 v11, s[16:19], s72 offen offset:1024 lds
    s_add_u32 m0, s49, 104448
    s_mov_b64 exec, s[40:41]
    buffer_load_dwordx4 v3, s[20:23], s73 offen sc1 lds
    s_mov_b64 exec, -1
    s_add_u32 s72, s72, 512
    buffer_load_dwordx4 v3, s[20:23], s73 offen offset:512 sc1 lds
    buffer_load_dwordx4 v3, s[20:23], s73 offen offset:1536 sc1 lds
    buffer_load_dwordx4 v3, s[20:23], s73 offen offset:2560 sc1 lds
    buffer_load_dwordx4 v3, s[20:23], s73 offen offset:3584 sc1 lds
    s_add_u32 s73, s73, 73728
    s_add_u32 m0, s48, 0
    s_nop 0
    s_cmp_lg_u32 s52, 0
    s_cbranch_scc1 L_k2_lloop
    s_mov_b32 s74, 0x8000
    buffer_load_dword v33, v30, s[76:79], s74 offen sc1
    s_and_b32 s90, s3, 1
    s_cmp_eq_u32 s90, 0
    s_cselect_b32 s92, s60, s62
    s_cselect_b32 s93, s61, s63
    s_mov_b32 s94, 5308416
    s_mov_b32 s95, 0x20000
    s_mul_i32 s90, s33, 165888
    s_lshl_b32 s91, s30, 11
    s_add_u32 s90, s90, s91
    s_mul_i32 s91, s44, 36
    v_min_u32 v24, 35, v2
    v_add_u32 v24, s91, v24
    v_lshrrev_b32 v25, 3, v24
    v_mul_u32_u24 v25, 7168, v25
    v_lshl_add_u32 v24, v24, 8, v25
    buffer_load_dword v26, v24, s[92:95], s90 offen offset:0
    s_waitcnt vmcnt(20)
    s_barrier
    s_waitcnt vmcnt(11)
    s_barrier
    s_waitcnt vmcnt(1)
    s_barrier
    s_cmp_lg_u32 s28, 4
    s_cbranch_scc1 L_k2_nop2
    s_mov_b32 s74, 0x8000
    v_cmp_ne_u32 vcc, v31, v33
    s_nop 4
    s_cbranch_vccz L_k2_nop2
    s_mov_b32 s55, 0x20000
L_sequential_preLN__spectral_fnet__glu_gated_glu__prompt_pagain_17:
    buffer_load_dword v32, v30, s[76:79], s74 offen sc1
    s_waitcnt vmcnt(0)
    v_cmp_ne_u32 vcc, v31, v32
    s_nop 4
    s_cbranch_vccz L_sequential_preLN__spectral_fnet__glu_gated_glu__prompt_pw_18
    s_sleep 2
    s_sub_u32 s55, s55, 1
    s_cbranch_scc0 L_sequential_preLN__spectral_fnet__glu_gated_glu__prompt_pagain_17
L_sequential_preLN__spectral_fnet__glu_gated_glu__prompt_pw_18:
L_sequential_preLN__spectral_fnet__glu_gated_glu__prompt_pok_16:
L_k2_nop2:
    s_barrier
    s_branch L_k3_entry
L_k2_end:
    s_endpgm
L_k3_entry:
    s_load_dwordx4 s[12:15], s[0:1], 48
    s_load_dwordx2 s[8:9], s[0:1], 88
    s_load_dwordx2 s[60:61], s[0:1], 64
    v_mbcnt_lo_u32_b32 v2, -1, 0
    v_mbcnt_hi_u32_b32 v2, -1, v2
    s_cmp_lt_u32 s28, 4
    s_cbranch_scc1 L_k3_noct
    s_getpc_b64 s[98:99]
    s_and_b32 s34, s28, 3
    s_lshl_b32 s34, s34, 13
    v_lshl_add_u32 v255, v2, 7, s34
    global_load_dword v255, v255, s[98:99]
L_k3_noct:
    s_and_b32 s3, s2, 7
    s_lshr_b32 s33, s2, 3
    s_and_b32 s29, s3, 1
    s_lshl_b32 s29, s29, 2
    s_and_b32 s34, s33, 3
    s_add_u32 s29, s29, s34
    s_lshr_b32 s30, s3, 1
    s_lshl_b32 s30, s30, 3
    s_lshr_b32 s34, s33, 2
    s_add_u32 s30, s30, s34
    v_lshlrev_b32 v252, 4, v2
    v_lshrrev_b32 v3, 3, v2
    v_mul_u32_u24 v3, 9216, v3
    v_bfe_u32 v4, v2, 1, 2
    v_lshrrev_b32 v5, 4, v2
    v_xor_b32 v4, v4, v5
    v_lshl_add_u32 v3, v4, 5, v3
    v_and_b32 v4, 1, v2
    v_lshl_add_u32 v253, v4, 4, v3
    s_and_b32 s36, s28, 3
    s_lshr_b32 s39, s28, 2
    s_mul_i32 s37, s36, 221184
    s_lshl_b32 s38, s30, 8
    s_add_u32 s37, s37, s38
    s_mul_i32 s40, s39, 12288
    s_mul_i32 s41, s36, 3072
    s_add_u32 s40, s40, s41
    s_lshl_b32 s44, s29, 3
    s_add_u32 s44, s44, s28
    s_mul_i32 s44, s44, 36864
    s_and_b32 s34, s29, 3
    s_mul_i32 s34, s34, 3
    s_lshr_b32 s35, s29, 2
    s_add_u32 s34, s34, s35
    s_lshr_b32 s34, s34, 1
    s_mul_i32 s35, s34, 43
    s_lshr_b32 s35, s35, 8
    s_mul_i32 s35, s35, 6
    s_sub_u32 s34, s34, s35
    s_mul_i32 s35, s34, 884736
    s_add_u32 s80, s35, s37
    s_mul_i32 s35, s34, 3072
    s_add_u32 s86, s35, s44
    s_add_u32 s34, s34, 1
    s_cmp_eq_u32 s34, 6
    s_cselect_b32 s34, 0, s34
    s_mul_i32 s35, s34, 884736
    s_add_u32 s81, s35, s37
    s_mul_i32 s35, s34, 3072
    s_add_u32 s87, s35, s44
    s_add_u32 s34, s34, 1
    s_cmp_eq_u32 s34, 6
    s_cselect_b32 s34, 0, s34
    s_mul_i32 s35, s34, 884736
    s_add_u32 s82, s35, s37
    s_mul_i32 s35, s34, 3072
    s_add_u32 s88, s35, s44
    s_add_u32 s34, s34, 1
    s_cmp_eq_u32 s34, 6
    s_cselect_b32 s34, 0, s34
    s_mul_i32 s35, s34, 884736
    s_add_u32 s83, s35, s37
    s_mul_i32 s35, s34, 3072
    s_add_u32 s89, s35, s44
    s_add_u32 s34, s34, 1
    s_cmp_eq_u32 s34, 6
    s_cselect_b32 s34, 0, s34
    s_mul_i32 s35, s34, 884736
    s_add_u32 s84, s35, s37
    s_mul_i32 s35, s34, 3072
    s_add_u32 s90, s35, s44
    s_add_u32 s34, s34, 1
    s_cmp_eq_u32 s34, 6
    s_cselect_b32 s34, 0, s34
    s_mul_i32 s35, s34, 884736
    s_add_u32 s85, s35, s37
    s_mul_i32 s35, s34, 3072
    s_add_u32 s91, s35, s44
    s_add_u32 s34, s34, 1
    s_cmp_eq_u32 s34, 6
    s_cselect_b32 s34, 0, s34
    v_lshrrev_b32 v3, 2, v2
    v_lshlrev_b32 v3, 7, v3
    v_and_b32 v4, 3, v2
    v_lshl_add_u32 v3, v4, 3, v3
    v_bfe_u32 v4, v2, 3, 2
    v_xor_b32 v5, 0, v4
    v_lshl_add_u32 v248, v5, 5, v3
    v_xor_b32 v5, 1, v4
    v_lshl_add_u32 v249, v5, 5, v3
    v_xor_b32 v5, 2, v4
    v_lshl_add_u32 v250, v5, 5, v3
    v_xor_b32 v5, 3, v4
    v_lshl_add_u32 v251, v5, 5, v3
    s_waitcnt lgkmcnt(0)
    s_cmp_eq_u32 s39, 0
    s_cselect_b32 s16, s12, s14
    s_cselect_b32 s17, s13, s15
    s_mov_b32 s18, 5308416
    s_mov_b32 s19, 0x20000
    s_add_u32 s20, s8, 0x1080000
    s_addc_u32 s21, s9, 0
    s_mov_b32 s22, 0x240000
    s_mov_b32 s23, 0x20000
    s_cmp_lt_u32 s28, 4
    s_cbranch_scc1 L_k3_nopre
    s_mov_b32 s92, s12
    s_mov_b32 s93, s13
    s_mov_b32 s94, 0x510000
    s_mov_b32 s95, 0x20000
    s_barrier
    s_add_u32 m0, s41, 0
    s_add_u32 s45, s80, 0
    buffer_load_dwordx4 v253, s[92:95], s45 offen lds
    s_add_u32 m0, s40, 0
    s_nop 0
    buffer_load_dwordx4 v253, s[16:19], s45 offen lds
    s_add_u32 m0, s41, 1024
    s_add_u32 s45, s80, 73728
    buffer_load_dwordx4 v253, s[92:95], s45 offen lds
    s_add_u32 m0, s40, 1024
    s_nop 0
    buffer_load_dwordx4 v253, s[16:19], s45 offen lds
    s_add_u32 m0, s41, 2048
    s_add_u32 s45, s80, 147456
    buffer_load_dwordx4 v253, s[92:95], s45 offen lds
    s_add_u32 m0, s40, 2048
    s_nop 0
    buffer_load_dwordx4 v253, s[16:19], s45 offen lds
    s_add_u32 m0, s41, 24576
    s_add_u32 s45, s81, 0
    buffer_load_dwordx4 v253, s[92:95], s45 offen lds
    s_add_u32 m0, s40, 24576
    s_nop 0
    buffer_load_dwordx4 v253, s[16:19], s45 offen lds
    s_add_u32 m0, s41, 25600
    s_add_u32 s45, s81, 73728
    buffer_load_dwordx4 v253, s[92:95], s45 offen lds
    s_add_u32 m0, s40, 25600
    s_nop 0
    buffer_load_dwordx4 v253, s[16:19], s45 offen lds
    s_add_u32 m0, s41, 26624
    s_add_u32 s45, s81, 147456
    buffer_load_dwordx4 v253, s[92:95], s45 offen lds
    s_add_u32 m0, s40, 26624
    s_nop 0
    buffer_load_dwordx4 v253, s[16:19], s45 offen lds
    s_add_u32 m0, s41, 49152
    s_add_u32 s45, s82, 0
    buffer_load_dwordx4 v253, s[92:95], s45 offen lds
    s_add_u32 m0, s40, 49152
    s_nop 0
    buffer_load_dwordx4 v253, s[16:19], s45 offen lds
    s_add_u32 m0, s41, 50176
    s_add_u32 s45, s82, 73728
    buffer_load_dwordx4 v253, s[92:95], s45 offen lds
    s_add_u32 m0, s40, 50176
    s_nop 0
    buffer_load_dwordx4 v253, s[16:19], s45 offen lds
    s_add_u32 m0, s41, 51200
    s_add_u32 s45, s82, 147456
    buffer_load_dwordx4 v253, s[92:95], s45 offen lds
    s_add_u32 m0, s40, 51200
    s_nop 0
    buffer_load_dwordx4 v253, s[16:19], s45 offen lds
    s_barrier
    s_add_u32 m0, s41, 73728
    s_add_u32 s45, s83, 0
    buffer_load_dwordx4 v253, s[92:95], s45 offen lds
    s_add_u32 m0, s40, 73728
    s_nop 0
    buffer_load_dwordx4 v253, s[16:19], s45 offen lds
    s_add_u32 m0, s41, 74752
    s_add_u32 s45, s83, 73728
    buffer_load_dwordx4 v253, s[92:95], s45 offen lds
    s_add_u32 m0, s40, 74752
    s_nop 0
    buffer_load_dwordx4 v253, s[16:19], s45 offen lds
    s_add_u32 m0, s41, 75776
    s_add_u32 s45, s83, 147456
    buffer_load_dwordx4 v253, s[92:95], s45 offen lds
    s_add_u32 m0, s40, 75776
    s_nop 0
    buffer_load_dwordx4 v253, s[16:19], s45 offen lds
    s_add_u32 m0, s41, 98304
    s_add_u32 s45, s84, 0
    buffer_load_dwordx4 v253, s[92:95], s45 offen lds
    s_add_u32 m0, s40, 98304
    s_nop 0
    buffer_load_dwordx4 v253, s[16:19], s45 offen lds
    s_add_u32 m0, s41, 99328
    s_add_u32 s45, s84, 73728
    buffer_load_dwordx4 v253, s[92:95], s45 offen lds
    s_add_u32 m0, s40, 99328
    s_nop 0
    buffer_load_dwordx4 v253, s[16:19], s45 offen lds
    s_add_u32 m0, s41, 100352
    s_add_u32 s45, s84, 147456
    buffer_load_dwordx4 v253, s[92:95], s45 offen lds
    s_add_u32 m0, s40, 100352
    s_nop 0
    buffer_load_dwordx4 v253, s[16:19], s45 offen lds
    s_add_u32 m0, s41, 122880
    s_add_u32 s45, s85, 0
    buffer_load_dwordx4 v253, s[92:95], s45 offen lds
    s_add_u32 m0, s40, 122880
    s_nop 0
    buffer_load_dwordx4 v253, s[16:19], s45 offen lds
    s_add_u32 m0, s41, 123904
    s_add_u32 s45, s85, 73728
    buffer_load_dwordx4 v253, s[92:95], s45 offen lds
    s_add_u32 m0, s40, 123904
    s_nop 0
    buffer_load_dwordx4 v253, s[16:19], s45 offen lds
    s_add_u32 m0, s41, 124928
    s_add_u32 s45, s85, 147456
    buffer_load_dwordx4 v253, s[92:95], s45 offen lds
    s_add_u32 m0, s40, 124928
    s_nop 0
    buffer_load_dwordx4 v253, s[16:19], s45 offen lds
L_k3_nopre:
    s_add_u32 s92, s8, 0x3080000
    s_addc_u32 s93, s9, 0
    s_mov_b32 s94, 0x80000
    s_mov_b32 s95, 0x20000
    s_lshl_b32 s46, s29, 1
    s_add_u32 s46, s46, s39
    s_lshl_b32 s46, s46, 13
    s_bfe_u32 s47, s28, 0x10001
    s_lshl_b32 s47, s47, 10
    s_add_u32 s46, s46, s47
    s_add_u32 s46, s46, 196608
    s_and_b32 s47, s28, 1
    s_lshl_b32 s47, s47, 1
    v_bfe_u32 v3, v2, 3, 1
    v_or_b32 v3, s47, v3
    v_and_b32 v4, 1, v2
    v_lshlrev_b32 v5, 1, v4
    v_xor_b32 v3, v3, v5
    v_lshl_add_u32 v3, v3, 1, v4
    v_lshlrev_b32 v3, 7, v3
    v_bfe_u32 v4, v2, 1, 2
    v_lshl_add_u32 v3, v4, 11, v3
    s_barrier
    s_mov_b64 exec, 0xffff
    s_mov_b32 s55, 0x20000
L_sequential_preLN__spectral_fnet__glu_gated_glu__prompt_pagain_20:
    buffer_load_dword v4, v3, s[92:95], s46 offen offset:4 sc1
    s_waitcnt vmcnt(0)
    v_cmp_ne_u32 vcc, 1, v4
    s_nop 4
    s_cbranch_vccz L_sequential_preLN__spectral_fnet__glu_gated_glu__prompt_pw_21
    s_sleep 2
    s_sub_u32 s55, s55, 1
    s_cbranch_scc0 L_sequential_preLN__spectral_fnet__glu_gated_glu__prompt_pagain_20
L_sequential_preLN__spectral_fnet__glu_gated_glu__prompt_pw_21:
L_sequential_preLN__spectral_fnet__glu_gated_glu__prompt_pok_19:
    s_mov_b64 exec, -1
    buffer_load_dwordx4 v[0:3], v252, s[20:23], s86 offen offset:0 sc1
    s_add_u32 s46, s86, 18432
    buffer_load_dwordx4 v[4:7], v252, s[20:23], s46 offen offset:0 sc1
    buffer_load_dwordx4 v[8:11], v252, s[20:23], s86 offen offset:1024 sc1
    s_add_u32 s46, s86, 18432
    buffer_load_dwordx4 v[12:15], v252, s[20:23], s46 offen offset:1024 sc1
    buffer_load_dwordx4 v[16:19], v252, s[20:23], s86 offen offset:2048 sc1
    s_add_u32 s46, s86, 18432
    buffer_load_dwordx4 v[20:23], v252, s[20:23], s46 offen offset:2048 sc1
    s_add_u32 s24, s8, 0x1300000
    s_addc_u32 s25, s9, 0
    s_mov_b32 s26, 0x1200000
    s_mov_b32 s27, 0x20000
    s_lshl_b32 s50, s29, 1
    s_add_u32 s50, s50, s39
    s_mul_i32 s50, s50, 1179648
    s_lshl_b32 s51, s36, 11
    s_add_u32 s50, s50, s51
    s_lshr_b32 s51, s30, 1
    s_lshl_b32 s51, s51, 13
    s_add_u32 s51, s51, s50
    s_and_b32 s52, s30, 1
    s_lshl_b32 s52, s52, 9
    s_add_u32 s51, s51, s52
    s_add_u32 s51, s51, 1048576
    s_lshl_b32 s52, s30, 15
    s_add_u32 s50, s50, s52
    s_mov_b32 s58, 0xbfb8aa3b
    s_cmp_ge_u32 s28, 6
    s_cselect_b32 s53, 2, 0
    s_sub_u32 s53, s28, s53
    s_add_u32 s55, s53, s34
    s_cmp_ge_u32 s55, 6
    s_cselect_b32 s54, 6, 0
    s_sub_u32 s55, s55, s54
    s_mul_i32 s53, s53, 6144
    s_mul_i32 s55, s55, 6144
    s_mul_i32 s54, s30, 36864
    s_add_u32 s54, s54, s55
    s_barrier
    ds_read_b64_tr_b16 v[208:209], v248 offset:0
    ds_read_b64_tr_b16 v[210:211], v248 offset:2048
    ds_read_b64_tr_b16 v[212:213], v248 offset:12288
    ds_read_b64_tr_b16 v[214:215], v248 offset:14336
    ds_read_b64_tr_b16 v[216:217], v249 offset:0
    ds_read_b64_tr_b16 v[218:219], v249 offset:2048
    ds_read_b64_tr_b16 v[220:221], v249 offset:12288
    ds_read_b64_tr_b16 v[222:223], v249 offset:14336
    ds_read_b64_tr_b16 v[224:225], v250 offset:0
    ds_read_b64_tr_b16 v[226:227], v250 offset:2048
    ds_read_b64_tr_b16 v[228:229], v250 offset:12288
    ds_read_b64_tr_b16 v[230:231], v250 offset:14336
    ds_read_b64_tr_b16 v[232:233], v251 offset:0
    ds_read_b64_tr_b16 v[234:235], v251 offset:2048
    s_waitcnt vmcnt(4)
    s_waitcnt lgkmcnt(10)
    v_mfma_f32_16x16x32_bf16 v[144:147], v[208:211], v[0:3], 0
    ds_read_b64_tr_b16 v[236:237], v251 offset:12288
    buffer_load_dwordx4 v[24:27], v252, s[20:23], s87 offen offset:0 sc1
    v_mfma_f32_16x16x32_bf16 v[148:151], v[208:211], v[4:7], 0
    ds_read_b64_tr_b16 v[238:239], v251 offset:14336
    v_mfma_f32_16x16x32_bf16 v[152:155], v[212:215], v[0:3], 0
    ds_read_b64_tr_b16 v[208:209], v248 offset:4096
    v_mfma_f32_16x16x32_bf16 v[156:159], v[212:215], v[4:7], 0
    ds_read_b64_tr_b16 v[210:211], v248 offset:6144
    s_waitcnt lgkmcnt(10)
    v_mfma_f32_16x16x32_bf16 v[160:163], v[216:219], v[0:3], 0
    ds_read_b64_tr_b16 v[212:213], v248 offset:16384
    s_add_u32 s46, s87, 18432
    buffer_load_dwordx4 v[28:31], v252, s[20:23], s46 offen offset:0 sc1
    v_mfma_f32_16x16x32_bf16 v[164:167], v[216:219], v[4:7], 0
    ds_read_b64_tr_b16 v[214:215], v248 offset:18432
    v_mfma_f32_16x16x32_bf16 v[168:171], v[220:223], v[0:3], 0
    ds_read_b64_tr_b16 v[216:217], v249 offset:4096
    v_mfma_f32_16x16x32_bf16 v[172:175], v[220:223], v[4:7], 0
    ds_read_b64_tr_b16 v[218:219], v249 offset:6144
    s_waitcnt lgkmcnt(10)
    v_mfma_f32_16x16x32_bf16 v[176:179], v[224:227], v[0:3], 0
    ds_read_b64_tr_b16 v[220:221], v249 offset:16384
    buffer_load_dwordx4 v[32:35], v252, s[20:23], s87 offen offset:1024 sc1
    v_mfma_f32_16x16x32_bf16 v[180:183], v[224:227], v[4:7], 0
    ds_read_b64_tr_b16 v[222:223], v249 offset:18432
    v_mfma_f32_16x16x32_bf16 v[184:187], v[228:231], v[0:3], 0
    ds_read_b64_tr_b16 v[224:225], v250 offset:4096
    v_mfma_f32_16x16x32_bf16 v[188:191], v[228:231], v[4:7], 0
    ds_read_b64_tr_b16 v[226:227], v250 offset:6144
    s_waitcnt lgkmcnt(10)
    v_mfma_f32_16x16x32_bf16 v[192:195], v[232:235], v[0:3], 0
    ds_read_b64_tr_b16 v[228:229], v250 offset:16384
    s_add_u32 s46, s87, 18432
    buffer_load_dwordx4 v[36:39], v252, s[20:23], s46 offen offset:1024 sc1
    v_mfma_f32_16x16x32_bf16 v[196:199], v[232:235], v[4:7], 0
    ds_read_b64_tr_b16 v[230:231], v250 offset:18432
    v_mfma_f32_16x16x32_bf16 v[200:203], v[236:239], v[0:3], 0
    ds_read_b64_tr_b16 v[232:233], v251 offset:4096
    v_mfma_f32_16x16x32_bf16 v[204:207], v[236:239], v[4:7], 0
    ds_read_b64_tr_b16 v[234:235], v251 offset:6144
    s_waitcnt vmcnt(6)
    s_waitcnt lgkmcnt(10)
    v_mfma_f32_16x16x32_bf16 v[144:147], v[208:211], v[8:11], v[144:147]
    ds_read_b64_tr_b16 v[236:237], v251 offset:16384
    v_mfma_f32_16x16x32_bf16 v[148:151], v[208:211], v[12:15], v[148:151]
    ds_read_b64_tr_b16 v[238:239], v251 offset:18432
    buffer_load_dwordx4 v[40:43], v252, s[20:23], s87 offen offset:2048 sc1
    v_mfma_f32_16x16x32_bf16 v[152:155], v[212:215], v[8:11], v[152:155]
    ds_read_b64_tr_b16 v[208:209], v248 offset:8192
    v_mfma_f32_16x16x32_bf16 v[156:159], v[212:215], v[12:15], v[156:159]
    ds_read_b64_tr_b16 v[210:211], v248 offset:10240
    s_waitcnt lgkmcnt(10)
    v_mfma_f32_16x16x32_bf16 v[160:163], v[216:219], v[8:11], v[160:163]
    ds_read_b64_tr_b16 v[212:213], v248 offset:20480
    v_mfma_f32_16x16x32_bf16 v[164:167], v[216:219], v[12:15], v[164:167]
    ds_read_b64_tr_b16 v[214:215], v248 offset:22528
    s_add_u32 s46, s87, 18432
    buffer_load_dwordx4 v[44:47], v252, s[20:23], s46 offen offset:2048 sc1
    v_mfma_f32_16x16x32_bf16 v[168:171], v[220:223], v[8:11], v[168:171]
    ds_read_b64_tr_b16 v[216:217], v249 offset:8192
    v_mfma_f32_16x16x32_bf16 v[172:175], v[220:223], v[12:15], v[172:175]
    ds_read_b64_tr_b16 v[218:219], v249 offset:10240
    s_waitcnt lgkmcnt(10)
    v_mfma_f32_16x16x32_bf16 v[176:179], v[224:227], v[8:11], v[176:179]
    ds_read_b64_tr_b16 v[220:221], v249 offset:20480
    v_mfma_f32_16x16x32_bf16 v[180:183], v[224:227], v[12:15], v[180:183]
    ds_read_b64_tr_b16 v[222:223], v249 offset:22528
    buffer_load_dwordx4 v[48:51], v252, s[20:23], s88 offen offset:0 sc1
    v_mfma_f32_16x16x32_bf16 v[184:187], v[228:231], v[8:11], v[184:187]
    ds_read_b64_tr_b16 v[224:225], v250 offset:8192
    v_mfma_f32_16x16x32_bf16 v[188:191], v[228:231], v[12:15], v[188:191]
    ds_read_b64_tr_b16 v[226:227], v250 offset:10240
    s_waitcnt lgkmcnt(10)
    v_mfma_f32_16x16x32_bf16 v[192:195], v[232:235], v[8:11], v[192:195]
    ds_read_b64_tr_b16 v[228:229], v250 offset:20480
    v_mfma_f32_16x16x32_bf16 v[196:199], v[232:235], v[12:15], v[196:199]
    ds_read_b64_tr_b16 v[230:231], v250 offset:22528
    s_add_u32 s46, s88, 18432
    buffer_load_dwordx4 v[52:55], v252, s[20:23], s46 offen offset:0 sc1
    v_mfma_f32_16x16x32_bf16 v[200:203], v[236:239], v[8:11], v[200:203]
    ds_read_b64_tr_b16 v[232:233], v251 offset:8192
    v_mfma_f32_16x16x32_bf16 v[204:207], v[236:239], v[12:15], v[204:207]
    ds_read_b64_tr_b16 v[234:235], v251 offset:10240
    s_waitcnt vmcnt(8)
    s_waitcnt lgkmcnt(10)
    v_mfma_f32_16x16x32_bf16 v[144:147], v[208:211], v[16:19], v[144:147]
    ds_read_b64_tr_b16 v[236:237], v251 offset:20480
    v_mfma_f32_16x16x32_bf16 v[148:151], v[208:211], v[20:23], v[148:151]
    ds_read_b64_tr_b16 v[238:239], v251 offset:22528
    v_mfma_f32_16x16x32_bf16 v[152:155], v[212:215], v[16:19], v[152:155]
    ds_read_b64_tr_b16 v[208:209], v248 offset:24576
    buffer_load_dwordx4 v[56:59], v252, s[20:23], s88 offen offset:1024 sc1
    v_mfma_f32_16x16x32_bf16 v[156:159], v[212:215], v[20:23], v[156:159]
    ds_read_b64_tr_b16 v[210:211], v248 offset:26624
    s_waitcnt lgkmcnt(10)
    v_mfma_f32_16x16x32_bf16 v[160:163], v[216:219], v[16:19], v[160:163]
    ds_read_b64_tr_b16 v[212:213], v248 offset:36864
    v_mfma_f32_16x16x32_bf16 v[164:167], v[216:219], v[20:23], v[164:167]
    ds_read_b64_tr_b16 v[214:215], v248 offset:38912
    v_mfma_f32_16x16x32_bf16 v[168:171], v[220:223], v[16:19], v[168:171]
    ds_read_b64_tr_b16 v[216:217], v249 offset:24576
    s_add_u32 s46, s88, 18432
    buffer_load_dwordx4 v[60:63], v252, s[20:23], s46 offen offset:1024 sc1
    v_mfma_f32_16x16x32_bf16 v[172:175], v[220:223], v[20:23], v[172:175]
    ds_read_b64_tr_b16 v[218:219], v249 offset:26624
    s_waitcnt lgkmcnt(10)
    v_mfma_f32_16x16x32_bf16 v[176:179], v[224:227], v[16:19], v[176:179]
    ds_read_b64_tr_b16 v[220:221], v249 offset:36864
    v_mfma_f32_16x16x32_bf16 v[180:183], v[224:227], v[20:23], v[180:183]
    ds_read_b64_tr_b16 v[222:223], v249 offset:38912
    v_mfma_f32_16x16x32_bf16 v[184:187], v[228:231], v[16:19], v[184:187]
    ds_read_b64_tr_b16 v[224:225], v250 offset:24576
    buffer_load_dwordx4 v[64:67], v252, s[20:23], s88 offen offset:2048 sc1
    v_mfma_f32_16x16x32_bf16 v[188:191], v[228:231], v[20:23], v[188:191]
    ds_read_b64_tr_b16 v[226:227], v250 offset:26624
    s_waitcnt lgkmcnt(10)
    v_mfma_f32_16x16x32_bf16 v[192:195], v[232:235], v[16:19], v[192:195]
    ds_read_b64_tr_b16 v[228:229], v250 offset:36864
    v_mfma_f32_16x16x32_bf16 v[196:199], v[232:235], v[20:23], v[196:199]
    ds_read_b64_tr_b16 v[230:231], v250 offset:38912
    v_mfma_f32_16x16x32_bf16 v[200:203], v[236:239], v[16:19], v[200:203]
    ds_read_b64_tr_b16 v[232:233], v251 offset:24576
    s_add_u32 s46, s88, 18432
    buffer_load_dwordx4 v[68:71], v252, s[20:23], s46 offen offset:2048 sc1
    v_mfma_f32_16x16x32_bf16 v[204:207], v[236:239], v[20:23], v[204:207]
    ds_read_b64_tr_b16 v[234:235], v251 offset:26624
    s_waitcnt vmcnt(10)
    s_waitcnt lgkmcnt(10)
    v_mfma_f32_16x16x32_bf16 v[144:147], v[208:211], v[24:27], v[144:147]
    ds_read_b64_tr_b16 v[236:237], v251 offset:36864
    v_mfma_f32_16x16x32_bf16 v[148:151], v[208:211], v[28:31], v[148:151]
    ds_read_b64_tr_b16 v[238:239], v251 offset:38912
    v_mfma_f32_16x16x32_bf16 v[152:155], v[212:215], v[24:27], v[152:155]
    ds_read_b64_tr_b16 v[208:209], v248 offset:28672
    v_mfma_f32_16x16x32_bf16 v[156:159], v[212:215], v[28:31], v[156:159]
    ds_read_b64_tr_b16 v[210:211], v248 offset:30720
    buffer_load_dwordx4 v[72:75], v252, s[20:23], s89 offen offset:0 sc1
    s_waitcnt lgkmcnt(10)
    v_mfma_f32_16x16x32_bf16 v[160:163], v[216:219], v[24:27], v[160:163]
    ds_read_b64_tr_b16 v[212:213], v248 offset:40960
    v_mfma_f32_16x16x32_bf16 v[164:167], v[216:219], v[28:31], v[164:167]
    ds_read_b64_tr_b16 v[214:215], v248 offset:43008
    v_mfma_f32_16x16x32_bf16 v[168:171], v[220:223], v[24:27], v[168:171]
    ds_read_b64_tr_b16 v[216:217], v249 offset:28672
    v_mfma_f32_16x16x32_bf16 v[172:175], v[220:223], v[28:31], v[172:175]
    ds_read_b64_tr_b16 v[218:219], v249 offset:30720
    s_add_u32 s46, s89, 18432
    buffer_load_dwordx4 v[76:79], v252, s[20:23], s46 offen offset:0 sc1
    s_waitcnt lgkmcnt(10)
    v_mfma_f32_16x16x32_bf16 v[176:179], v[224:227], v[24:27], v[176:179]
    ds_read_b64_tr_b16 v[220:221], v249 offset:40960
    v_mfma_f32_16x16x32_bf16 v[180:183], v[224:227], v[28:31], v[180:183]
    ds_read_b64_tr_b16 v[222:223], v249 offset:43008
    v_mfma_f32_16x16x32_bf16 v[184:187], v[228:231], v[24:27], v[184:187]
    ds_read_b64_tr_b16 v[224:225], v250 offset:28672
    v_mfma_f32_16x16x32_bf16 v[188:191], v[228:231], v[28:31], v[188:191]
    ds_read_b64_tr_b16 v[226:227], v250 offset:30720
    buffer_load_dwordx4 v[80:83], v252, s[20:23], s89 offen offset:1024 sc1
    s_waitcnt lgkmcnt(10)
    v_mfma_f32_16x16x32_bf16 v[192:195], v[232:235], v[24:27], v[192:195]
    ds_read_b64_tr_b16 v[228:229], v250 offset:40960
    v_mfma_f32_16x16x32_bf16 v[196:199], v[232:235], v[28:31], v[196:199]
    ds_read_b64_tr_b16 v[230:231], v250 offset:43008
    v_mfma_f32_16x16x32_bf16 v[200:203], v[236:239], v[24:27], v[200:203]
    ds_read_b64_tr_b16 v[232:233], v251 offset:28672
    v_mfma_f32_16x16x32_bf16 v[204:207], v[236:239], v[28:31], v[204:207]
    ds_read_b64_tr_b16 v[234:235], v251 offset:30720
    s_waitcnt vmcnt(11)
    s_waitcnt lgkmcnt(10)
    v_mfma_f32_16x16x32_bf16 v[144:147], v[208:211], v[32:35], v[144:147]
    ds_read_b64_tr_b16 v[236:237], v251 offset:40960
    s_add_u32 s46, s89, 18432
    buffer_load_dwordx4 v[84:87], v252, s[20:23], s46 offen offset:1024 sc1
    v_mfma_f32_16x16x32_bf16 v[148:151], v[208:211], v[36:39], v[148:151]
    ds_read_b64_tr_b16 v[238:239], v251 offset:43008
    v_mfma_f32_16x16x32_bf16 v[152:155], v[212:215], v[32:35], v[152:155]
    ds_read_b64_tr_b16 v[208:209], v248 offset:32768
    v_mfma_f32_16x16x32_bf16 v[156:159], v[212:215], v[36:39], v[156:159]
    ds_read_b64_tr_b16 v[210:211], v248 offset:34816
    s_waitcnt lgkmcnt(10)
    v_mfma_f32_16x16x32_bf16 v[160:163], v[216:219], v[32:35], v[160:163]
    ds_read_b64_tr_b16 v[212:213], v248 offset:45056
    buffer_load_dwordx4 v[88:91], v252, s[20:23], s89 offen offset:2048 sc1
    v_mfma_f32_16x16x32_bf16 v[164:167], v[216:219], v[36:39], v[164:167]
    ds_read_b64_tr_b16 v[214:215], v248 offset:47104
    v_mfma_f32_16x16x32_bf16 v[168:171], v[220:223], v[32:35], v[168:171]
    ds_read_b64_tr_b16 v[216:217], v249 offset:32768
    v_mfma_f32_16x16x32_bf16 v[172:175], v[220:223], v[36:39], v[172:175]
    ds_read_b64_tr_b16 v[218:219], v249 offset:34816
    s_waitcnt lgkmcnt(10)
    v_mfma_f32_16x16x32_bf16 v[176:179], v[224:227], v[32:35], v[176:179]
    ds_read_b64_tr_b16 v[220:221], v249 offset:45056
    s_add_u32 s46, s89, 18432
    buffer_load_dwordx4 v[92:95], v252, s[20:23], s46 offen offset:2048 sc1
    v_mfma_f32_16x16x32_bf16 v[180:183], v[224:227], v[36:39], v[180:183]
    ds_read_b64_tr_b16 v[222:223], v249 offset:47104
    v_mfma_f32_16x16x32_bf16 v[184:187], v[228:231], v[32:35], v[184:187]
    ds_read_b64_tr_b16 v[224:225], v250 offset:32768
    v_mfma_f32_16x16x32_bf16 v[188:191], v[228:231], v[36:39], v[188:191]
    ds_read_b64_tr_b16 v[226:227], v250 offset:34816
    s_waitcnt lgkmcnt(10)
    v_mfma_f32_16x16x32_bf16 v[192:195], v[232:235], v[32:35], v[192:195]
    ds_read_b64_tr_b16 v[228:229], v250 offset:45056
    buffer_load_dwordx4 v[96:99], v252, s[20:23], s90 offen offset:0 sc1
    v_mfma_f32_16x16x32_bf16 v[196:199], v[232:235], v[36:39], v[196:199]
    ds_read_b64_tr_b16 v[230:231], v250 offset:47104
    v_mfma_f32_16x16x32_bf16 v[200:203], v[236:239], v[32:35], v[200:203]
    ds_read_b64_tr_b16 v[232:233], v251 offset:32768
    v_mfma_f32_16x16x32_bf16 v[204:207], v[236:239], v[36:39], v[204:207]
    ds_read_b64_tr_b16 v[234:235], v251 offset:34816
    s_waitcnt vmcnt(13)
    s_waitcnt lgkmcnt(10)
    v_mfma_f32_16x16x32_bf16 v[144:147], v[208:211], v[40:43], v[144:147]
    ds_read_b64_tr_b16 v[236:237], v251 offset:45056
    v_mfma_f32_16x16x32_bf16 v[148:151], v[208:211], v[44:47], v[148:151]
    ds_read_b64_tr_b16 v[238:239], v251 offset:47104
    s_add_u32 s46, s90, 18432
    buffer_load_dwordx4 v[100:103], v252, s[20:23], s46 offen offset:0 sc1
    v_add_u32 v248, 0xc000, v248
    v_mfma_f32_16x16x32_bf16 v[152:155], v[212:215], v[40:43], v[152:155]
    ds_read_b64_tr_b16 v[208:209], v248 offset:0
    v_mfma_f32_16x16x32_bf16 v[156:159], v[212:215], v[44:47], v[156:159]
    ds_read_b64_tr_b16 v[210:211], v248 offset:2048
    s_waitcnt lgkmcnt(10)
    v_mfma_f32_16x16x32_bf16 v[160:163], v[216:219], v[40:43], v[160:163]
    ds_read_b64_tr_b16 v[212:213], v248 offset:12288
    v_mfma_f32_16x16x32_bf16 v[164:167], v[216:219], v[44:47], v[164:167]
    ds_read_b64_tr_b16 v[214:215], v248 offset:14336
    buffer_load_dwordx4 v[104:107], v252, s[20:23], s90 offen offset:1024 sc1
    v_add_u32 v249, 0xc000, v249
    v_mfma_f32_16x16x32_bf16 v[168:171], v[220:223], v[40:43], v[168:171]
    ds_read_b64_tr_b16 v[216:217], v249 offset:0
    v_mfma_f32_16x16x32_bf16 v[172:175], v[220:223], v[44:47], v[172:175]
    ds_read_b64_tr_b16 v[218:219], v249 offset:2048
    s_waitcnt lgkmcnt(10)
    v_mfma_f32_16x16x32_bf16 v[176:179], v[224:227], v[40:43], v[176:179]
    ds_read_b64_tr_b16 v[220:221], v249 offset:12288
    v_mfma_f32_16x16x32_bf16 v[180:183], v[224:227], v[44:47], v[180:183]
    ds_read_b64_tr_b16 v[222:223], v249 offset:14336
    s_add_u32 s46, s90, 18432
    buffer_load_dwordx4 v[108:111], v252, s[20:23], s46 offen offset:1024 sc1
    v_add_u32 v250, 0xc000, v250
    v_mfma_f32_16x16x32_bf16 v[184:187], v[228:231], v[40:43], v[184:187]
    ds_read_b64_tr_b16 v[224:225], v250 offset:0
    v_mfma_f32_16x16x32_bf16 v[188:191], v[228:231], v[44:47], v[188:191]
    ds_read_b64_tr_b16 v[226:227], v250 offset:2048
    s_waitcnt lgkmcnt(10)
    v_mfma_f32_16x16x32_bf16 v[192:195], v[232:235], v[40:43], v[192:195]
    ds_read_b64_tr_b16 v[228:229], v250 offset:12288
    v_mfma_f32_16x16x32_bf16 v[196:199], v[232:235], v[44:47], v[196:199]
    ds_read_b64_tr_b16 v[230:231], v250 offset:14336
    buffer_load_dwordx4 v[112:115], v252, s[20:23], s90 offen offset:2048 sc1
    v_add_u32 v251, 0xc000, v251
    v_mfma_f32_16x16x32_bf16 v[200:203], v[236:239], v[40:43], v[200:203]
    ds_read_b64_tr_b16 v[232:233], v251 offset:0
    v_mfma_f32_16x16x32_bf16 v[204:207], v[236:239], v[44:47], v[204:207]
    ds_read_b64_tr_b16 v[234:235], v251 offset:2048
    s_waitcnt vmcnt(15)
    s_waitcnt lgkmcnt(10)
    v_mfma_f32_16x16x32_bf16 v[144:147], v[208:211], v[48:51], v[144:147]
    ds_read_b64_tr_b16 v[236:237], v251 offset:12288
    v_mfma_f32_16x16x32_bf16 v[148:151], v[208:211], v[52:55], v[148:151]
    ds_read_b64_tr_b16 v[238:239], v251 offset:14336
    v_mfma_f32_16x16x32_bf16 v[152:155], v[212:215], v[48:51], v[152:155]
    ds_read_b64_tr_b16 v[208:209], v248 offset:4096
    s_add_u32 s46, s90, 18432
    buffer_load_dwordx4 v[116:119], v252, s[20:23], s46 offen offset:2048 sc1
    v_mfma_f32_16x16x32_bf16 v[156:159], v[212:215], v[52:55], v[156:159]
    ds_read_b64_tr_b16 v[210:211], v248 offset:6144
    s_waitcnt lgkmcnt(10)
    v_mfma_f32_16x16x32_bf16 v[160:163], v[216:219], v[48:51], v[160:163]
    ds_read_b64_tr_b16 v[212:213], v248 offset:16384
    v_mfma_f32_16x16x32_bf16 v[164:167], v[216:219], v[52:55], v[164:167]
    ds_read_b64_tr_b16 v[214:215], v248 offset:18432
    v_mfma_f32_16x16x32_bf16 v[168:171], v[220:223], v[48:51], v[168:171]
    ds_read_b64_tr_b16 v[216:217], v249 offset:4096
    buffer_load_dwordx4 v[120:123], v252, s[20:23], s91 offen offset:0 sc1
    v_mfma_f32_16x16x32_bf16 v[172:175], v[220:223], v[52:55], v[172:175]
    ds_read_b64_tr_b16 v[218:219], v249 offset:6144
    s_waitcnt lgkmcnt(10)
    v_mfma_f32_16x16x32_bf16 v[176:179], v[224:227], v[48:51], v[176:179]
    ds_read_b64_tr_b16 v[220:221], v249 offset:16384
    v_mfma_f32_16x16x32_bf16 v[180:183], v[224:227], v[52:55], v[180:183]
    ds_read_b64_tr_b16 v[222:223], v249 offset:18432
    v_mfma_f32_16x16x32_bf16 v[184:187], v[228:231], v[48:51], v[184:187]
    ds_read_b64_tr_b16 v[224:225], v250 offset:4096
    s_add_u32 s46, s91, 18432
    buffer_load_dwordx4 v[124:127], v252, s[20:23], s46 offen offset:0 sc1
    v_mfma_f32_16x16x32_bf16 v[188:191], v[228:231], v[52:55], v[188:191]
    ds_read_b64_tr_b16 v[226:227], v250 offset:6144
    s_waitcnt lgkmcnt(10)
    v_mfma_f32_16x16x32_bf16 v[192:195], v[232:235], v[48:51], v[192:195]
    ds_read_b64_tr_b16 v[228:229], v250 offset:16384
    v_mfma_f32_16x16x32_bf16 v[196:199], v[232:235], v[52:55], v[196:199]
    ds_read_b64_tr_b16 v[230:231], v250 offset:18432
    v_mfma_f32_16x16x32_bf16 v[200:203], v[236:239], v[48:51], v[200:203]
    ds_read_b64_tr_b16 v[232:233], v251 offset:4096
    buffer_load_dwordx4 v[128:131], v252, s[20:23], s91 offen offset:1024 sc1
    v_mfma_f32_16x16x32_bf16 v[204:207], v[236:239], v[52:55], v[204:207]
    ds_read_b64_tr_b16 v[234:235], v251 offset:6144
    s_waitcnt vmcnt(17)
    s_waitcnt lgkmcnt(10)
    v_mfma_f32_16x16x32_bf16 v[144:147], v[208:211], v[56:59], v[144:147]
    ds_read_b64_tr_b16 v[236:237], v251 offset:16384
    v_mfma_f32_16x16x32_bf16 v[148:151], v[208:211], v[60:63], v[148:151]
    ds_read_b64_tr_b16 v[238:239], v251 offset:18432
    v_mfma_f32_16x16x32_bf16 v[152:155], v[212:215], v[56:59], v[152:155]
    ds_read_b64_tr_b16 v[208:209], v248 offset:8192
    v_mfma_f32_16x16x32_bf16 v[156:159], v[212:215], v[60:63], v[156:159]
    ds_read_b64_tr_b16 v[210:211], v248 offset:10240
    s_add_u32 s46, s91, 18432
    buffer_load_dwordx4 v[132:135], v252, s[20:23], s46 offen offset:1024 sc1
    s_waitcnt lgkmcnt(10)
    v_mfma_f32_16x16x32_bf16 v[160:163], v[216:219], v[56:59], v[160:163]
    ds_read_b64_tr_b16 v[212:213], v248 offset:20480
    v_mfma_f32_16x16x32_bf16 v[164:167], v[216:219], v[60:63], v[164:167]
    ds_read_b64_tr_b16 v[214:215], v248 offset:22528
    v_mfma_f32_16x16x32_bf16 v[168:171], v[220:223], v[56:59], v[168:171]
    ds_read_b64_tr_b16 v[216:217], v249 offset:8192
    v_mfma_f32_16x16x32_bf16 v[172:175], v[220:223], v[60:63], v[172:175]
    ds_read_b64_tr_b16 v[218:219], v249 offset:10240
    buffer_load_dwordx4 v[136:139], v252, s[20:23], s91 offen offset:2048 sc1
    s_waitcnt lgkmcnt(10)
    v_mfma_f32_16x16x32_bf16 v[176:179], v[224:227], v[56:59], v[176:179]
    ds_read_b64_tr_b16 v[220:221], v249 offset:20480
    v_mfma_f32_16x16x32_bf16 v[180:183], v[224:227], v[60:63], v[180:183]
    ds_read_b64_tr_b16 v[222:223], v249 offset:22528
    v_mfma_f32_16x16x32_bf16 v[184:187], v[228:231], v[56:59], v[184:187]
    ds_read_b64_tr_b16 v[224:225], v250 offset:8192
    v_mfma_f32_16x16x32_bf16 v[188:191], v[228:231], v[60:63], v[188:191]
    ds_read_b64_tr_b16 v[226:227], v250 offset:10240
    s_add_u32 s46, s91, 18432
    buffer_load_dwordx4 v[140:143], v252, s[20:23], s46 offen offset:2048 sc1
    s_waitcnt lgkmcnt(10)
    v_mfma_f32_16x16x32_bf16 v[192:195], v[232:235], v[56:59], v[192:195]
    ds_read_b64_tr_b16 v[228:229], v250 offset:20480
    v_mfma_f32_16x16x32_bf16 v[196:199], v[232:235], v[60:63], v[196:199]
    ds_read_b64_tr_b16 v[230:231], v250 offset:22528
    v_mfma_f32_16x16x32_bf16 v[200:203], v[236:239], v[56:59], v[200:203]
    ds_read_b64_tr_b16 v[232:233], v251 offset:8192
    v_mfma_f32_16x16x32_bf16 v[204:207], v[236:239], v[60:63], v[204:207]
    ds_read_b64_tr_b16 v[234:235], v251 offset:10240
    s_waitcnt vmcnt(18)
    s_waitcnt lgkmcnt(10)
    v_mfma_f32_16x16x32_bf16 v[144:147], v[208:211], v[64:67], v[144:147]
    ds_read_b64_tr_b16 v[236:237], v251 offset:20480
    v_mfma_f32_16x16x32_bf16 v[148:151], v[208:211], v[68:71], v[148:151]
    ds_read_b64_tr_b16 v[238:239], v251 offset:22528
    s_barrier
    v_mfma_f32_16x16x32_bf16 v[152:155], v[212:215], v[64:67], v[152:155]
    ds_read_b64_tr_b16 v[208:209], v248 offset:24576
    v_mfma_f32_16x16x32_bf16 v[156:159], v[212:215], v[68:71], v[156:159]
    ds_read_b64_tr_b16 v[210:211], v248 offset:26624
    s_waitcnt lgkmcnt(10)
    v_mfma_f32_16x16x32_bf16 v[160:163], v[216:219], v[64:67], v[160:163]
    ds_read_b64_tr_b16 v[212:213], v248 offset:36864
    s_add_u32 m0, s40, 0
    s_add_u32 s45, s80, 128
    buffer_load_dwordx4 v253, s[16:19], s45 offen lds
    v_mfma_f32_16x16x32_bf16 v[164:167], v[216:219], v[68:71], v[164:167]
    ds_read_b64_tr_b16 v[214:215], v248 offset:38912
    v_mfma_f32_16x16x32_bf16 v[168:171], v[220:223], v[64:67], v[168:171]
    ds_read_b64_tr_b16 v[216:217], v249 offset:24576
    v_mfma_f32_16x16x32_bf16 v[172:175], v[220:223], v[68:71], v[172:175]
    ds_read_b64_tr_b16 v[218:219], v249 offset:26624
    s_waitcnt lgkmcnt(10)
    v_mfma_f32_16x16x32_bf16 v[176:179], v[224:227], v[64:67], v[176:179]
    ds_read_b64_tr_b16 v[220:221], v249 offset:36864
    v_mfma_f32_16x16x32_bf16 v[180:183], v[224:227], v[68:71], v[180:183]
    ds_read_b64_tr_b16 v[222:223], v249 offset:38912
    v_mfma_f32_16x16x32_bf16 v[184:187], v[228:231], v[64:67], v[184:187]
    ds_read_b64_tr_b16 v[224:225], v250 offset:24576
    v_mfma_f32_16x16x32_bf16 v[188:191], v[228:231], v[68:71], v[188:191]
    ds_read_b64_tr_b16 v[226:227], v250 offset:26624
    s_waitcnt lgkmcnt(10)
    v_mfma_f32_16x16x32_bf16 v[192:195], v[232:235], v[64:67], v[192:195]
    ds_read_b64_tr_b16 v[228:229], v250 offset:36864
    v_mfma_f32_16x16x32_bf16 v[196:199], v[232:235], v[68:71], v[196:199]
    ds_read_b64_tr_b16 v[230:231], v250 offset:38912
    v_mfma_f32_16x16x32_bf16 v[200:203], v[236:239], v[64:67], v[200:203]
    ds_read_b64_tr_b16 v[232:233], v251 offset:24576
    s_add_u32 m0, s40, 1024
    s_add_u32 s45, s80, 73856
    buffer_load_dwordx4 v253, s[16:19], s45 offen lds
    v_mfma_f32_16x16x32_bf16 v[204:207], v[236:239], v[68:71], v[204:207]
    ds_read_b64_tr_b16 v[234:235], v251 offset:26624
    s_waitcnt vmcnt(18)
    s_waitcnt lgkmcnt(10)
    v_mfma_f32_16x16x32_bf16 v[144:147], v[208:211], v[72:75], v[144:147]
    ds_read_b64_tr_b16 v[236:237], v251 offset:36864
    v_mfma_f32_16x16x32_bf16 v[148:151], v[208:211], v[76:79], v[148:151]
    ds_read_b64_tr_b16 v[238:239], v251 offset:38912
    v_mfma_f32_16x16x32_bf16 v[152:155], v[212:215], v[72:75], v[152:155]
    ds_read_b64_tr_b16 v[208:209], v248 offset:28672
    v_mfma_f32_16x16x32_bf16 v[156:159], v[212:215], v[76:79], v[156:159]
    ds_read_b64_tr_b16 v[210:211], v248 offset:30720
    s_waitcnt lgkmcnt(10)
    v_mfma_f32_16x16x32_bf16 v[160:163], v[216:219], v[72:75], v[160:163]
    ds_read_b64_tr_b16 v[212:213], v248 offset:40960
    v_mfma_f32_16x16x32_bf16 v[164:167], v[216:219], v[76:79], v[164:167]
    ds_read_b64_tr_b16 v[214:215], v248 offset:43008
    v_mfma_f32_16x16x32_bf16 v[168:171], v[220:223], v[72:75], v[168:171]
    ds_read_b64_tr_b16 v[216:217], v249 offset:28672
    v_mfma_f32_16x16x32_bf16 v[172:175], v[220:223], v[76:79], v[172:175]
    ds_read_b64_tr_b16 v[218:219], v249 offset:30720
    s_waitcnt lgkmcnt(10)
    v_mfma_f32_16x16x32_bf16 v[176:179], v[224:227], v[72:75], v[176:179]
    ds_read_b64_tr_b16 v[220:221], v249 offset:40960
    s_add_u32 m0, s40, 2048
    s_add_u32 s45, s80, 147584
    buffer_load_dwordx4 v253, s[16:19], s45 offen lds
    v_mfma_f32_16x16x32_bf16 v[180:183], v[224:227], v[76:79], v[180:183]
    ds_read_b64_tr_b16 v[222:223], v249 offset:43008
    v_mfma_f32_16x16x32_bf16 v[184:187], v[228:231], v[72:75], v[184:187]
    ds_read_b64_tr_b16 v[224:225], v250 offset:28672
    v_mfma_f32_16x16x32_bf16 v[188:191], v[228:231], v[76:79], v[188:191]
    ds_read_b64_tr_b16 v[226:227], v250 offset:30720
    s_waitcnt lgkmcnt(10)
    v_mfma_f32_16x16x32_bf16 v[192:195], v[232:235], v[72:75], v[192:195]
    ds_read_b64_tr_b16 v[228:229], v250 offset:40960
    v_mfma_f32_16x16x32_bf16 v[196:199], v[232:235], v[76:79], v[196:199]
    ds_read_b64_tr_b16 v[230:231], v250 offset:43008
    v_mfma_f32_16x16x32_bf16 v[200:203], v[236:239], v[72:75], v[200:203]
    ds_read_b64_tr_b16 v[232:233], v251 offset:28672
    v_mfma_f32_16x16x32_bf16 v[204:207], v[236:239], v[76:79], v[204:207]
    ds_read_b64_tr_b16 v[234:235], v251 offset:30720
    s_waitcnt vmcnt(17)
    s_waitcnt lgkmcnt(10)
    v_mfma_f32_16x16x32_bf16 v[144:147], v[208:211], v[80:83], v[144:147]
    ds_read_b64_tr_b16 v[236:237], v251 offset:40960
    v_mfma_f32_16x16x32_bf16 v[148:151], v[208:211], v[84:87], v[148:151]
    ds_read_b64_tr_b16 v[238:239], v251 offset:43008
    v_mfma_f32_16x16x32_bf16 v[152:155], v[212:215], v[80:83], v[152:155]
    ds_read_b64_tr_b16 v[208:209], v248 offset:32768
    s_add_u32 m0, s40, 24576
    s_add_u32 s45, s81, 128
    buffer_load_dwordx4 v253, s[16:19], s45 offen lds
    v_mfma_f32_16x16x32_bf16 v[156:159], v[212:215], v[84:87], v[156:159]
    ds_read_b64_tr_b16 v[210:211], v248 offset:34816
    s_waitcnt lgkmcnt(10)
    v_mfma_f32_16x16x32_bf16 v[160:163], v[216:219], v[80:83], v[160:163]
    ds_read_b64_tr_b16 v[212:213], v248 offset:45056
    v_mfma_f32_16x16x32_bf16 v[164:167], v[216:219], v[84:87], v[164:167]
    ds_read_b64_tr_b16 v[214:215], v248 offset:47104
    v_mfma_f32_16x16x32_bf16 v[168:171], v[220:223], v[80:83], v[168:171]
    ds_read_b64_tr_b16 v[216:217], v249 offset:32768
    v_mfma_f32_16x16x32_bf16 v[172:175], v[220:223], v[84:87], v[172:175]
    ds_read_b64_tr_b16 v[218:219], v249 offset:34816
    s_waitcnt lgkmcnt(10)
    v_mfma_f32_16x16x32_bf16 v[176:179], v[224:227], v[80:83], v[176:179]
    ds_read_b64_tr_b16 v[220:221], v249 offset:45056
    v_mfma_f32_16x16x32_bf16 v[180:183], v[224:227], v[84:87], v[180:183]
    ds_read_b64_tr_b16 v[222:223], v249 offset:47104
    v_mfma_f32_16x16x32_bf16 v[184:187], v[228:231], v[80:83], v[184:187]
    ds_read_b64_tr_b16 v[224:225], v250 offset:32768
    v_mfma_f32_16x16x32_bf16 v[188:191], v[228:231], v[84:87], v[188:191]
    ds_read_b64_tr_b16 v[226:227], v250 offset:34816
    s_waitcnt lgkmcnt(10)
    v_mfma_f32_16x16x32_bf16 v[192:195], v[232:235], v[80:83], v[192:195]
    ds_read_b64_tr_b16 v[228:229], v250 offset:45056
    s_add_u32 m0, s40, 25600
    s_add_u32 s45, s81, 73856
    buffer_load_dwordx4 v253, s[16:19], s45 offen lds
    v_mfma_f32_16x16x32_bf16 v[196:199], v[232:235], v[84:87], v[196:199]
    ds_read_b64_tr_b16 v[230:231], v250 offset:47104
    v_mfma_f32_16x16x32_bf16 v[200:203], v[236:239], v[80:83], v[200:203]
    ds_read_b64_tr_b16 v[232:233], v251 offset:32768
    v_mfma_f32_16x16x32_bf16 v[204:207], v[236:239], v[84:87], v[204:207]
    ds_read_b64_tr_b16 v[234:235], v251 offset:34816
    s_waitcnt vmcnt(17)
    s_waitcnt lgkmcnt(10)
    v_mfma_f32_16x16x32_bf16 v[144:147], v[208:211], v[88:91], v[144:147]
    ds_read_b64_tr_b16 v[236:237], v251 offset:45056
    v_mfma_f32_16x16x32_bf16 v[148:151], v[208:211], v[92:95], v[148:151]
    ds_read_b64_tr_b16 v[238:239], v251 offset:47104
    v_add_u32 v248, 0xc000, v248
    v_mfma_f32_16x16x32_bf16 v[152:155], v[212:215], v[88:91], v[152:155]
    ds_read_b64_tr_b16 v[208:209], v248 offset:0
    v_mfma_f32_16x16x32_bf16 v[156:159], v[212:215], v[92:95], v[156:159]
    ds_read_b64_tr_b16 v[210:211], v248 offset:2048
    s_waitcnt lgkmcnt(10)
    v_mfma_f32_16x16x32_bf16 v[160:163], v[216:219], v[88:91], v[160:163]
    ds_read_b64_tr_b16 v[212:213], v248 offset:12288
    v_mfma_f32_16x16x32_bf16 v[164:167], v[216:219], v[92:95], v[164:167]
    ds_read_b64_tr_b16 v[214:215], v248 offset:14336
    v_add_u32 v249, 0xc000, v249
    v_mfma_f32_16x16x32_bf16 v[168:171], v[220:223], v[88:91], v[168:171]
    ds_read_b64_tr_b16 v[216:217], v249 offset:0
    s_add_u32 m0, s40, 26624
    s_add_u32 s45, s81, 147584
    buffer_load_dwordx4 v253, s[16:19], s45 offen lds
    v_mfma_f32_16x16x32_bf16 v[172:175], v[220:223], v[92:95], v[172:175]
    ds_read_b64_tr_b16 v[218:219], v249 offset:2048
    s_waitcnt lgkmcnt(10)
    v_mfma_f32_16x16x32_bf16 v[176:179], v[224:227], v[88:91], v[176:179]
    ds_read_b64_tr_b16 v[220:221], v249 offset:12288
    v_mfma_f32_16x16x32_bf16 v[180:183], v[224:227], v[92:95], v[180:183]
    ds_read_b64_tr_b16 v[222:223], v249 offset:14336
    v_add_u32 v250, 0xc000, v250
    v_mfma_f32_16x16x32_bf16 v[184:187], v[228:231], v[88:91], v[184:187]
    ds_read_b64_tr_b16 v[224:225], v250 offset:0
    v_mfma_f32_16x16x32_bf16 v[188:191], v[228:231], v[92:95], v[188:191]
    ds_read_b64_tr_b16 v[226:227], v250 offset:2048
    s_waitcnt lgkmcnt(10)
    v_mfma_f32_16x16x32_bf16 v[192:195], v[232:235], v[88:91], v[192:195]
    ds_read_b64_tr_b16 v[228:229], v250 offset:12288
    v_mfma_f32_16x16x32_bf16 v[196:199], v[232:235], v[92:95], v[196:199]
    ds_read_b64_tr_b16 v[230:231], v250 offset:14336
    v_add_u32 v251, 0xc000, v251
    v_mfma_f32_16x16x32_bf16 v[200:203], v[236:239], v[88:91], v[200:203]
    ds_read_b64_tr_b16 v[232:233], v251 offset:0
    v_mfma_f32_16x16x32_bf16 v[204:207], v[236:239], v[92:95], v[204:207]
    ds_read_b64_tr_b16 v[234:235], v251 offset:2048
    s_waitcnt vmcnt(16)
    s_waitcnt lgkmcnt(10)
    v_mfma_f32_16x16x32_bf16 v[144:147], v[208:211], v[96:99], v[144:147]
    ds_read_b64_tr_b16 v[236:237], v251 offset:12288
    v_mfma_f32_16x16x32_bf16 v[148:151], v[208:211], v[100:103], v[148:151]
    ds_read_b64_tr_b16 v[238:239], v251 offset:14336
    v_mfma_f32_16x16x32_bf16 v[152:155], v[212:215], v[96:99], v[152:155]
    ds_read_b64_tr_b16 v[208:209], v248 offset:4096
    v_mfma_f32_16x16x32_bf16 v[156:159], v[212:215], v[100:103], v[156:159]
    ds_read_b64_tr_b16 v[210:211], v248 offset:6144
    s_waitcnt lgkmcnt(10)
    v_mfma_f32_16x16x32_bf16 v[160:163], v[216:219], v[96:99], v[160:163]
    ds_read_b64_tr_b16 v[212:213], v248 offset:16384
    v_mfma_f32_16x16x32_bf16 v[164:167], v[216:219], v[100:103], v[164:167]
    ds_read_b64_tr_b16 v[214:215], v248 offset:18432
    v_mfma_f32_16x16x32_bf16 v[168:171], v[220:223], v[96:99], v[168:171]
    ds_read_b64_tr_b16 v[216:217], v249 offset:4096
    v_mfma_f32_16x16x32_bf16 v[172:175], v[220:223], v[100:103], v[172:175]
    ds_read_b64_tr_b16 v[218:219], v249 offset:6144
    s_waitcnt lgkmcnt(10)
    v_mfma_f32_16x16x32_bf16 v[176:179], v[224:227], v[96:99], v[176:179]
    ds_read_b64_tr_b16 v[220:221], v249 offset:16384
    v_mfma_f32_16x16x32_bf16 v[180:183], v[224:227], v[100:103], v[180:183]
    ds_read_b64_tr_b16 v[222:223], v249 offset:18432
    v_mfma_f32_16x16x32_bf16 v[184:187], v[228:231], v[96:99], v[184:187]
    ds_read_b64_tr_b16 v[224:225], v250 offset:4096
    v_mfma_f32_16x16x32_bf16 v[188:191], v[228:231], v[100:103], v[188:191]
    ds_read_b64_tr_b16 v[226:227], v250 offset:6144
    s_waitcnt lgkmcnt(10)
    v_mfma_f32_16x16x32_bf16 v[192:195], v[232:235], v[96:99], v[192:195]
    ds_read_b64_tr_b16 v[228:229], v250 offset:16384
    v_mfma_f32_16x16x32_bf16 v[196:199], v[232:235], v[100:103], v[196:199]
    ds_read_b64_tr_b16 v[230:231], v250 offset:18432
    v_mfma_f32_16x16x32_bf16 v[200:203], v[236:239], v[96:99], v[200:203]
    ds_read_b64_tr_b16 v[232:233], v251 offset:4096
    v_mfma_f32_16x16x32_bf16 v[204:207], v[236:239], v[100:103], v[204:207]
    ds_read_b64_tr_b16 v[234:235], v251 offset:6144
    s_waitcnt vmcnt(14)
    s_waitcnt lgkmcnt(10)
    v_mfma_f32_16x16x32_bf16 v[144:147], v[208:211], v[104:107], v[144:147]
    ds_read_b64_tr_b16 v[236:237], v251 offset:16384
    v_mfma_f32_16x16x32_bf16 v[148:151], v[208:211], v[108:111], v[148:151]
    ds_read_b64_tr_b16 v[238:239], v251 offset:18432
    v_mfma_f32_16x16x32_bf16 v[152:155], v[212:215], v[104:107], v[152:155]
    ds_read_b64_tr_b16 v[208:209], v248 offset:8192
    v_mfma_f32_16x16x32_bf16 v[156:159], v[212:215], v[108:111], v[156:159]
    ds_read_b64_tr_b16 v[210:211], v248 offset:10240
    s_waitcnt lgkmcnt(10)
    v_mfma_f32_16x16x32_bf16 v[160:163], v[216:219], v[104:107], v[160:163]
    ds_read_b64_tr_b16 v[212:213], v248 offset:20480
    v_mfma_f32_16x16x32_bf16 v[164:167], v[216:219], v[108:111], v[164:167]
    ds_read_b64_tr_b16 v[214:215], v248 offset:22528
    v_mfma_f32_16x16x32_bf16 v[168:171], v[220:223], v[104:107], v[168:171]
    ds_read_b64_tr_b16 v[216:217], v249 offset:8192
    v_mfma_f32_16x16x32_bf16 v[172:175], v[220:223], v[108:111], v[172:175]
    ds_read_b64_tr_b16 v[218:219], v249 offset:10240
    s_waitcnt lgkmcnt(10)
    v_mfma_f32_16x16x32_bf16 v[176:179], v[224:227], v[104:107], v[176:179]
    ds_read_b64_tr_b16 v[220:221], v249 offset:20480
    v_mfma_f32_16x16x32_bf16 v[180:183], v[224:227], v[108:111], v[180:183]
    ds_read_b64_tr_b16 v[222:223], v249 offset:22528
    v_mfma_f32_16x16x32_bf16 v[184:187], v[228:231], v[104:107], v[184:187]
    ds_read_b64_tr_b16 v[224:225], v250 offset:8192
    v_mfma_f32_16x16x32_bf16 v[188:191], v[228:231], v[108:111], v[188:191]
    ds_read_b64_tr_b16 v[226:227], v250 offset:10240
    s_waitcnt lgkmcnt(10)
    v_mfma_f32_16x16x32_bf16 v[192:195], v[232:235], v[104:107], v[192:195]
    ds_read_b64_tr_b16 v[228:229], v250 offset:20480
    v_mfma_f32_16x16x32_bf16 v[196:199], v[232:235], v[108:111], v[196:199]
    ds_read_b64_tr_b16 v[230:231], v250 offset:22528
    v_mfma_f32_16x16x32_bf16 v[200:203], v[236:239], v[104:107], v[200:203]
    ds_read_b64_tr_b16 v[232:233], v251 offset:8192
    v_mfma_f32_16x16x32_bf16 v[204:207], v[236:239], v[108:111], v[204:207]
    ds_read_b64_tr_b16 v[234:235], v251 offset:10240
    s_waitcnt vmcnt(12)
    s_waitcnt lgkmcnt(10)
    v_mfma_f32_16x16x32_bf16 v[144:147], v[208:211], v[112:115], v[144:147]
    ds_read_b64_tr_b16 v[236:237], v251 offset:20480
    v_mfma_f32_16x16x32_bf16 v[148:151], v[208:211], v[116:119], v[148:151]
    ds_read_b64_tr_b16 v[238:239], v251 offset:22528
    s_barrier
    v_mfma_f32_16x16x32_bf16 v[152:155], v[212:215], v[112:115], v[152:155]
    ds_read_b64_tr_b16 v[208:209], v248 offset:24576
    v_mfma_f32_16x16x32_bf16 v[156:159], v[212:215], v[116:119], v[156:159]
    ds_read_b64_tr_b16 v[210:211], v248 offset:26624
    s_waitcnt lgkmcnt(10)
    v_mfma_f32_16x16x32_bf16 v[160:163], v[216:219], v[112:115], v[160:163]
    ds_read_b64_tr_b16 v[212:213], v248 offset:36864
    s_add_u32 m0, s40, 49152
    s_add_u32 s45, s82, 128
    buffer_load_dwordx4 v253, s[16:19], s45 offen lds
    v_mfma_f32_16x16x32_bf16 v[164:167], v[216:219], v[116:119], v[164:167]
    ds_read_b64_tr_b16 v[214:215], v248 offset:38912
    v_mfma_f32_16x16x32_bf16 v[168:171], v[220:223], v[112:115], v[168:171]
    ds_read_b64_tr_b16 v[216:217], v248 offset:28672
    v_mfma_f32_16x16x32_bf16 v[172:175], v[220:223], v[116:119], v[172:175]
    ds_read_b64_tr_b16 v[218:219], v248 offset:30720
    s_waitcnt lgkmcnt(10)
    v_mfma_f32_16x16x32_bf16 v[176:179], v[224:227], v[112:115], v[176:179]
    ds_read_b64_tr_b16 v[220:221], v248 offset:40960
    s_add_u32 m0, s40, 50176
    s_add_u32 s45, s82, 73856
    buffer_load_dwordx4 v253, s[16:19], s45 offen lds
    v_mfma_f32_16x16x32_bf16 v[180:183], v[224:227], v[116:119], v[180:183]
    ds_read_b64_tr_b16 v[222:223], v248 offset:43008
    v_mfma_f32_16x16x32_bf16 v[184:187], v[228:231], v[112:115], v[184:187]
    ds_read_b64_tr_b16 v[224:225], v248 offset:32768
    v_mfma_f32_16x16x32_bf16 v[188:191], v[228:231], v[116:119], v[188:191]
    ds_read_b64_tr_b16 v[226:227], v248 offset:34816
    s_waitcnt lgkmcnt(10)
    v_mfma_f32_16x16x32_bf16 v[192:195], v[232:235], v[112:115], v[192:195]
    ds_read_b64_tr_b16 v[228:229], v248 offset:45056
    s_add_u32 m0, s40, 51200
    s_add_u32 s45, s82, 147584
    buffer_load_dwordx4 v253, s[16:19], s45 offen lds
    v_mfma_f32_16x16x32_bf16 v[196:199], v[232:235], v[116:119], v[196:199]
    ds_read_b64_tr_b16 v[230:231], v248 offset:47104
    v_mfma_f32_16x16x32_bf16 v[200:203], v[236:239], v[112:115], v[200:203]
    ds_read_b64_tr_b16 v[232:233], v249 offset:24576
    v_mfma_f32_16x16x32_bf16 v[204:207], v[236:239], v[116:119], v[204:207]
    ds_read_b64_tr_b16 v[234:235], v249 offset:26624
    s_waitcnt vmcnt(13)
    s_waitcnt lgkmcnt(10)
    v_mfma_f32_16x16x32_bf16 v[144:147], v[208:211], v[120:123], v[144:147]
    ds_read_b64_tr_b16 v[236:237], v249 offset:36864
    s_add_u32 m0, s40, 73728
    s_add_u32 s45, s83, 128
    buffer_load_dwordx4 v253, s[16:19], s45 offen lds
    v_mfma_f32_16x16x32_bf16 v[148:151], v[208:211], v[124:127], v[148:151]
    ds_read_b64_tr_b16 v[238:239], v249 offset:38912
    v_mfma_f32_16x16x32_bf16 v[152:155], v[212:215], v[120:123], v[152:155]
    ds_read_b64_tr_b16 v[208:209], v250 offset:24576
    v_mfma_f32_16x16x32_bf16 v[156:159], v[212:215], v[124:127], v[156:159]
    ds_read_b64_tr_b16 v[210:211], v250 offset:26624
    s_waitcnt vmcnt(12)
    s_waitcnt lgkmcnt(10)
    v_mfma_f32_16x16x32_bf16 v[144:147], v[216:219], v[128:131], v[144:147]
    ds_read_b64_tr_b16 v[212:213], v250 offset:36864
    s_add_u32 m0, s40, 74752
    s_add_u32 s45, s83, 73856
    buffer_load_dwordx4 v253, s[16:19], s45 offen lds
    v_mfma_f32_16x16x32_bf16 v[148:151], v[216:219], v[132:135], v[148:151]
    ds_read_b64_tr_b16 v[214:215], v250 offset:38912
    v_mfma_f32_16x16x32_bf16 v[152:155], v[220:223], v[128:131], v[152:155]
    ds_read_b64_tr_b16 v[216:217], v251 offset:24576
    v_mfma_f32_16x16x32_bf16 v[156:159], v[220:223], v[132:135], v[156:159]
    ds_read_b64_tr_b16 v[218:219], v251 offset:26624
    s_waitcnt vmcnt(11)
    s_waitcnt lgkmcnt(10)
    v_mfma_f32_16x16x32_bf16 v[144:147], v[224:227], v[136:139], v[144:147]
    ds_read_b64_tr_b16 v[220:221], v251 offset:36864
    s_add_u32 m0, s40, 75776
    s_add_u32 s45, s83, 147584
    buffer_load_dwordx4 v253, s[16:19], s45 offen lds
    v_mfma_f32_16x16x32_bf16 v[148:151], v[224:227], v[140:143], v[148:151]
    ds_read_b64_tr_b16 v[222:223], v251 offset:38912
    v_mfma_f32_16x16x32_bf16 v[152:155], v[228:231], v[136:139], v[152:155]
    ds_read_b64_tr_b16 v[224:225], v249 offset:28672
    v_mfma_f32_16x16x32_bf16 v[156:159], v[228:231], v[140:143], v[156:159]
    ds_read_b64_tr_b16 v[226:227], v249 offset:30720
    s_waitcnt lgkmcnt(10)
    v_mfma_f32_16x16x32_bf16 v[160:163], v[232:235], v[120:123], v[160:163]
    ds_read_b64_tr_b16 v[228:229], v249 offset:40960
    v_mfma_f32_16x16x32_bf16 v[164:167], v[232:235], v[124:127], v[164:167]
    ds_read_b64_tr_b16 v[230:231], v249 offset:43008
    v_mfma_f32_16x16x32_bf16 v[168:171], v[236:239], v[120:123], v[168:171]
    ds_read_b64_tr_b16 v[232:233], v250 offset:28672
    v_mfma_f32_16x16x32_bf16 v[172:175], v[236:239], v[124:127], v[172:175]
    ds_read_b64_tr_b16 v[234:235], v250 offset:30720
    s_waitcnt lgkmcnt(10)
    v_mfma_f32_16x16x32_bf16 v[176:179], v[208:211], v[120:123], v[176:179]
    ds_read_b64_tr_b16 v[236:237], v250 offset:40960
    ds_read_b64_tr_b16 v[238:239], v250 offset:43008
    v_mfma_f32_16x16x32_bf16 v[180:183], v[208:211], v[124:127], v[180:183]
    v_mul_f32 v144, 0xbfb8aa3b, v144
    v_mul_f32 v145, 0xbfb8aa3b, v145
    v_mul_f32 v146, 0xbfb8aa3b, v146
    v_mul_f32 v147, 0xbfb8aa3b, v147
    v_mfma_f32_16x16x32_bf16 v[184:187], v[212:215], v[120:123], v[184:187]
    ds_read_b64_tr_b16 v[208:209], v251 offset:28672
    ds_read_b64_tr_b16 v[210:211], v251 offset:30720
    v_mfma_f32_16x16x32_bf16 v[188:191], v[212:215], v[124:127], v[188:191]
    v_exp_f32 v144, v144
    v_exp_f32 v145, v145
    s_waitcnt lgkmcnt(10)
    v_mfma_f32_16x16x32_bf16 v[192:195], v[216:219], v[120:123], v[192:195]
    ds_read_b64_tr_b16 v[212:213], v251 offset:40960
    ds_read_b64_tr_b16 v[214:215], v251 offset:43008
    v_mfma_f32_16x16x32_bf16 v[196:199], v[216:219], v[124:127], v[196:199]
    v_exp_f32 v146, v146
    v_exp_f32 v147, v147
    v_mfma_f32_16x16x32_bf16 v[200:203], v[220:223], v[120:123], v[200:203]
    ds_read_b64_tr_b16 v[216:217], v249 offset:32768
    ds_read_b64_tr_b16 v[218:219], v249 offset:34816
    v_mfma_f32_16x16x32_bf16 v[204:207], v[220:223], v[124:127], v[204:207]
    v_add_f32 v144, 1.0, v144
    v_add_f32 v145, 1.0, v145
    v_add_f32 v146, 1.0, v146
    s_waitcnt lgkmcnt(10)
    v_mfma_f32_16x16x32_bf16 v[160:163], v[224:227], v[128:131], v[160:163]
    ds_read_b64_tr_b16 v[220:221], v249 offset:45056
    ds_read_b64_tr_b16 v[222:223], v249 offset:47104
    v_mfma_f32_16x16x32_bf16 v[164:167], v[224:227], v[132:135], v[164:167]
    v_add_f32 v147, 1.0, v147
    v_rcp_f32 v144, v144
    v_rcp_f32 v145, v145
    v_mfma_f32_16x16x32_bf16 v[168:171], v[228:231], v[128:131], v[168:171]
    ds_read_b64_tr_b16 v[224:225], v250 offset:32768
    ds_read_b64_tr_b16 v[226:227], v250 offset:34816
    v_mfma_f32_16x16x32_bf16 v[172:175], v[228:231], v[132:135], v[172:175]
    v_rcp_f32 v146, v146
    v_rcp_f32 v147, v147
    s_waitcnt lgkmcnt(10)
    v_mfma_f32_16x16x32_bf16 v[176:179], v[232:235], v[128:131], v[176:179]
    ds_read_b64_tr_b16 v[228:229], v250 offset:45056
    ds_read_b64_tr_b16 v[230:231], v250 offset:47104
    v_mfma_f32_16x16x32_bf16 v[180:183], v[232:235], v[132:135], v[180:183]
    v_mul_f32 v144, v144, v152
    v_mul_f32 v145, v145, v153
    v_mul_f32 v146, v146, v154
    v_mfma_f32_16x16x32_bf16 v[184:187], v[236:239], v[128:131], v[184:187]
    ds_read_b64_tr_b16 v[232:233], v251 offset:32768
    ds_read_b64_tr_b16 v[234:235], v251 offset:34816
    v_mfma_f32_16x16x32_bf16 v[188:191], v[236:239], v[132:135], v[188:191]
    v_mul_f32 v147, v147, v155
    v_cvt_pk_bf16_f32 v240, v144, v145
    v_cvt_pk_bf16_f32 v241, v146, v147
    s_waitcnt lgkmcnt(10)
    v_mfma_f32_16x16x32_bf16 v[192:195], v[208:211], v[128:131], v[192:195]
    ds_read_b64_tr_b16 v[236:237], v251 offset:45056
    ds_read_b64_tr_b16 v[238:239], v251 offset:47104
    v_mfma_f32_16x16x32_bf16 v[196:199], v[208:211], v[132:135], v[196:199]
    v_mul_f32 v148, 0xbfb8aa3b, v148
    v_mul_f32 v149, 0xbfb8aa3b, v149
    v_mul_f32 v150, 0xbfb8aa3b, v150
    v_mul_f32 v151, 0xbfb8aa3b, v151
    s_waitcnt vmcnt(6)
    s_barrier
    v_add_u32 v248, 0xfffe8000, v248
    v_mfma_f32_16x16x32_bf16 v[200:203], v[212:215], v[128:131], v[200:203]
    ds_read_b64_tr_b16 v[208:209], v248 offset:0
    ds_read_b64_tr_b16 v[210:211], v248 offset:2048
    v_mfma_f32_16x16x32_bf16 v[204:207], v[212:215], v[132:135], v[204:207]
    v_exp_f32 v148, v148
    v_exp_f32 v149, v149
    s_waitcnt lgkmcnt(10)
    v_mfma_f32_16x16x32_bf16 v[160:163], v[216:219], v[136:139], v[160:163]
    ds_read_b64_tr_b16 v[212:213], v248 offset:12288
    ds_read_b64_tr_b16 v[214:215], v248 offset:14336
    s_add_u32 m0, s40, 98304
    s_add_u32 s45, s84, 128
    buffer_load_dwordx4 v253, s[16:19], s45 offen lds
    v_mfma_f32_16x16x32_bf16 v[164:167], v[216:219], v[140:143], v[164:167]
    v_exp_f32 v150, v150
    v_exp_f32 v151, v151
    v_mfma_f32_16x16x32_bf16 v[168:171], v[220:223], v[136:139], v[168:171]
    ds_read_b64_tr_b16 v[216:217], v248 offset:4096
    ds_read_b64_tr_b16 v[218:219], v248 offset:6144
    s_add_u32 m0, s40, 99328
    s_add_u32 s45, s84, 73856
    buffer_load_dwordx4 v253, s[16:19], s45 offen lds
    v_mfma_f32_16x16x32_bf16 v[172:175], v[220:223], v[140:143], v[172:175]
    v_add_f32 v148, 1.0, v148
    v_add_f32 v149, 1.0, v149
    v_add_f32 v150, 1.0, v150
    s_waitcnt lgkmcnt(10)
    v_mfma_f32_16x16x32_bf16 v[176:179], v[224:227], v[136:139], v[176:179]
    ds_read_b64_tr_b16 v[220:221], v248 offset:16384
    ds_read_b64_tr_b16 v[222:223], v248 offset:18432
    v_mfma_f32_16x16x32_bf16 v[180:183], v[224:227], v[140:143], v[180:183]
    s_add_u32 m0, s40, 100352
    s_add_u32 s45, s84, 147584
    buffer_load_dwordx4 v253, s[16:19], s45 offen lds
    v_add_f32 v151, 1.0, v151
    v_rcp_f32 v148, v148
    v_rcp_f32 v149, v149
    v_mfma_f32_16x16x32_bf16 v[184:187], v[228:231], v[136:139], v[184:187]
    ds_read_b64_tr_b16 v[224:225], v248 offset:8192
    ds_read_b64_tr_b16 v[226:227], v248 offset:10240
    v_mfma_f32_16x16x32_bf16 v[188:191], v[228:231], v[140:143], v[188:191]
    v_rcp_f32 v150, v150
    v_rcp_f32 v151, v151
    s_waitcnt lgkmcnt(10)
    v_mfma_f32_16x16x32_bf16 v[192:195], v[232:235], v[136:139], v[192:195]
    ds_read_b64_tr_b16 v[228:229], v248 offset:20480
    ds_read_b64_tr_b16 v[230:231], v248 offset:22528
    v_mfma_f32_16x16x32_bf16 v[196:199], v[232:235], v[140:143], v[196:199]
    v_mul_f32 v148, v148, v156
    v_mul_f32 v149, v149, v157
    v_mul_f32 v150, v150, v158
    v_mfma_f32_16x16x32_bf16 v[200:203], v[236:239], v[136:139], v[200:203]
    ds_read_b64_tr_b16 v[232:233], v248 offset:24576
    ds_read_b64_tr_b16 v[234:235], v248 offset:26624
    v_mfma_f32_16x16x32_bf16 v[204:207], v[236:239], v[140:143], v[204:207]
    v_mul_f32 v151, v151, v159
    v_cvt_pk_bf16_f32 v244, v148, v149
    v_cvt_pk_bf16_f32 v245, v150, v151
    s_waitcnt lgkmcnt(10)
    v_mfma_f32_16x16x32_bf16 v[144:147], v[208:211], v[0:3], 0
    ds_read_b64_tr_b16 v[236:237], v248 offset:36864
    v_mfma_f32_16x16x32_bf16 v[148:151], v[208:211], v[4:7], 0
    ds_read_b64_tr_b16 v[238:239], v248 offset:38912
    v_mfma_f32_16x16x32_bf16 v[152:155], v[212:215], v[0:3], 0
    ds_read_b64_tr_b16 v[208:209], v248 offset:28672
    v_mfma_f32_16x16x32_bf16 v[156:159], v[212:215], v[4:7], 0
    ds_read_b64_tr_b16 v[210:211], v248 offset:30720
    s_waitcnt lgkmcnt(10)
    v_mfma_f32_16x16x32_bf16 v[144:147], v[216:219], v[8:11], v[144:147]
    ds_read_b64_tr_b16 v[212:213], v248 offset:40960
    ds_read_b64_tr_b16 v[214:215], v248 offset:43008
    v_mfma_f32_16x16x32_bf16 v[148:151], v[216:219], v[12:15], v[148:151]
    v_mul_f32 v160, 0xbfb8aa3b, v160
    v_mul_f32 v161, 0xbfb8aa3b, v161
    v_mul_f32 v162, 0xbfb8aa3b, v162
    v_mfma_f32_16x16x32_bf16 v[152:155], v[220:223], v[8:11], v[152:155]
    ds_read_b64_tr_b16 v[216:217], v248 offset:32768
    ds_read_b64_tr_b16 v[218:219], v248 offset:34816
    v_mfma_f32_16x16x32_bf16 v[156:159], v[220:223], v[12:15], v[156:159]
    v_mul_f32 v163, 0xbfb8aa3b, v163
    v_exp_f32 v160, v160
    s_waitcnt lgkmcnt(10)
    v_mfma_f32_16x16x32_bf16 v[144:147], v[224:227], v[16:19], v[144:147]
    ds_read_b64_tr_b16 v[220:221], v248 offset:45056
    ds_read_b64_tr_b16 v[222:223], v248 offset:47104
    v_mfma_f32_16x16x32_bf16 v[148:151], v[224:227], v[20:23], v[148:151]
    v_exp_f32 v161, v161
    v_exp_f32 v162, v162
    s_waitcnt vmcnt(3)
    s_barrier
    v_add_u32 v248, 0xc000, v248
    v_mfma_f32_16x16x32_bf16 v[152:155], v[228:231], v[16:19], v[152:155]
    ds_read_b64_tr_b16 v[224:225], v248 offset:0
    ds_read_b64_tr_b16 v[226:227], v248 offset:2048
    v_mfma_f32_16x16x32_bf16 v[156:159], v[228:231], v[20:23], v[156:159]
    v_exp_f32 v163, v163
    s_add_u32 s6, s8, 0x3080000
    s_addc_u32 s7, s9, 0
    s_waitcnt lgkmcnt(10)
    v_mfma_f32_16x16x32_bf16 v[144:147], v[232:235], v[24:27], v[144:147]
    ds_read_b64_tr_b16 v[228:229], v248 offset:12288
    ds_read_b64_tr_b16 v[230:231], v248 offset:14336
    s_add_u32 m0, s40, 122880
    s_add_u32 s45, s85, 128
    buffer_load_dwordx4 v253, s[16:19], s45 offen lds
    v_mfma_f32_16x16x32_bf16 v[148:151], v[232:235], v[28:31], v[148:151]
    v_add_f32 v160, 1.0, v160
    v_add_f32 v161, 1.0, v161
    v_mfma_f32_16x16x32_bf16 v[152:155], v[236:239], v[24:27], v[152:155]
    ds_read_b64_tr_b16 v[232:233], v248 offset:4096
    ds_read_b64_tr_b16 v[234:235], v248 offset:6144
    s_add_u32 m0, s40, 123904
    s_add_u32 s45, s85, 73856
    buffer_load_dwordx4 v253, s[16:19], s45 offen lds
    v_mfma_f32_16x16x32_bf16 v[156:159], v[236:239], v[28:31], v[156:159]
    v_add_f32 v162, 1.0, v162
    v_add_f32 v163, 1.0, v163
    v_rcp_f32 v160, v160
    s_waitcnt lgkmcnt(10)
    v_mfma_f32_16x16x32_bf16 v[144:147], v[208:211], v[32:35], v[144:147]
    ds_read_b64_tr_b16 v[236:237], v248 offset:16384
    ds_read_b64_tr_b16 v[238:239], v248 offset:18432
    v_mfma_f32_16x16x32_bf16 v[148:151], v[208:211], v[36:39], v[148:151]
    s_add_u32 m0, s40, 124928
    s_add_u32 s45, s85, 147584
    buffer_load_dwordx4 v253, s[16:19], s45 offen lds
    v_rcp_f32 v161, v161
    v_mfma_f32_16x16x32_bf16 v[152:155], v[212:215], v[32:35], v[152:155]
    ds_read_b64_tr_b16 v[208:209], v248 offset:8192
    ds_read_b64_tr_b16 v[210:211], v248 offset:10240
    v_mfma_f32_16x16x32_bf16 v[156:159], v[212:215], v[36:39], v[156:159]
    v_rcp_f32 v162, v162
    v_rcp_f32 v163, v163
    s_waitcnt lgkmcnt(10)
    v_mfma_f32_16x16x32_bf16 v[144:147], v[216:219], v[40:43], v[144:147]
    ds_read_b64_tr_b16 v[212:213], v248 offset:20480
    ds_read_b64_tr_b16 v[214:215], v248 offset:22528
    v_mfma_f32_16x16x32_bf16 v[148:151], v[216:219], v[44:47], v[148:151]
    v_mul_f32 v160, v160, v168
    v_mfma_f32_16x16x32_bf16 v[152:155], v[220:223], v[40:43], v[152:155]
    ds_read_b64_tr_b16 v[216:217], v248 offset:24576
    ds_read_b64_tr_b16 v[218:219], v248 offset:26624
    v_mfma_f32_16x16x32_bf16 v[156:159], v[220:223], v[44:47], v[156:159]
    v_mul_f32 v161, v161, v169
    v_mul_f32 v162, v162, v170
    v_mul_f32 v163, v163, v171
    s_waitcnt lgkmcnt(10)
    v_mfma_f32_16x16x32_bf16 v[144:147], v[224:227], v[48:51], v[144:147]
    ds_read_b64_tr_b16 v[220:221], v248 offset:36864
    ds_read_b64_tr_b16 v[222:223], v248 offset:38912
    v_mfma_f32_16x16x32_bf16 v[148:151], v[224:227], v[52:55], v[148:151]
    v_cvt_pk_bf16_f32 v242, v160, v161
    v_cvt_pk_bf16_f32 v243, v162, v163
    v_mul_f32 v164, 0xbfb8aa3b, v164
    v_mfma_f32_16x16x32_bf16 v[152:155], v[228:231], v[48:51], v[152:155]
    ds_read_b64_tr_b16 v[224:225], v248 offset:28672
    ds_read_b64_tr_b16 v[226:227], v248 offset:30720
    v_mfma_f32_16x16x32_bf16 v[156:159], v[228:231], v[52:55], v[156:159]
    v_mul_f32 v165, 0xbfb8aa3b, v165
    v_mul_f32 v166, 0xbfb8aa3b, v166
    v_mul_f32 v167, 0xbfb8aa3b, v167
    s_waitcnt lgkmcnt(10)
    v_mfma_f32_16x16x32_bf16 v[144:147], v[232:235], v[56:59], v[144:147]
    ds_read_b64_tr_b16 v[228:229], v248 offset:40960
    ds_read_b64_tr_b16 v[230:231], v248 offset:43008
    v_mfma_f32_16x16x32_bf16 v[148:151], v[232:235], v[60:63], v[148:151]
    v_exp_f32 v164, v164
    v_exp_f32 v165, v165
    v_mfma_f32_16x16x32_bf16 v[152:155], v[236:239], v[56:59], v[152:155]
    ds_read_b64_tr_b16 v[232:233], v248 offset:32768
    ds_read_b64_tr_b16 v[234:235], v248 offset:34816
    v_mfma_f32_16x16x32_bf16 v[156:159], v[236:239], v[60:63], v[156:159]
    v_exp_f32 v166, v166
    s_waitcnt lgkmcnt(10)
    v_mfma_f32_16x16x32_bf16 v[144:147], v[208:211], v[64:67], v[144:147]
    ds_read_b64_tr_b16 v[236:237], v248 offset:45056
    ds_read_b64_tr_b16 v[238:239], v248 offset:47104
    v_mfma_f32_16x16x32_bf16 v[148:151], v[208:211], v[68:71], v[148:151]
    v_exp_f32 v167, v167
    v_add_u32 v249, 0xfffe8000, v249
    v_mfma_f32_16x16x32_bf16 v[152:155], v[212:215], v[64:67], v[152:155]
    ds_read_b64_tr_b16 v[208:209], v249 offset:0
    ds_read_b64_tr_b16 v[210:211], v249 offset:2048
    v_mfma_f32_16x16x32_bf16 v[156:159], v[212:215], v[68:71], v[156:159]
    v_add_f32 v164, 1.0, v164
    v_add_f32 v165, 1.0, v165
    v_add_f32 v166, 1.0, v166
    s_waitcnt lgkmcnt(10)
    v_mfma_f32_16x16x32_bf16 v[144:147], v[216:219], v[72:75], v[144:147]
    ds_read_b64_tr_b16 v[212:213], v249 offset:12288
    ds_read_b64_tr_b16 v[214:215], v249 offset:14336
    v_mfma_f32_16x16x32_bf16 v[148:151], v[216:219], v[76:79], v[148:151]
    v_add_f32 v167, 1.0, v167
    v_rcp_f32 v164, v164
    v_mfma_f32_16x16x32_bf16 v[152:155], v[220:223], v[72:75], v[152:155]
    ds_read_b64_tr_b16 v[216:217], v249 offset:4096
    ds_read_b64_tr_b16 v[218:219], v249 offset:6144
    v_mfma_f32_16x16x32_bf16 v[156:159], v[220:223], v[76:79], v[156:159]
    v_rcp_f32 v165, v165
    s_waitcnt lgkmcnt(10)
    v_mfma_f32_16x16x32_bf16 v[144:147], v[224:227], v[80:83], v[144:147]
    ds_read_b64_tr_b16 v[220:221], v249 offset:16384
    ds_read_b64_tr_b16 v[222:223], v249 offset:18432
    v_mfma_f32_16x16x32_bf16 v[148:151], v[224:227], v[84:87], v[148:151]
    v_rcp_f32 v166, v166
    v_rcp_f32 v167, v167
    v_mfma_f32_16x16x32_bf16 v[152:155], v[228:231], v[80:83], v[152:155]
    ds_read_b64_tr_b16 v[224:225], v249 offset:8192
    ds_read_b64_tr_b16 v[226:227], v249 offset:10240
    v_mfma_f32_16x16x32_bf16 v[156:159], v[228:231], v[84:87], v[156:159]
    v_mul_f32 v164, v164, v172
    v_mul_f32 v165, v165, v173
    s_waitcnt lgkmcnt(10)
    v_mfma_f32_16x16x32_bf16 v[144:147], v[232:235], v[88:91], v[144:147]
    ds_read_b64_tr_b16 v[228:229], v249 offset:20480
    ds_read_b64_tr_b16 v[230:231], v249 offset:22528
    v_mfma_f32_16x16x32_bf16 v[148:151], v[232:235], v[92:95], v[148:151]
    v_mul_f32 v166, v166, v174
    v_mul_f32 v167, v167, v175
    v_cvt_pk_bf16_f32 v246, v164, v165
    v_mfma_f32_16x16x32_bf16 v[152:155], v[236:239], v[88:91], v[152:155]
    ds_read_b64_tr_b16 v[232:233], v249 offset:24576
    ds_read_b64_tr_b16 v[234:235], v249 offset:26624
    v_mfma_f32_16x16x32_bf16 v[156:159], v[236:239], v[92:95], v[156:159]
    v_cvt_pk_bf16_f32 v247, v166, v167
    s_add_u32 s46, s50, 0
    buffer_store_dwordx4 v[240:243], v252, s[24:27], s46 offen offset:0 sc1
    buffer_store_dwordx4 v[244:247], v252, s[24:27], s46 offen offset:1024 sc1
    s_waitcnt lgkmcnt(10)
    v_mfma_f32_16x16x32_bf16 v[160:163], v[208:211], v[0:3], 0
    ds_read_b64_tr_b16 v[236:237], v249 offset:36864
    ds_read_b64_tr_b16 v[238:239], v249 offset:38912
    v_mfma_f32_16x16x32_bf16 v[164:167], v[208:211], v[4:7], 0
    v_mul_f32 v176, 0xbfb8aa3b, v176
    v_mul_f32 v177, 0xbfb8aa3b, v177
    v_mul_f32 v178, 0xbfb8aa3b, v178
    s_mov_b32 s92, s60
    s_mov_b32 s93, s61
    s_mov_b32 s94, 0x510000
    s_mov_b32 s95, 0x20000
    s_lshl_b32 s62, s33, 3
    s_add_u32 s62, s62, s28
    s_mul_i32 s62, s62, 36
    s_lshr_b32 s63, s3, 1
    s_mul_i32 s57, s63, 1032192
    s_sub_u32 s57, 3538944, s57
    s_mul_i32 s63, s63, 1179648
    v_lshrrev_b32 v254, 4, v252
    v_min_u32 v254, 35, v254
    v_add_u32 v254, s62, v254
    v_lshrrev_b32 v255, 3, v254
    v_add_lshl_u32 v255, v255, v254, 7
    v_lshrrev_b32 v254, 13, v254
    v_mul_lo_u32 v254, v254, s57
    v_add_u32 v254, v254, v255
    buffer_load_dword v255, v254, s[92:95], s63 offen
    v_mfma_f32_16x16x32_bf16 v[168:171], v[212:215], v[0:3], 0
    ds_read_b64_tr_b16 v[208:209], v249 offset:28672
    ds_read_b64_tr_b16 v[210:211], v249 offset:30720
    v_mfma_f32_16x16x32_bf16 v[172:175], v[212:215], v[4:7], 0
    v_mul_f32 v179, 0xbfb8aa3b, v179
    v_exp_f32 v176, v176
    s_waitcnt lgkmcnt(10)
    v_mfma_f32_16x16x32_bf16 v[160:163], v[216:219], v[8:11], v[160:163]
    ds_read_b64_tr_b16 v[212:213], v249 offset:40960
    ds_read_b64_tr_b16 v[214:215], v249 offset:43008
    v_mfma_f32_16x16x32_bf16 v[164:167], v[216:219], v[12:15], v[164:167]
    v_exp_f32 v177, v177
    v_mfma_f32_16x16x32_bf16 v[168:171], v[220:223], v[8:11], v[168:171]
    ds_read_b64_tr_b16 v[216:217], v249 offset:32768
    ds_read_b64_tr_b16 v[218:219], v249 offset:34816
    v_mfma_f32_16x16x32_bf16 v[172:175], v[220:223], v[12:15], v[172:175]
    v_exp_f32 v178, v178
    s_waitcnt lgkmcnt(10)
    v_mfma_f32_16x16x32_bf16 v[160:163], v[224:227], v[16:19], v[160:163]
    ds_read_b64_tr_b16 v[220:221], v249 offset:45056
    ds_read_b64_tr_b16 v[222:223], v249 offset:47104
    v_mfma_f32_16x16x32_bf16 v[164:167], v[224:227], v[20:23], v[164:167]
    v_exp_f32 v179, v179
    v_add_f32 v176, 1.0, v176
    v_add_u32 v249, 0xc000, v249
    v_mfma_f32_16x16x32_bf16 v[168:171], v[228:231], v[16:19], v[168:171]
    ds_read_b64_tr_b16 v[224:225], v249 offset:0
    ds_read_b64_tr_b16 v[226:227], v249 offset:2048
    v_mfma_f32_16x16x32_bf16 v[172:175], v[228:231], v[20:23], v[172:175]
    v_add_f32 v177, 1.0, v177
    v_add_f32 v178, 1.0, v178
    s_waitcnt lgkmcnt(10)
    v_mfma_f32_16x16x32_bf16 v[160:163], v[232:235], v[24:27], v[160:163]
    ds_read_b64_tr_b16 v[228:229], v249 offset:12288
    ds_read_b64_tr_b16 v[230:231], v249 offset:14336
    v_mfma_f32_16x16x32_bf16 v[164:167], v[232:235], v[28:31], v[164:167]
    v_add_f32 v179, 1.0, v179
    v_rcp_f32 v176, v176
    v_mfma_f32_16x16x32_bf16 v[168:171], v[236:239], v[24:27], v[168:171]
    ds_read_b64_tr_b16 v[232:233], v249 offset:4096
    ds_read_b64_tr_b16 v[234:235], v249 offset:6144
    v_mfma_f32_16x16x32_bf16 v[172:175], v[236:239], v[28:31], v[172:175]
    v_rcp_f32 v177, v177
    s_waitcnt lgkmcnt(10)
    v_mfma_f32_16x16x32_bf16 v[160:163], v[208:211], v[32:35], v[160:163]
    ds_read_b64_tr_b16 v[236:237], v249 offset:16384
    ds_read_b64_tr_b16 v[238:239], v249 offset:18432
    v_mfma_f32_16x16x32_bf16 v[164:167], v[208:211], v[36:39], v[164:167]
    v_rcp_f32 v178, v178
    v_rcp_f32 v179, v179
    v_mfma_f32_16x16x32_bf16 v[168:171], v[212:215], v[32:35], v[168:171]
    ds_read_b64_tr_b16 v[208:209], v249 offset:8192
    ds_read_b64_tr_b16 v[210:211], v249 offset:10240
    v_mfma_f32_16x16x32_bf16 v[172:175], v[212:215], v[36:39], v[172:175]
    v_mul_f32 v176, v176, v184
    s_waitcnt lgkmcnt(10)
    v_mfma_f32_16x16x32_bf16 v[160:163], v[216:219], v[40:43], v[160:163]
    ds_read_b64_tr_b16 v[212:213], v249 offset:20480
    ds_read_b64_tr_b16 v[214:215], v249 offset:22528
    v_mfma_f32_16x16x32_bf16 v[164:167], v[216:219], v[44:47], v[164:167]
    v_mul_f32 v177, v177, v185
    v_mul_f32 v178, v178, v186
    v_mul_f32 v179, v179, v187
    v_mfma_f32_16x16x32_bf16 v[168:171], v[220:223], v[40:43], v[168:171]
    ds_read_b64_tr_b16 v[216:217], v249 offset:24576
    ds_read_b64_tr_b16 v[218:219], v249 offset:26624
    v_mfma_f32_16x16x32_bf16 v[172:175], v[220:223], v[44:47], v[172:175]
    v_cvt_pk_bf16_f32 v240, v176, v177
    v_cvt_pk_bf16_f32 v241, v178, v179
    s_waitcnt lgkmcnt(10)
    v_mfma_f32_16x16x32_bf16 v[160:163], v[224:227], v[48:51], v[160:163]
    ds_read_b64_tr_b16 v[220:221], v249 offset:36864
    ds_read_b64_tr_b16 v[222:223], v249 offset:38912
    v_mfma_f32_16x16x32_bf16 v[164:167], v[224:227], v[52:55], v[164:167]
    v_mul_f32 v180, 0xbfb8aa3b, v180
    v_mul_f32 v181, 0xbfb8aa3b, v181
    v_mul_f32 v182, 0xbfb8aa3b, v182
    v_mfma_f32_16x16x32_bf16 v[168:171], v[228:231], v[48:51], v[168:171]
    ds_read_b64_tr_b16 v[224:225], v249 offset:28672
    ds_read_b64_tr_b16 v[226:227], v249 offset:30720
    v_mfma_f32_16x16x32_bf16 v[172:175], v[228:231], v[52:55], v[172:175]
    v_mul_f32 v183, 0xbfb8aa3b, v183
    v_exp_f32 v180, v180
    s_waitcnt lgkmcnt(10)
    v_mfma_f32_16x16x32_bf16 v[160:163], v[232:235], v[56:59], v[160:163]
    ds_read_b64_tr_b16 v[228:229], v249 offset:40960
    ds_read_b64_tr_b16 v[230:231], v249 offset:43008
    v_mfma_f32_16x16x32_bf16 v[164:167], v[232:235], v[60:63], v[164:167]
    v_exp_f32 v181, v181
    v_mfma_f32_16x16x32_bf16 v[168:171], v[236:239], v[56:59], v[168:171]
    ds_read_b64_tr_b16 v[232:233], v249 offset:32768
    ds_read_b64_tr_b16 v[234:235], v249 offset:34816
    v_mfma_f32_16x16x32_bf16 v[172:175], v[236:239], v[60:63], v[172:175]
    v_exp_f32 v182, v182
    s_waitcnt lgkmcnt(10)
    v_mfma_f32_16x16x32_bf16 v[160:163], v[208:211], v[64:67], v[160:163]
    ds_read_b64_tr_b16 v[236:237], v249 offset:45056
    ds_read_b64_tr_b16 v[238:239], v249 offset:47104
    v_mfma_f32_16x16x32_bf16 v[164:167], v[208:211], v[68:71], v[164:167]
    v_exp_f32 v183, v183
    v_add_f32 v180, 1.0, v180
    s_waitcnt vmcnt(3)
    s_barrier
    v_add_u32 v248, 0xc000, v248
    v_mfma_f32_16x16x32_bf16 v[168:171], v[212:215], v[64:67], v[168:171]
    ds_read_b64_tr_b16 v[208:209], v248 offset:0
    ds_read_b64_tr_b16 v[210:211], v248 offset:2048
    v_mfma_f32_16x16x32_bf16 v[172:175], v[212:215], v[68:71], v[172:175]
    v_add_f32 v181, 1.0, v181
    v_add_f32 v182, 1.0, v182
    s_waitcnt lgkmcnt(10)
    v_mfma_f32_16x16x32_bf16 v[160:163], v[216:219], v[72:75], v[160:163]
    ds_read_b64_tr_b16 v[212:213], v248 offset:12288
    ds_read_b64_tr_b16 v[214:215], v248 offset:14336
    v_mfma_f32_16x16x32_bf16 v[164:167], v[216:219], v[76:79], v[164:167]
    v_add_f32 v183, 1.0, v183
    v_rcp_f32 v180, v180
    v_mfma_f32_16x16x32_bf16 v[168:171], v[220:223], v[72:75], v[168:171]
    ds_read_b64_tr_b16 v[216:217], v248 offset:4096
    ds_read_b64_tr_b16 v[218:219], v248 offset:6144
    v_mfma_f32_16x16x32_bf16 v[172:175], v[220:223], v[76:79], v[172:175]
    v_rcp_f32 v181, v181
    s_waitcnt lgkmcnt(10)
    v_mfma_f32_16x16x32_bf16 v[160:163], v[224:227], v[80:83], v[160:163]
    ds_read_b64_tr_b16 v[220:221], v248 offset:16384
    ds_read_b64_tr_b16 v[222:223], v248 offset:18432
    v_mfma_f32_16x16x32_bf16 v[164:167], v[224:227], v[84:87], v[164:167]
    v_rcp_f32 v182, v182
    v_rcp_f32 v183, v183
    v_mfma_f32_16x16x32_bf16 v[168:171], v[228:231], v[80:83], v[168:171]
    ds_read_b64_tr_b16 v[224:225], v248 offset:8192
    ds_read_b64_tr_b16 v[226:227], v248 offset:10240
    v_mfma_f32_16x16x32_bf16 v[172:175], v[228:231], v[84:87], v[172:175]
    v_mul_f32 v180, v180, v188
    s_waitcnt lgkmcnt(10)
    v_mfma_f32_16x16x32_bf16 v[160:163], v[232:235], v[88:91], v[160:163]
    ds_read_b64_tr_b16 v[228:229], v248 offset:20480
    ds_read_b64_tr_b16 v[230:231], v248 offset:22528
    v_mfma_f32_16x16x32_bf16 v[164:167], v[232:235], v[92:95], v[164:167]
    v_mul_f32 v181, v181, v189
    v_mul_f32 v182, v182, v190
    v_mul_f32 v183, v183, v191
    v_mfma_f32_16x16x32_bf16 v[168:171], v[236:239], v[88:91], v[168:171]
    ds_read_b64_tr_b16 v[232:233], v248 offset:24576
    ds_read_b64_tr_b16 v[234:235], v248 offset:26624
    v_mfma_f32_16x16x32_bf16 v[172:175], v[236:239], v[92:95], v[172:175]
    v_cvt_pk_bf16_f32 v244, v180, v181
    v_cvt_pk_bf16_f32 v245, v182, v183
    s_waitcnt lgkmcnt(10)
    v_mfma_f32_16x16x32_bf16 v[144:147], v[208:211], v[96:99], v[144:147]
    ds_read_b64_tr_b16 v[236:237], v248 offset:36864
    ds_read_b64_tr_b16 v[238:239], v248 offset:38912
    v_mfma_f32_16x16x32_bf16 v[148:151], v[208:211], v[100:103], v[148:151]
    v_mul_f32 v192, 0xbfb8aa3b, v192
    v_mul_f32 v193, 0xbfb8aa3b, v193
    v_mul_f32 v194, 0xbfb8aa3b, v194
    v_mfma_f32_16x16x32_bf16 v[152:155], v[212:215], v[96:99], v[152:155]
    ds_read_b64_tr_b16 v[208:209], v248 offset:28672
    ds_read_b64_tr_b16 v[210:211], v248 offset:30720
    v_mfma_f32_16x16x32_bf16 v[156:159], v[212:215], v[100:103], v[156:159]
    v_mul_f32 v195, 0xbfb8aa3b, v195
    v_exp_f32 v192, v192
    s_waitcnt lgkmcnt(10)
    v_mfma_f32_16x16x32_bf16 v[144:147], v[216:219], v[104:107], v[144:147]
    ds_read_b64_tr_b16 v[212:213], v248 offset:40960
    ds_read_b64_tr_b16 v[214:215], v248 offset:43008
    v_mfma_f32_16x16x32_bf16 v[148:151], v[216:219], v[108:111], v[148:151]
    v_exp_f32 v193, v193
    v_mfma_f32_16x16x32_bf16 v[152:155], v[220:223], v[104:107], v[152:155]
    ds_read_b64_tr_b16 v[216:217], v248 offset:32768
    ds_read_b64_tr_b16 v[218:219], v248 offset:34816
    v_mfma_f32_16x16x32_bf16 v[156:159], v[220:223], v[108:111], v[156:159]
    v_exp_f32 v194, v194
    v_exp_f32 v195, v195
    s_waitcnt lgkmcnt(10)
    v_mfma_f32_16x16x32_bf16 v[144:147], v[224:227], v[112:115], v[144:147]
    ds_read_b64_tr_b16 v[220:221], v248 offset:45056
    ds_read_b64_tr_b16 v[222:223], v248 offset:47104
    v_mfma_f32_16x16x32_bf16 v[148:151], v[224:227], v[116:119], v[148:151]
    v_add_f32 v192, 1.0, v192
    v_add_u32 v249, 0xc000, v249
    v_mfma_f32_16x16x32_bf16 v[152:155], v[228:231], v[112:115], v[152:155]
    ds_read_b64_tr_b16 v[224:225], v249 offset:0
    ds_read_b64_tr_b16 v[226:227], v249 offset:2048
    v_mfma_f32_16x16x32_bf16 v[156:159], v[228:231], v[116:119], v[156:159]
    v_add_f32 v193, 1.0, v193
    v_add_f32 v194, 1.0, v194
    v_add_f32 v195, 1.0, v195
    s_waitcnt lgkmcnt(10)
    v_mfma_f32_16x16x32_bf16 v[144:147], v[232:235], v[120:123], v[144:147]
    ds_read_b64_tr_b16 v[228:229], v249 offset:12288
    ds_read_b64_tr_b16 v[230:231], v249 offset:14336
    v_mfma_f32_16x16x32_bf16 v[148:151], v[232:235], v[124:127], v[148:151]
    v_rcp_f32 v192, v192
    v_mfma_f32_16x16x32_bf16 v[152:155], v[236:239], v[120:123], v[152:155]
    ds_read_b64_tr_b16 v[232:233], v249 offset:4096
    ds_read_b64_tr_b16 v[234:235], v249 offset:6144
    v_mfma_f32_16x16x32_bf16 v[156:159], v[236:239], v[124:127], v[156:159]
    v_rcp_f32 v193, v193
    v_rcp_f32 v194, v194
    s_waitcnt lgkmcnt(10)
    v_mfma_f32_16x16x32_bf16 v[144:147], v[208:211], v[128:131], v[144:147]
    ds_read_b64_tr_b16 v[236:237], v249 offset:16384
    ds_read_b64_tr_b16 v[238:239], v249 offset:18432
    v_mfma_f32_16x16x32_bf16 v[148:151], v[208:211], v[132:135], v[148:151]
    v_rcp_f32 v195, v195
    v_mfma_f32_16x16x32_bf16 v[152:155], v[212:215], v[128:131], v[152:155]
    ds_read_b64_tr_b16 v[208:209], v249 offset:8192
    ds_read_b64_tr_b16 v[210:211], v249 offset:10240
    v_mfma_f32_16x16x32_bf16 v[156:159], v[212:215], v[132:135], v[156:159]
    v_mul_f32 v192, v192, v200
    v_mul_f32 v193, v193, v201
    s_waitcnt lgkmcnt(10)
    v_mfma_f32_16x16x32_bf16 v[144:147], v[216:219], v[136:139], v[144:147]
    ds_read_b64_tr_b16 v[212:213], v249 offset:20480
    ds_read_b64_tr_b16 v[214:215], v249 offset:22528
    v_mfma_f32_16x16x32_bf16 v[148:151], v[216:219], v[140:143], v[148:151]
    v_mul_f32 v194, v194, v202
    v_mul_f32 v195, v195, v203
    v_mfma_f32_16x16x32_bf16 v[152:155], v[220:223], v[136:139], v[152:155]
    ds_read_b64_tr_b16 v[216:217], v249 offset:24576
    ds_read_b64_tr_b16 v[218:219], v249 offset:26624
    v_mfma_f32_16x16x32_bf16 v[156:159], v[220:223], v[140:143], v[156:159]
    v_cvt_pk_bf16_f32 v242, v192, v193
    v_cvt_pk_bf16_f32 v243, v194, v195
    v_mul_f32 v196, 0xbfb8aa3b, v196
    s_add_u32 s20, s8, 0x3080000
    s_addc_u32 s21, s9, 0
    s_mov_b32 s22, 0x80000
    s_mov_b32 s23, 0x20000
    s_lshl_b32 s47, s29, 1
    s_add_u32 s47, s47, s39
    s_lshl_b32 s47, s47, 2
    s_lshr_b32 s48, s30, 3
    s_add_u32 s47, s47, s48
    s_lshl_b32 s47, s47, 7
    s_and_b32 s48, s30, 7
    s_lshl_b32 s48, s48, 2
    s_add_u32 s47, s47, s48
    s_add_u32 s47, s47, s36
    s_waitcnt vmcnt(1)
    v_mov_b32 v254, 1
    s_mov_b64 exec, 1
    buffer_store_byte v254, off, s[20:23], s47 sc1
    s_mov_b64 exec, -1
    s_add_u32 s47, s47, 8192
    s_waitcnt lgkmcnt(10)
    v_mfma_f32_16x16x32_bf16 v[160:163], v[224:227], v[96:99], v[160:163]
    ds_read_b64_tr_b16 v[220:221], v249 offset:36864
    ds_read_b64_tr_b16 v[222:223], v249 offset:38912
    v_mfma_f32_16x16x32_bf16 v[164:167], v[224:227], v[100:103], v[164:167]
    v_mul_f32 v197, 0xbfb8aa3b, v197
    v_mul_f32 v198, 0xbfb8aa3b, v198
    v_mul_f32 v199, 0xbfb8aa3b, v199
    v_mfma_f32_16x16x32_bf16 v[168:171], v[228:231], v[96:99], v[168:171]
    ds_read_b64_tr_b16 v[224:225], v249 offset:28672
    ds_read_b64_tr_b16 v[226:227], v249 offset:30720
    v_mfma_f32_16x16x32_bf16 v[172:175], v[228:231], v[100:103], v[172:175]
    v_exp_f32 v196, v196
    s_waitcnt lgkmcnt(10)
    v_mfma_f32_16x16x32_bf16 v[160:163], v[232:235], v[104:107], v[160:163]
    ds_read_b64_tr_b16 v[228:229], v249 offset:40960
    ds_read_b64_tr_b16 v[230:231], v249 offset:43008
    v_mfma_f32_16x16x32_bf16 v[164:167], v[232:235], v[108:111], v[164:167]
    v_exp_f32 v197, v197
    v_exp_f32 v198, v198
    v_mfma_f32_16x16x32_bf16 v[168:171], v[236:239], v[104:107], v[168:171]
    ds_read_b64_tr_b16 v[232:233], v249 offset:32768
    ds_read_b64_tr_b16 v[234:235], v249 offset:34816
    v_mfma_f32_16x16x32_bf16 v[172:175], v[236:239], v[108:111], v[172:175]
    v_exp_f32 v199, v199
    s_waitcnt lgkmcnt(10)
    v_mfma_f32_16x16x32_bf16 v[160:163], v[208:211], v[112:115], v[160:163]
    ds_read_b64_tr_b16 v[236:237], v249 offset:45056
    ds_read_b64_tr_b16 v[238:239], v249 offset:47104
    v_mfma_f32_16x16x32_bf16 v[164:167], v[208:211], v[116:119], v[164:167]
    v_add_f32 v196, 1.0, v196
    v_add_f32 v197, 1.0, v197
    v_add_u32 v250, 0xfffe8000, v250
    v_mfma_f32_16x16x32_bf16 v[168:171], v[212:215], v[112:115], v[168:171]
    ds_read_b64_tr_b16 v[208:209], v250 offset:0
    ds_read_b64_tr_b16 v[210:211], v250 offset:2048
    v_mfma_f32_16x16x32_bf16 v[172:175], v[212:215], v[116:119], v[172:175]
    v_add_f32 v198, 1.0, v198
    v_add_f32 v199, 1.0, v199
    s_waitcnt lgkmcnt(10)
    v_mfma_f32_16x16x32_bf16 v[160:163], v[216:219], v[120:123], v[160:163]
    ds_read_b64_tr_b16 v[212:213], v250 offset:12288
    ds_read_b64_tr_b16 v[214:215], v250 offset:14336
    v_mfma_f32_16x16x32_bf16 v[164:167], v[216:219], v[124:127], v[164:167]
    v_rcp_f32 v196, v196
    v_rcp_f32 v197, v197
    v_add_u32 v251, 0xfffe8000, v251
    v_mfma_f32_16x16x32_bf16 v[168:171], v[220:223], v[120:123], v[168:171]
    ds_read_b64_tr_b16 v[216:217], v251 offset:0
    ds_read_b64_tr_b16 v[218:219], v251 offset:2048
    v_mfma_f32_16x16x32_bf16 v[172:175], v[220:223], v[124:127], v[172:175]
    v_rcp_f32 v198, v198
    s_waitcnt lgkmcnt(10)
    v_mfma_f32_16x16x32_bf16 v[160:163], v[224:227], v[128:131], v[160:163]
    ds_read_b64_tr_b16 v[220:221], v251 offset:12288
    ds_read_b64_tr_b16 v[222:223], v251 offset:14336
    v_mfma_f32_16x16x32_bf16 v[164:167], v[224:227], v[132:135], v[164:167]
    v_rcp_f32 v199, v199
    v_mfma_f32_16x16x32_bf16 v[168:171], v[228:231], v[128:131], v[168:171]
    ds_read_b64_tr_b16 v[224:225], v250 offset:4096
    ds_read_b64_tr_b16 v[226:227], v250 offset:6144
    v_mfma_f32_16x16x32_bf16 v[172:175], v[228:231], v[132:135], v[172:175]
    v_mul_f32 v196, v196, v204
    v_mul_f32 v197, v197, v205
    s_waitcnt lgkmcnt(10)
    v_mfma_f32_16x16x32_bf16 v[160:163], v[232:235], v[136:139], v[160:163]
    ds_read_b64_tr_b16 v[228:229], v250 offset:16384
    ds_read_b64_tr_b16 v[230:231], v250 offset:18432
    v_mfma_f32_16x16x32_bf16 v[164:167], v[232:235], v[140:143], v[164:167]
    v_mul_f32 v198, v198, v206
    v_mul_f32 v199, v199, v207
    v_cvt_pk_bf16_f32 v246, v196, v197
    v_mfma_f32_16x16x32_bf16 v[168:171], v[236:239], v[136:139], v[168:171]
    ds_read_b64_tr_b16 v[232:233], v251 offset:4096
    ds_read_b64_tr_b16 v[234:235], v251 offset:6144
    v_mfma_f32_16x16x32_bf16 v[172:175], v[236:239], v[140:143], v[172:175]
    v_cvt_pk_bf16_f32 v247, v198, v199
    s_add_u32 s46, s50, 8192
    buffer_store_dwordx4 v[240:243], v252, s[24:27], s46 offen offset:0 sc1
    buffer_store_dwordx4 v[244:247], v252, s[24:27], s46 offen offset:1024 sc1
    s_waitcnt lgkmcnt(10)
    v_mfma_f32_16x16x32_bf16 v[176:179], v[208:211], v[0:3], 0
    ds_read_b64_tr_b16 v[236:237], v251 offset:16384
    ds_read_b64_tr_b16 v[238:239], v251 offset:18432
    v_mfma_f32_16x16x32_bf16 v[180:183], v[208:211], v[4:7], 0
    v_mul_f32 v144, 0xbfb8aa3b, v144
    v_mul_f32 v145, 0xbfb8aa3b, v145
    v_mul_f32 v146, 0xbfb8aa3b, v146
    v_mfma_f32_16x16x32_bf16 v[184:187], v[212:215], v[0:3], 0
    ds_read_b64_tr_b16 v[208:209], v250 offset:8192
    ds_read_b64_tr_b16 v[210:211], v250 offset:10240
    v_mfma_f32_16x16x32_bf16 v[188:191], v[212:215], v[4:7], 0
    v_mul_f32 v147, 0xbfb8aa3b, v147
    v_exp_f32 v144, v144
    s_waitcnt lgkmcnt(10)
    v_mfma_f32_16x16x32_bf16 v[192:195], v[216:219], v[0:3], 0
    ds_read_b64_tr_b16 v[212:213], v250 offset:20480
    ds_read_b64_tr_b16 v[214:215], v250 offset:22528
    v_mfma_f32_16x16x32_bf16 v[196:199], v[216:219], v[4:7], 0
    v_exp_f32 v145, v145
    v_mfma_f32_16x16x32_bf16 v[200:203], v[220:223], v[0:3], 0
    ds_read_b64_tr_b16 v[216:217], v251 offset:8192
    ds_read_b64_tr_b16 v[218:219], v251 offset:10240
    v_mfma_f32_16x16x32_bf16 v[204:207], v[220:223], v[4:7], 0
    v_exp_f32 v146, v146
    s_waitcnt lgkmcnt(10)
    v_mfma_f32_16x16x32_bf16 v[176:179], v[224:227], v[8:11], v[176:179]
    ds_read_b64_tr_b16 v[220:221], v251 offset:20480
    ds_read_b64_tr_b16 v[222:223], v251 offset:22528
    v_mfma_f32_16x16x32_bf16 v[180:183], v[224:227], v[12:15], v[180:183]
    v_exp_f32 v147, v147
    v_mfma_f32_16x16x32_bf16 v[184:187], v[228:231], v[8:11], v[184:187]
    ds_read_b64_tr_b16 v[224:225], v250 offset:24576
    ds_read_b64_tr_b16 v[226:227], v250 offset:26624
    v_mfma_f32_16x16x32_bf16 v[188:191], v[228:231], v[12:15], v[188:191]
    v_add_f32 v144, 1.0, v144
    v_add_f32 v145, 1.0, v145
    s_waitcnt lgkmcnt(10)
    v_mfma_f32_16x16x32_bf16 v[192:195], v[232:235], v[8:11], v[192:195]
    ds_read_b64_tr_b16 v[228:229], v250 offset:36864
    ds_read_b64_tr_b16 v[230:231], v250 offset:38912
    v_mfma_f32_16x16x32_bf16 v[196:199], v[232:235], v[12:15], v[196:199]
    v_add_f32 v146, 1.0, v146
    v_add_f32 v147, 1.0, v147
    v_rcp_f32 v144, v144
    v_mfma_f32_16x16x32_bf16 v[200:203], v[236:239], v[8:11], v[200:203]
    ds_read_b64_tr_b16 v[232:233], v251 offset:24576
    ds_read_b64_tr_b16 v[234:235], v251 offset:26624
    v_mfma_f32_16x16x32_bf16 v[204:207], v[236:239], v[12:15], v[204:207]
    v_rcp_f32 v145, v145
    s_waitcnt lgkmcnt(10)
    v_mfma_f32_16x16x32_bf16 v[176:179], v[208:211], v[16:19], v[176:179]
    ds_read_b64_tr_b16 v[236:237], v251 offset:36864
    ds_read_b64_tr_b16 v[238:239], v251 offset:38912
    v_mfma_f32_16x16x32_bf16 v[180:183], v[208:211], v[20:23], v[180:183]
    v_rcp_f32 v146, v146
    v_mfma_f32_16x16x32_bf16 v[184:187], v[212:215], v[16:19], v[184:187]
    ds_read_b64_tr_b16 v[208:209], v250 offset:28672
    ds_read_b64_tr_b16 v[210:211], v250 offset:30720
    v_mfma_f32_16x16x32_bf16 v[188:191], v[212:215], v[20:23], v[188:191]
    v_rcp_f32 v147, v147
    s_waitcnt lgkmcnt(10)
    v_mfma_f32_16x16x32_bf16 v[192:195], v[216:219], v[16:19], v[192:195]
    ds_read_b64_tr_b16 v[212:213], v250 offset:40960
    ds_read_b64_tr_b16 v[214:215], v250 offset:43008
    v_mfma_f32_16x16x32_bf16 v[196:199], v[216:219], v[20:23], v[196:199]
    v_mul_f32 v144, v144, v152
    v_mul_f32 v145, v145, v153
    v_mfma_f32_16x16x32_bf16 v[200:203], v[220:223], v[16:19], v[200:203]
    ds_read_b64_tr_b16 v[216:217], v251 offset:28672
    ds_read_b64_tr_b16 v[218:219], v251 offset:30720
    v_mfma_f32_16x16x32_bf16 v[204:207], v[220:223], v[20:23], v[204:207]
    v_mul_f32 v146, v146, v154
    v_mul_f32 v147, v147, v155
    s_waitcnt lgkmcnt(10)
    v_mfma_f32_16x16x32_bf16 v[176:179], v[224:227], v[24:27], v[176:179]
    ds_read_b64_tr_b16 v[220:221], v251 offset:40960
    ds_read_b64_tr_b16 v[222:223], v251 offset:43008
    v_mfma_f32_16x16x32_bf16 v[180:183], v[224:227], v[28:31], v[180:183]
    v_cvt_pk_bf16_f32 v240, v144, v145
    v_cvt_pk_bf16_f32 v241, v146, v147
    v_mfma_f32_16x16x32_bf16 v[184:187], v[228:231], v[24:27], v[184:187]
    ds_read_b64_tr_b16 v[224:225], v250 offset:32768
    ds_read_b64_tr_b16 v[226:227], v250 offset:34816
    v_mfma_f32_16x16x32_bf16 v[188:191], v[228:231], v[28:31], v[188:191]
    v_mul_f32 v148, 0xbfb8aa3b, v148
    v_mul_f32 v149, 0xbfb8aa3b, v149
    v_mul_f32 v150, 0xbfb8aa3b, v150
    s_waitcnt lgkmcnt(10)
    v_mfma_f32_16x16x32_bf16 v[192:195], v[232:235], v[24:27], v[192:195]
    ds_read_b64_tr_b16 v[228:229], v250 offset:45056
    ds_read_b64_tr_b16 v[230:231], v250 offset:47104
    v_mfma_f32_16x16x32_bf16 v[196:199], v[232:235], v[28:31], v[196:199]
    v_mul_f32 v151, 0xbfb8aa3b, v151
    v_exp_f32 v148, v148
    v_mfma_f32_16x16x32_bf16 v[200:203], v[236:239], v[24:27], v[200:203]
    ds_read_b64_tr_b16 v[232:233], v251 offset:32768
    ds_read_b64_tr_b16 v[234:235], v251 offset:34816
    v_mfma_f32_16x16x32_bf16 v[204:207], v[236:239], v[28:31], v[204:207]
    v_exp_f32 v149, v149
    s_waitcnt lgkmcnt(10)
    v_mfma_f32_16x16x32_bf16 v[176:179], v[208:211], v[32:35], v[176:179]
    ds_read_b64_tr_b16 v[236:237], v251 offset:45056
    ds_read_b64_tr_b16 v[238:239], v251 offset:47104
    v_mfma_f32_16x16x32_bf16 v[180:183], v[208:211], v[36:39], v[180:183]
    v_exp_f32 v150, v150
    v_add_u32 v250, 0xc000, v250
    v_mfma_f32_16x16x32_bf16 v[184:187], v[212:215], v[32:35], v[184:187]
    ds_read_b64_tr_b16 v[208:209], v250 offset:0
    ds_read_b64_tr_b16 v[210:211], v250 offset:2048
    v_mfma_f32_16x16x32_bf16 v[188:191], v[212:215], v[36:39], v[188:191]
    v_exp_f32 v151, v151
    s_waitcnt lgkmcnt(10)
    v_mfma_f32_16x16x32_bf16 v[192:195], v[216:219], v[32:35], v[192:195]
    ds_read_b64_tr_b16 v[212:213], v250 offset:12288
    ds_read_b64_tr_b16 v[214:215], v250 offset:14336
    v_mfma_f32_16x16x32_bf16 v[196:199], v[216:219], v[36:39], v[196:199]
    v_add_f32 v148, 1.0, v148
    v_add_f32 v149, 1.0, v149
    v_mfma_f32_16x16x32_bf16 v[200:203], v[220:223], v[32:35], v[200:203]
    ds_read_b64_tr_b16 v[216:217], v250 offset:4096
    ds_read_b64_tr_b16 v[218:219], v250 offset:6144
    v_mfma_f32_16x16x32_bf16 v[204:207], v[220:223], v[36:39], v[204:207]
    v_add_f32 v150, 1.0, v150
    v_add_f32 v151, 1.0, v151
    v_rcp_f32 v148, v148
    s_waitcnt lgkmcnt(10)
    v_mfma_f32_16x16x32_bf16 v[176:179], v[224:227], v[40:43], v[176:179]
    ds_read_b64_tr_b16 v[220:221], v250 offset:16384
    ds_read_b64_tr_b16 v[222:223], v250 offset:18432
    v_mfma_f32_16x16x32_bf16 v[180:183], v[224:227], v[44:47], v[180:183]
    v_rcp_f32 v149, v149
    v_mfma_f32_16x16x32_bf16 v[184:187], v[228:231], v[40:43], v[184:187]
    ds_read_b64_tr_b16 v[224:225], v250 offset:8192
    ds_read_b64_tr_b16 v[226:227], v250 offset:10240
    v_mfma_f32_16x16x32_bf16 v[188:191], v[228:231], v[44:47], v[188:191]
    v_rcp_f32 v150, v150
    s_waitcnt lgkmcnt(10)
    v_mfma_f32_16x16x32_bf16 v[192:195], v[232:235], v[40:43], v[192:195]
    ds_read_b64_tr_b16 v[228:229], v250 offset:20480
    ds_read_b64_tr_b16 v[230:231], v250 offset:22528
    v_mfma_f32_16x16x32_bf16 v[196:199], v[232:235], v[44:47], v[196:199]
    v_rcp_f32 v151, v151
    v_mfma_f32_16x16x32_bf16 v[200:203], v[236:239], v[40:43], v[200:203]
    ds_read_b64_tr_b16 v[232:233], v250 offset:24576
    ds_read_b64_tr_b16 v[234:235], v250 offset:26624
    v_mfma_f32_16x16x32_bf16 v[204:207], v[236:239], v[44:47], v[204:207]
    v_mul_f32 v148, v148, v156
    v_mul_f32 v149, v149, v157
    s_waitcnt lgkmcnt(10)
    v_mfma_f32_16x16x32_bf16 v[176:179], v[208:211], v[48:51], v[176:179]
    ds_read_b64_tr_b16 v[236:237], v250 offset:36864
    ds_read_b64_tr_b16 v[238:239], v250 offset:38912
    v_mfma_f32_16x16x32_bf16 v[180:183], v[208:211], v[52:55], v[180:183]
    v_mul_f32 v150, v150, v158
    v_mul_f32 v151, v151, v159
    v_mfma_f32_16x16x32_bf16 v[184:187], v[212:215], v[48:51], v[184:187]
    ds_read_b64_tr_b16 v[208:209], v250 offset:28672
    ds_read_b64_tr_b16 v[210:211], v250 offset:30720
    v_mfma_f32_16x16x32_bf16 v[188:191], v[212:215], v[52:55], v[188:191]
    v_cvt_pk_bf16_f32 v244, v148, v149
    v_cvt_pk_bf16_f32 v245, v150, v151
    s_waitcnt lgkmcnt(10)
    v_mfma_f32_16x16x32_bf16 v[176:179], v[216:219], v[56:59], v[176:179]
    ds_read_b64_tr_b16 v[212:213], v250 offset:40960
    ds_read_b64_tr_b16 v[214:215], v250 offset:43008
    v_mfma_f32_16x16x32_bf16 v[180:183], v[216:219], v[60:63], v[180:183]
    v_mul_f32 v160, 0xbfb8aa3b, v160
    v_mul_f32 v161, 0xbfb8aa3b, v161
    v_mul_f32 v162, 0xbfb8aa3b, v162
    v_mfma_f32_16x16x32_bf16 v[184:187], v[220:223], v[56:59], v[184:187]
    ds_read_b64_tr_b16 v[216:217], v250 offset:32768
    ds_read_b64_tr_b16 v[218:219], v250 offset:34816
    v_mfma_f32_16x16x32_bf16 v[188:191], v[220:223], v[60:63], v[188:191]
    v_mul_f32 v163, 0xbfb8aa3b, v163
    v_exp_f32 v160, v160
    s_waitcnt lgkmcnt(10)
    v_mfma_f32_16x16x32_bf16 v[176:179], v[224:227], v[64:67], v[176:179]
    ds_read_b64_tr_b16 v[220:221], v250 offset:45056
    ds_read_b64_tr_b16 v[222:223], v250 offset:47104
    v_mfma_f32_16x16x32_bf16 v[180:183], v[224:227], v[68:71], v[180:183]
    v_exp_f32 v161, v161
    s_barrier
    v_add_u32 v250, 0xc000, v250
    v_mfma_f32_16x16x32_bf16 v[184:187], v[228:231], v[64:67], v[184:187]
    ds_read_b64_tr_b16 v[224:225], v250 offset:0
    ds_read_b64_tr_b16 v[226:227], v250 offset:2048
    v_mfma_f32_16x16x32_bf16 v[188:191], v[228:231], v[68:71], v[188:191]
    v_exp_f32 v162, v162
    s_waitcnt lgkmcnt(10)
    v_mfma_f32_16x16x32_bf16 v[176:179], v[232:235], v[72:75], v[176:179]
    ds_read_b64_tr_b16 v[228:229], v250 offset:12288
    ds_read_b64_tr_b16 v[230:231], v250 offset:14336
    s_add_u32 s16, s8, 0x2e00000
    s_addc_u32 s17, s9, 0
    s_mov_b32 s18, 0x120000
    s_mov_b32 s19, 0x20000
    s_mov_b32 m0, s53
    s_nop 0
    buffer_load_dwordx4 v252, s[16:19], s54 offen lds
    v_mfma_f32_16x16x32_bf16 v[180:183], v[232:235], v[76:79], v[180:183]
    v_exp_f32 v163, v163
    v_mfma_f32_16x16x32_bf16 v[184:187], v[236:239], v[72:75], v[184:187]
    ds_read_b64_tr_b16 v[232:233], v250 offset:4096
    ds_read_b64_tr_b16 v[234:235], v250 offset:6144
    v_mfma_f32_16x16x32_bf16 v[188:191], v[236:239], v[76:79], v[188:191]
    buffer_load_dwordx4 v252, s[16:19], s54 offen offset:1024 lds
    v_add_f32 v160, 1.0, v160
    v_add_f32 v161, 1.0, v161
    v_add_f32 v162, 1.0, v162
    s_waitcnt lgkmcnt(10)
    v_mfma_f32_16x16x32_bf16 v[176:179], v[208:211], v[80:83], v[176:179]
    ds_read_b64_tr_b16 v[236:237], v250 offset:16384
    ds_read_b64_tr_b16 v[238:239], v250 offset:18432
    v_mfma_f32_16x16x32_bf16 v[180:183], v[208:211], v[84:87], v[180:183]
    v_add_f32 v163, 1.0, v163
    v_rcp_f32 v160, v160
    v_mfma_f32_16x16x32_bf16 v[184:187], v[212:215], v[80:83], v[184:187]
    ds_read_b64_tr_b16 v[208:209], v250 offset:8192
    ds_read_b64_tr_b16 v[210:211], v250 offset:10240
    buffer_load_dwordx4 v252, s[16:19], s54 offen offset:2048 lds
    v_mfma_f32_16x16x32_bf16 v[188:191], v[212:215], v[84:87], v[188:191]
    v_rcp_f32 v161, v161
    s_waitcnt lgkmcnt(10)
    v_mfma_f32_16x16x32_bf16 v[176:179], v[216:219], v[88:91], v[176:179]
    ds_read_b64_tr_b16 v[212:213], v250 offset:20480
    ds_read_b64_tr_b16 v[214:215], v250 offset:22528
    v_mfma_f32_16x16x32_bf16 v[180:183], v[216:219], v[92:95], v[180:183]
    buffer_load_dwordx4 v252, s[16:19], s54 offen offset:3072 lds
    v_rcp_f32 v162, v162
    v_mfma_f32_16x16x32_bf16 v[184:187], v[220:223], v[88:91], v[184:187]
    ds_read_b64_tr_b16 v[216:217], v250 offset:24576
    ds_read_b64_tr_b16 v[218:219], v250 offset:26624
    v_mfma_f32_16x16x32_bf16 v[188:191], v[220:223], v[92:95], v[188:191]
    v_rcp_f32 v163, v163
    s_waitcnt lgkmcnt(10)
    v_mfma_f32_16x16x32_bf16 v[176:179], v[224:227], v[96:99], v[176:179]
    ds_read_b64_tr_b16 v[220:221], v250 offset:36864
    ds_read_b64_tr_b16 v[222:223], v250 offset:38912
    s_add_u32 m0, s53, 4096
    s_add_u32 s54, s54, 4096
    buffer_load_dwordx4 v252, s[16:19], s54 offen lds
    v_mfma_f32_16x16x32_bf16 v[180:183], v[224:227], v[100:103], v[180:183]
    v_mul_f32 v160, v160, v168
    v_mul_f32 v161, v161, v169
    v_mfma_f32_16x16x32_bf16 v[184:187], v[228:231], v[96:99], v[184:187]
    ds_read_b64_tr_b16 v[224:225], v250 offset:28672
    ds_read_b64_tr_b16 v[226:227], v250 offset:30720
    v_mfma_f32_16x16x32_bf16 v[188:191], v[228:231], v[100:103], v[188:191]
    buffer_load_dwordx4 v252, s[16:19], s54 offen offset:1024 lds
    v_mul_f32 v162, v162, v170
    v_mul_f32 v163, v163, v171
    v_cvt_pk_bf16_f32 v242, v160, v161
    s_waitcnt lgkmcnt(10)
    v_mfma_f32_16x16x32_bf16 v[176:179], v[232:235], v[104:107], v[176:179]
    ds_read_b64_tr_b16 v[228:229], v250 offset:40960
    ds_read_b64_tr_b16 v[230:231], v250 offset:43008
    v_mfma_f32_16x16x32_bf16 v[180:183], v[232:235], v[108:111], v[180:183]
    v_cvt_pk_bf16_f32 v243, v162, v163
    v_mul_f32 v164, 0xbfb8aa3b, v164
    v_mfma_f32_16x16x32_bf16 v[184:187], v[236:239], v[104:107], v[184:187]
    ds_read_b64_tr_b16 v[232:233], v250 offset:32768
    ds_read_b64_tr_b16 v[234:235], v250 offset:34816
    v_mfma_f32_16x16x32_bf16 v[188:191], v[236:239], v[108:111], v[188:191]
    v_mul_f32 v165, 0xbfb8aa3b, v165
    v_mul_f32 v166, 0xbfb8aa3b, v166
    s_waitcnt lgkmcnt(10)
    v_mfma_f32_16x16x32_bf16 v[176:179], v[208:211], v[112:115], v[176:179]
    ds_read_b64_tr_b16 v[236:237], v250 offset:45056
    ds_read_b64_tr_b16 v[238:239], v250 offset:47104
    v_mfma_f32_16x16x32_bf16 v[180:183], v[208:211], v[116:119], v[180:183]
    v_mul_f32 v167, 0xbfb8aa3b, v167
    v_exp_f32 v164, v164
    v_add_u32 v251, 0xc000, v251
    v_mfma_f32_16x16x32_bf16 v[184:187], v[212:215], v[112:115], v[184:187]
    ds_read_b64_tr_b16 v[208:209], v251 offset:0
    ds_read_b64_tr_b16 v[210:211], v251 offset:2048
    v_mfma_f32_16x16x32_bf16 v[188:191], v[212:215], v[116:119], v[188:191]
    v_exp_f32 v165, v165
    s_waitcnt lgkmcnt(10)
    v_mfma_f32_16x16x32_bf16 v[176:179], v[216:219], v[120:123], v[176:179]
    ds_read_b64_tr_b16 v[212:213], v251 offset:12288
    ds_read_b64_tr_b16 v[214:215], v251 offset:14336
    v_mfma_f32_16x16x32_bf16 v[180:183], v[216:219], v[124:127], v[180:183]
    v_exp_f32 v166, v166
    v_mfma_f32_16x16x32_bf16 v[184:187], v[220:223], v[120:123], v[184:187]
    ds_read_b64_tr_b16 v[216:217], v251 offset:4096
    ds_read_b64_tr_b16 v[218:219], v251 offset:6144
    v_mfma_f32_16x16x32_bf16 v[188:191], v[220:223], v[124:127], v[188:191]
    v_exp_f32 v167, v167
    v_add_f32 v164, 1.0, v164
    s_waitcnt lgkmcnt(10)
    v_mfma_f32_16x16x32_bf16 v[176:179], v[224:227], v[128:131], v[176:179]
    ds_read_b64_tr_b16 v[220:221], v251 offset:16384
    ds_read_b64_tr_b16 v[222:223], v251 offset:18432
    v_mfma_f32_16x16x32_bf16 v[180:183], v[224:227], v[132:135], v[180:183]
    v_add_f32 v165, 1.0, v165
    v_add_f32 v166, 1.0, v166
    v_mfma_f32_16x16x32_bf16 v[184:187], v[228:231], v[128:131], v[184:187]
    ds_read_b64_tr_b16 v[224:225], v251 offset:8192
    ds_read_b64_tr_b16 v[226:227], v251 offset:10240
    v_mfma_f32_16x16x32_bf16 v[188:191], v[228:231], v[132:135], v[188:191]
    v_add_f32 v167, 1.0, v167
    v_rcp_f32 v164, v164
    s_waitcnt lgkmcnt(10)
    v_mfma_f32_16x16x32_bf16 v[176:179], v[232:235], v[136:139], v[176:179]
    ds_read_b64_tr_b16 v[228:229], v251 offset:20480
    ds_read_b64_tr_b16 v[230:231], v251 offset:22528
    v_mfma_f32_16x16x32_bf16 v[180:183], v[232:235], v[140:143], v[180:183]
    v_rcp_f32 v165, v165
    v_mfma_f32_16x16x32_bf16 v[184:187], v[236:239], v[136:139], v[184:187]
    ds_read_b64_tr_b16 v[232:233], v251 offset:24576
    ds_read_b64_tr_b16 v[234:235], v251 offset:26624
    v_mfma_f32_16x16x32_bf16 v[188:191], v[236:239], v[140:143], v[188:191]
    v_rcp_f32 v166, v166
    s_waitcnt vmcnt(6)
    v_mov_b32 v254, 1
    s_mov_b64 exec, 1
    buffer_store_byte v254, off, s[20:23], s47 sc1
    s_mov_b64 exec, -1
    s_add_u32 s47, s47, 8192
    s_waitcnt lgkmcnt(10)
    v_mfma_f32_16x16x32_bf16 v[192:195], v[208:211], v[48:51], v[192:195]
    ds_read_b64_tr_b16 v[236:237], v251 offset:36864
    ds_read_b64_tr_b16 v[238:239], v251 offset:38912
    v_mfma_f32_16x16x32_bf16 v[196:199], v[208:211], v[52:55], v[196:199]
    v_rcp_f32 v167, v167
    v_mfma_f32_16x16x32_bf16 v[200:203], v[212:215], v[48:51], v[200:203]
    ds_read_b64_tr_b16 v[208:209], v251 offset:28672
    ds_read_b64_tr_b16 v[210:211], v251 offset:30720
    s_lshr_b32 s30, s3, 1
    s_and_b32 s29, s3, 1
    s_lshl_b32 s29, s29, 3
    v_mfma_f32_16x16x32_bf16 v[204:207], v[212:215], v[52:55], v[204:207]
    v_mul_f32 v164, v164, v172
    v_mul_f32 v165, v165, v173
    v_mul_f32 v166, v166, v174
    s_lshr_b32 s34, s33, 2
    s_add_u32 s29, s29, s34
    s_waitcnt lgkmcnt(10)
    v_mfma_f32_16x16x32_bf16 v[192:195], v[216:219], v[56:59], v[192:195]
    ds_read_b64_tr_b16 v[212:213], v251 offset:40960
    ds_read_b64_tr_b16 v[214:215], v251 offset:43008
    s_and_b32 s31, s33, 3
    s_lshl_b32 s35, s29, 2
    s_add_u32 s35, s35, s30
    v_mfma_f32_16x16x32_bf16 v[196:199], v[216:219], v[60:63], v[196:199]
    v_mul_f32 v167, v167, v175
    v_cvt_pk_bf16_f32 v246, v164, v165
    s_lshl_b32 s35, s35, 7
    s_bfe_u32 s44, s28, 0x10001
    v_mfma_f32_16x16x32_bf16 v[200:203], v[220:223], v[56:59], v[200:203]
    ds_read_b64_tr_b16 v[216:217], v251 offset:32768
    ds_read_b64_tr_b16 v[218:219], v251 offset:34816
    s_and_b32 s45, s28, 1
    s_mul_i32 s36, s29, 1179648
    s_lshl_b32 s37, s45, 12
    v_mfma_f32_16x16x32_bf16 v[204:207], v[220:223], v[60:63], v[204:207]
    v_cvt_pk_bf16_f32 v247, v166, v167
    s_add_u32 s46, s50, 16384
    buffer_store_dwordx4 v[240:243], v252, s[24:27], s46 offen offset:0 sc1
    buffer_store_dwordx4 v[244:247], v252, s[24:27], s46 offen offset:1024 sc1
    s_add_u32 s36, s36, s37
    s_mul_i32 s37, s45, 18432
    s_waitcnt lgkmcnt(10)
    v_mfma_f32_16x16x32_bf16 v[192:195], v[224:227], v[64:67], v[192:195]
    ds_read_b64_tr_b16 v[220:221], v251 offset:45056
    ds_read_b64_tr_b16 v[222:223], v251 offset:47104
    s_lshl_b32 s38, s31, 8
    s_add_u32 s37, s37, s38
    s_lshl_b32 s38, s31, 10
    v_mfma_f32_16x16x32_bf16 v[196:199], v[224:227], v[68:71], v[196:199]
    v_mul_f32 v176, 0xbfb8aa3b, v176
    v_mul_f32 v177, 0xbfb8aa3b, v177
    v_mul_f32 v178, 0xbfb8aa3b, v178
    s_lshl_b32 s39, s45, 9
    s_add_u32 s38, s38, s39
    v_add_u32 v251, 0xc000, v251
    v_mfma_f32_16x16x32_bf16 v[200:203], v[228:231], v[64:67], v[200:203]
    ds_read_b64_tr_b16 v[224:225], v251 offset:0
    ds_read_b64_tr_b16 v[226:227], v251 offset:2048
    s_add_u32 s42, s31, s29
    s_lshl_b32 s48, s28, 12
    s_add_u32 s48, s48, 2048
    v_mfma_f32_16x16x32_bf16 v[204:207], v[228:231], v[68:71], v[204:207]
    v_mul_f32 v179, 0xbfb8aa3b, v179
    v_exp_f32 v176, v176
    s_add_u32 s49, s48, 18432
    s_lshl_b32 s56, s28, 9
    s_waitcnt lgkmcnt(10)
    v_mfma_f32_16x16x32_bf16 v[192:195], v[232:235], v[72:75], v[192:195]
    ds_read_b64_tr_b16 v[228:229], v251 offset:12288
    ds_read_b64_tr_b16 v[230:231], v251 offset:14336
    s_add_u32 s56, s56, 18432
    s_mov_b32 s40, -1
    v_mfma_f32_16x16x32_bf16 v[196:199], v[232:235], v[76:79], v[196:199]
    v_exp_f32 v177, v177
    s_mov_b32 s41, 0
    s_mov_b32 s16, s60
    s_mov_b32 s17, s61
    v_mfma_f32_16x16x32_bf16 v[200:203], v[236:239], v[72:75], v[200:203]
    ds_read_b64_tr_b16 v[232:233], v251 offset:4096
    ds_read_b64_tr_b16 v[234:235], v251 offset:6144
    s_mov_b32 s18, 5308416
    s_mov_b32 s19, 0x20000
    v_mfma_f32_16x16x32_bf16 v[204:207], v[236:239], v[76:79], v[204:207]
    v_exp_f32 v178, v178
    s_add_u32 s12, s8, 0x2f80000
    s_addc_u32 s13, s9, 0
    s_mov_b32 s14, 0x90000
    s_mov_b32 s15, 0x20000
    s_waitcnt lgkmcnt(10)
    v_mfma_f32_16x16x32_bf16 v[192:195], v[208:211], v[80:83], v[192:195]
    ds_read_b64_tr_b16 v[236:237], v251 offset:16384
    ds_read_b64_tr_b16 v[238:239], v251 offset:18432
    s_lshl_b32 s52, s30, 5
    s_lshl_b32 s53, s44, 2
    v_mfma_f32_16x16x32_bf16 v[196:199], v[208:211], v[84:87], v[196:199]
    v_exp_f32 v179, v179
    s_add_u32 s52, s52, s53
    s_add_u32 s53, s42, 0
    s_and_b32 s53, s53, 3
    v_mfma_f32_16x16x32_bf16 v[200:203], v[212:215], v[80:83], v[200:203]
    ds_read_b64_tr_b16 v[208:209], v251 offset:8192
    ds_read_b64_tr_b16 v[210:211], v251 offset:10240
    s_lshl_b32 s53, s53, 3
    s_add_u32 s53, s53, s52
    v_mfma_f32_16x16x32_bf16 v[204:207], v[212:215], v[84:87], v[204:207]
    v_add_f32 v176, 1.0, v176
    v_add_f32 v177, 1.0, v177
    s_lshl_b32 s54, s53, 13
    s_add_u32 s80, s54, s36
    s_mul_i32 s54, s53, 36864
    s_waitcnt lgkmcnt(10)
    v_mfma_f32_16x16x32_bf16 v[192:195], v[216:219], v[88:91], v[192:195]
    ds_read_b64_tr_b16 v[212:213], v251 offset:20480
    ds_read_b64_tr_b16 v[214:215], v251 offset:22528
    s_add_u32 s81, s54, s37
    s_lshl_b32 s54, s53, 12
    v_mfma_f32_16x16x32_bf16 v[196:199], v[216:219], v[92:95], v[196:199]
    v_add_f32 v178, 1.0, v178
    v_add_f32 v179, 1.0, v179
    v_rcp_f32 v176, v176
    s_add_u32 s82, s54, s38
    s_add_u32 s53, s42, 1
    s_and_b32 s53, s53, 3
    v_mfma_f32_16x16x32_bf16 v[200:203], v[220:223], v[88:91], v[200:203]
    ds_read_b64_tr_b16 v[216:217], v251 offset:24576
    ds_read_b64_tr_b16 v[218:219], v251 offset:26624
    s_lshl_b32 s53, s53, 3
    s_add_u32 s53, s53, s52
    v_mfma_f32_16x16x32_bf16 v[204:207], v[220:223], v[92:95], v[204:207]
    v_rcp_f32 v177, v177
    s_lshl_b32 s54, s53, 13
    s_add_u32 s83, s54, s36
    s_waitcnt lgkmcnt(10)
    v_mfma_f32_16x16x32_bf16 v[192:195], v[224:227], v[96:99], v[192:195]
    ds_read_b64_tr_b16 v[220:221], v251 offset:36864
    ds_read_b64_tr_b16 v[222:223], v251 offset:38912
    s_mul_i32 s54, s53, 36864
    s_add_u32 s84, s54, s37
    s_lshl_b32 s54, s53, 12
    v_mfma_f32_16x16x32_bf16 v[196:199], v[224:227], v[100:103], v[196:199]
    v_rcp_f32 v178, v178
    s_add_u32 s85, s54, s38
    s_add_u32 s53, s42, 2
    v_mfma_f32_16x16x32_bf16 v[200:203], v[228:231], v[96:99], v[200:203]
    ds_read_b64_tr_b16 v[224:225], v251 offset:28672
    ds_read_b64_tr_b16 v[226:227], v251 offset:30720
    s_and_b32 s53, s53, 3
    s_lshl_b32 s53, s53, 3
    s_add_u32 s53, s53, s52
    v_mfma_f32_16x16x32_bf16 v[204:207], v[228:231], v[100:103], v[204:207]
    v_rcp_f32 v179, v179
    s_lshl_b32 s54, s53, 13
    s_add_u32 s86, s54, s36
    s_waitcnt lgkmcnt(10)
    v_mfma_f32_16x16x32_bf16 v[192:195], v[232:235], v[104:107], v[192:195]
    ds_read_b64_tr_b16 v[228:229], v251 offset:40960
    ds_read_b64_tr_b16 v[230:231], v251 offset:43008
    s_mul_i32 s54, s53, 36864
    s_add_u32 s87, s54, s37
    s_lshl_b32 s54, s53, 12
    v_mfma_f32_16x16x32_bf16 v[196:199], v[232:235], v[108:111], v[196:199]
    v_mul_f32 v176, v176, v184
    v_mul_f32 v177, v177, v185
    s_add_u32 s88, s54, s38
    s_add_u32 s53, s42, 3
    v_mfma_f32_16x16x32_bf16 v[200:203], v[236:239], v[104:107], v[200:203]
    ds_read_b64_tr_b16 v[232:233], v251 offset:32768
    ds_read_b64_tr_b16 v[234:235], v251 offset:34816
    s_and_b32 s53, s53, 3
    s_lshl_b32 s53, s53, 3
    s_add_u32 s53, s53, s52
    v_lshrrev_b32 v164, 8, v252
    v_mfma_f32_16x16x32_bf16 v[204:207], v[236:239], v[108:111], v[204:207]
    v_mul_f32 v178, v178, v186
    v_mul_f32 v179, v179, v187
    s_lshl_b32 s54, s53, 13
    s_add_u32 s89, s54, s36
    v_mul_u32_u24 v165, 1152, v164
    s_waitcnt lgkmcnt(10)
    v_mfma_f32_16x16x32_bf16 v[192:195], v[208:211], v[112:115], v[192:195]
    ds_read_b64_tr_b16 v[236:237], v251 offset:45056
    ds_read_b64_tr_b16 v[238:239], v251 offset:47104
    s_mul_i32 s54, s53, 36864
    s_add_u32 s90, s54, s37
    s_lshl_b32 s54, s53, 12
    v_and_or_b32 v165, v252, 16, v165
    v_mfma_f32_16x16x32_bf16 v[196:199], v[208:211], v[116:119], v[196:199]
    v_cvt_pk_bf16_f32 v240, v176, v177
    v_cvt_pk_bf16_f32 v241, v178, v179
    s_add_u32 s91, s54, s38
    s_lshl_b32 s52, s30, 2
    v_bfe_u32 v166, v252, 5, 3
    s_waitcnt vmcnt(3)
    s_barrier
    v_lshrrev_b32 v248, 1, v252
    v_mfma_f32_16x16x32_bf16 v[200:203], v[212:215], v[112:115], v[200:203]
    ds_read_b64_tr_b16 v[208:209], v248 offset:0
    ds_read_b64_tr_b16 v[210:211], v248 offset:512
    s_add_u32 s52, s52, s44
    s_add_u32 s52, s52, 128
    v_xor_b32 v166, v166, v164
    v_mfma_f32_16x16x32_bf16 v[204:207], v[212:215], v[116:119], v[204:207]
    v_mul_f32 v180, 0xbfb8aa3b, v180
    v_mul_f32 v181, 0xbfb8aa3b, v181
    v_mul_f32 v182, 0xbfb8aa3b, v182
    s_mul_i32 s54, s45, 13824
    s_sub_u32 s39, s37, s54
    s_add_u32 s53, s42, 0
    v_lshl_add_u32 v160, v166, 5, v165
    s_waitcnt lgkmcnt(10)
    v_mfma_f32_16x16x32_bf16 v[192:195], v[216:219], v[120:123], v[192:195]
    ds_read_b64_tr_b16 v[212:213], v248 offset:1024
    ds_read_b64_tr_b16 v[214:215], v248 offset:1536
    s_and_b32 s53, s53, 1
    s_lshl_b32 s53, s53, 1
    v_add_u32 v162, 7168, v160
    v_mfma_f32_16x16x32_bf16 v[196:199], v[216:219], v[124:127], v[196:199]
    v_mul_f32 v183, 0xbfb8aa3b, v183
    v_exp_f32 v180, v180
    s_add_u32 s53, s53, s52
    s_lshl_b32 s54, s53, 13
    s_add_u32 s92, s54, s36
    v_xor_b32 v166, 4, v166
    v_mfma_f32_16x16x32_bf16 v[200:203], v[220:223], v[120:123], v[200:203]
    ds_read_b64_tr_b16 v[216:217], v248 offset:2048
    ds_read_b64_tr_b16 v[218:219], v248 offset:2560
    s_mul_i32 s54, s53, 36864
    s_add_u32 s93, s54, s39
    v_lshl_add_u32 v161, v166, 5, v165
    v_mfma_f32_16x16x32_bf16 v[204:207], v[220:223], v[124:127], v[204:207]
    v_exp_f32 v181, v181
    s_lshl_b32 s54, s53, 12
    s_add_u32 s94, s54, s38
    s_add_u32 s53, s42, 1
    v_add_u32 v161, 3584, v161
    s_waitcnt lgkmcnt(10)
    v_mfma_f32_16x16x32_bf16 v[192:195], v[224:227], v[128:131], v[192:195]
    ds_read_b64_tr_b16 v[220:221], v248 offset:3072
    ds_read_b64_tr_b16 v[222:223], v248 offset:3584
    s_and_b32 s53, s53, 1
    s_lshl_b32 s53, s53, 1
    v_add_u32 v163, 7168, v161
    v_mfma_f32_16x16x32_bf16 v[196:199], v[224:227], v[132:135], v[196:199]
    v_exp_f32 v182, v182
    s_add_u32 s53, s53, s52
    s_lshl_b32 s54, s53, 13
    s_add_u32 s95, s54, s36
    v_lshrrev_b32 v253, 2, v252
    v_mfma_f32_16x16x32_bf16 v[200:203], v[228:231], v[128:131], v[200:203]
    ds_read_b64_tr_b16 v[224:225], v248 offset:4096
    ds_read_b64_tr_b16 v[226:227], v248 offset:4608
    s_mul_i32 s54, s53, 36864
    s_add_u32 s96, s54, s39
    v_and_b32 v253, 0x1c, v253
    v_mfma_f32_16x16x32_bf16 v[204:207], v[228:231], v[132:135], v[204:207]
    v_exp_f32 v183, v183
    s_lshl_b32 s54, s53, 12
    s_add_u32 s97, s54, s38
    s_waitcnt lgkmcnt(10)
    v_mfma_f32_16x16x32_bf16 v[192:195], v[232:235], v[136:139], v[192:195]
    ds_read_b64_tr_b16 v[228:229], v248 offset:5120
    ds_read_b64_tr_b16 v[230:231], v248 offset:5632
    v_mfma_f32_16x16x32_bf16 v[196:199], v[232:235], v[140:143], v[196:199]
    v_add_f32 v180, 1.0, v180
    v_add_f32 v181, 1.0, v181
    s_load_dwordx8 s[72:79], s[6:7], s35
    v_mfma_f32_16x16x32_bf16 v[200:203], v[236:239], v[136:139], v[200:203]
    ds_read_b64_tr_b16 v[232:233], v248 offset:6144
    ds_read_b64_tr_b16 v[234:235], v248 offset:6656
    v_mfma_f32_16x16x32_bf16 v[204:207], v[236:239], v[140:143], v[204:207]
    v_add_f32 v182, 1.0, v182
    v_add_f32 v183, 1.0, v183
    v_rcp_f32 v180, v180
    v_and_b32 v249, 0xf0, v252
    v_bfe_u32 v254, v252, 8, 1
    v_lshl_add_u32 v249, v254, 10, v249
    v_lshrrev_b32 v254, 9, v252
    v_lshl_add_u32 v249, v254, 8, v249
    s_waitcnt lgkmcnt(10)
    v_mfma_f32_16x16x32_bf16 v[144:147], v[208:211], v[0:3], 0
    ds_read_b64_tr_b16 v[236:237], v248 offset:7168
    ds_read_b64_tr_b16 v[238:239], v248 offset:7680
    v_mfma_f32_16x16x32_bf16 v[148:151], v[208:211], v[4:7], 0
    v_rcp_f32 v181, v181
    v_mfma_f32_16x16x32_bf16 v[152:155], v[212:215], v[0:3], 0
    ds_read_b64_tr_b16 v[208:209], v248 offset:8192
    ds_read_b64_tr_b16 v[210:211], v248 offset:8704
    v_mfma_f32_16x16x32_bf16 v[156:159], v[212:215], v[4:7], 0
    v_rcp_f32 v182, v182
    s_barrier
    s_waitcnt lgkmcnt(10)
    v_mfma_f32_16x16x32_bf16 v[144:147], v[216:219], v[8:11], v[144:147]
    ds_read_b64_tr_b16 v[212:213], v248 offset:9216
    ds_read_b64_tr_b16 v[214:215], v248 offset:9728
    v_mfma_f32_16x16x32_bf16 v[148:151], v[216:219], v[12:15], v[148:151]
    v_rcp_f32 v183, v183
    v_mfma_f32_16x16x32_bf16 v[152:155], v[220:223], v[8:11], v[152:155]
    ds_read_b64_tr_b16 v[216:217], v248 offset:10240
    ds_read_b64_tr_b16 v[218:219], v248 offset:10752
    v_mfma_f32_16x16x32_bf16 v[156:159], v[220:223], v[12:15], v[156:159]
    v_mul_f32 v180, v180, v188
    v_mul_f32 v181, v181, v189
    s_waitcnt lgkmcnt(10)
    v_mfma_f32_16x16x32_bf16 v[144:147], v[224:227], v[16:19], v[144:147]
    ds_read_b64_tr_b16 v[220:221], v248 offset:11264
    ds_read_b64_tr_b16 v[222:223], v248 offset:11776
    v_mfma_f32_16x16x32_bf16 v[148:151], v[224:227], v[20:23], v[148:151]
    v_mul_f32 v182, v182, v190
    v_mul_f32 v183, v183, v191
    v_mfma_f32_16x16x32_bf16 v[152:155], v[228:231], v[16:19], v[152:155]
    ds_read_b64_tr_b16 v[224:225], v248 offset:12288
    ds_read_b64_tr_b16 v[226:227], v248 offset:12800
    v_mfma_f32_16x16x32_bf16 v[156:159], v[228:231], v[20:23], v[156:159]
    v_cvt_pk_bf16_f32 v244, v180, v181
    v_cvt_pk_bf16_f32 v245, v182, v183
    s_waitcnt lgkmcnt(10)
    v_mfma_f32_16x16x32_bf16 v[144:147], v[232:235], v[24:27], v[144:147]
    ds_read_b64_tr_b16 v[228:229], v248 offset:13312
    ds_read_b64_tr_b16 v[230:231], v248 offset:13824
    v_mfma_f32_16x16x32_bf16 v[148:151], v[232:235], v[28:31], v[148:151]
    v_mul_f32 v192, 0xbfb8aa3b, v192
    v_mul_f32 v193, 0xbfb8aa3b, v193
    s_waitcnt vmcnt(0)
    v_mov_b32 v254, 1
    s_mov_b64 exec, 1
    buffer_store_byte v254, off, s[20:23], s47 sc1
    s_mov_b64 exec, -1
    s_add_u32 s47, s47, 8192
    v_mfma_f32_16x16x32_bf16 v[152:155], v[236:239], v[24:27], v[152:155]
    ds_read_b64_tr_b16 v[232:233], v248 offset:14336
    ds_read_b64_tr_b16 v[234:235], v248 offset:14848
    v_mfma_f32_16x16x32_bf16 v[156:159], v[236:239], v[28:31], v[156:159]
    v_mul_f32 v194, 0xbfb8aa3b, v194
    v_mul_f32 v195, 0xbfb8aa3b, v195
    s_cmp_ge_u32 s28, 4
    s_cbranch_scc1 L_sequential_preLN__spectral_fnet__glu_gated_glu__prompt_noearly_22
    s_mov_b32 s62, 0x01010101
    s_waitcnt lgkmcnt(0)
    s_and_b64 s[72:73], s[72:73], s[74:75]
    s_and_b64 s[76:77], s[76:77], s[78:79]
    s_and_b64 s[72:73], s[72:73], s[76:77]
    s_and_b32 s72, s72, s73
    s_and_b32 s72, s72, s62
    s_cmp_eq_u32 s72, s62
    s_cbranch_scc1 L_sequential_preLN__spectral_fnet__glu_gated_glu__prompt_ok_23
    s_mov_b32 s55, 0x40000
L_sequential_preLN__spectral_fnet__glu_gated_glu__prompt_again_24:
    buffer_load_dword v255, v253, s[20:23], s35 offen sc1
    s_waitcnt vmcnt(0)
    v_and_b32 v255, s62, v255
    v_cmp_ne_u32 vcc, s62, v255
    s_nop 4
    s_cbranch_vccz L_sequential_preLN__spectral_fnet__glu_gated_glu__prompt_ok_23
    s_sub_u32 s55, s55, 1
    s_cbranch_scc1 L_sequential_preLN__spectral_fnet__glu_gated_glu__prompt_ok_23
    s_sleep 2
    s_branch L_sequential_preLN__spectral_fnet__glu_gated_glu__prompt_again_24
L_sequential_preLN__spectral_fnet__glu_gated_glu__prompt_ok_23:
    s_add_u32 s35, s35, 8192
    s_add_u32 m0, s49, 34816
    s_nop 0
    buffer_load_dwordx4 v252, s[24:27], s80 offen offset:0 sc1 lds
    buffer_load_dwordx4 v252, s[24:27], s80 offen offset:1024 sc1 lds
    buffer_load_dwordx4 v252, s[24:27], s80 offen offset:2048 sc1 lds
    buffer_load_dwordx4 v252, s[24:27], s80 offen offset:3072 sc1 lds
L_sequential_preLN__spectral_fnet__glu_gated_glu__prompt_noearly_22:
    s_waitcnt lgkmcnt(10)
    v_mfma_f32_16x16x32_bf16 v[144:147], v[208:211], v[32:35], v[144:147]
    ds_read_b64_tr_b16 v[236:237], v248 offset:15360
    ds_read_b64_tr_b16 v[238:239], v248 offset:15872
    v_mfma_f32_16x16x32_bf16 v[148:151], v[208:211], v[36:39], v[148:151]
    v_exp_f32 v192, v192
    v_mfma_f32_16x16x32_bf16 v[152:155], v[212:215], v[32:35], v[152:155]
    ds_read_b64_tr_b16 v[208:209], v248 offset:16384
    ds_read_b64_tr_b16 v[210:211], v248 offset:16896
    v_mfma_f32_16x16x32_bf16 v[156:159], v[212:215], v[36:39], v[156:159]
    v_exp_f32 v193, v193
    s_waitcnt lgkmcnt(10)
    v_mfma_f32_16x16x32_bf16 v[144:147], v[216:219], v[40:43], v[144:147]
    ds_read_b64_tr_b16 v[212:213], v248 offset:17408
    ds_read_b64_tr_b16 v[214:215], v248 offset:17920
    v_mfma_f32_16x16x32_bf16 v[148:151], v[216:219], v[44:47], v[148:151]
    v_exp_f32 v194, v194
    v_mfma_f32_16x16x32_bf16 v[152:155], v[220:223], v[40:43], v[152:155]
    ds_read_b64_tr_b16 v[216:217], v248 offset:18432
    ds_read_b64_tr_b16 v[218:219], v248 offset:18944
    v_mfma_f32_16x16x32_bf16 v[156:159], v[220:223], v[44:47], v[156:159]
    v_exp_f32 v195, v195
    s_cmp_ge_u32 s28, 4
    s_cbranch_scc1 L_sequential_preLN__spectral_fnet__glu_gated_glu__prompt_noearly_25
    s_add_u32 m0, s56, 34816
    s_mov_b64 exec, s[40:41]
    buffer_load_dwordx4 v252, s[12:15], s82 offen lds
    s_add_u32 m0, s48, 34816
    s_mov_b64 exec, -1
    buffer_load_dwordx4 v160, s[16:19], s81 offen offset:0 lds
    s_add_u32 s80, s80, 8192
    s_add_u32 s82, s82, 4096
    buffer_load_dwordx4 v161, s[16:19], s81 offen offset:1024 lds
    buffer_load_dwordx4 v162, s[16:19], s81 offen offset:2048 lds
    buffer_load_dwordx4 v163, s[16:19], s81 offen offset:3072 lds
    s_add_u32 s81, s81, 36864
L_sequential_preLN__spectral_fnet__glu_gated_glu__prompt_noearly_25:
    s_waitcnt lgkmcnt(10)
    v_mfma_f32_16x16x32_bf16 v[144:147], v[224:227], v[48:51], v[144:147]
    ds_read_b64_tr_b16 v[220:221], v248 offset:19456
    ds_read_b64_tr_b16 v[222:223], v248 offset:19968
    v_mfma_f32_16x16x32_bf16 v[148:151], v[224:227], v[52:55], v[148:151]
    v_add_f32 v192, 1.0, v192
    v_add_f32 v193, 1.0, v193
    v_mfma_f32_16x16x32_bf16 v[152:155], v[228:231], v[48:51], v[152:155]
    ds_read_b64_tr_b16 v[224:225], v248 offset:20480
    ds_read_b64_tr_b16 v[226:227], v248 offset:20992
    v_mfma_f32_16x16x32_bf16 v[156:159], v[228:231], v[52:55], v[156:159]
    v_add_f32 v194, 1.0, v194
    v_add_f32 v195, 1.0, v195
    s_waitcnt lgkmcnt(10)
    v_mfma_f32_16x16x32_bf16 v[144:147], v[232:235], v[56:59], v[144:147]
    ds_read_b64_tr_b16 v[228:229], v248 offset:21504
    ds_read_b64_tr_b16 v[230:231], v248 offset:22016
    v_mfma_f32_16x16x32_bf16 v[148:151], v[232:235], v[60:63], v[148:151]
    v_rcp_f32 v192, v192
    v_mfma_f32_16x16x32_bf16 v[152:155], v[236:239], v[56:59], v[152:155]
    ds_read_b64_tr_b16 v[232:233], v248 offset:22528
    ds_read_b64_tr_b16 v[234:235], v248 offset:23040
    v_mfma_f32_16x16x32_bf16 v[156:159], v[236:239], v[60:63], v[156:159]
    v_rcp_f32 v193, v193
    s_cmp_ge_u32 s28, 4
    s_cbranch_scc1 L_sequential_preLN__spectral_fnet__glu_gated_glu__prompt_noearly_26
    s_add_u32 m0, s49, 69632
    s_nop 0
    buffer_load_dwordx4 v252, s[24:27], s83 offen offset:0 sc1 lds
    buffer_load_dwordx4 v252, s[24:27], s83 offen offset:1024 sc1 lds
    buffer_load_dwordx4 v252, s[24:27], s83 offen offset:2048 sc1 lds
    buffer_load_dwordx4 v252, s[24:27], s83 offen offset:3072 sc1 lds
L_sequential_preLN__spectral_fnet__glu_gated_glu__prompt_noearly_26:
    s_waitcnt lgkmcnt(10)
    v_mfma_f32_16x16x32_bf16 v[144:147], v[208:211], v[64:67], v[144:147]
    ds_read_b64_tr_b16 v[236:237], v248 offset:23552
    ds_read_b64_tr_b16 v[238:239], v248 offset:24064
    v_mfma_f32_16x16x32_bf16 v[148:151], v[208:211], v[68:71], v[148:151]
    v_rcp_f32 v194, v194
    v_mfma_f32_16x16x32_bf16 v[152:155], v[212:215], v[64:67], v[152:155]
    ds_read_b64_tr_b16 v[208:209], v248 offset:24576
    ds_read_b64_tr_b16 v[210:211], v248 offset:25088
    v_mfma_f32_16x16x32_bf16 v[156:159], v[212:215], v[68:71], v[156:159]
    v_rcp_f32 v195, v195
    s_waitcnt lgkmcnt(10)
    v_mfma_f32_16x16x32_bf16 v[144:147], v[216:219], v[72:75], v[144:147]
    ds_read_b64_tr_b16 v[212:213], v248 offset:25600
    ds_read_b64_tr_b16 v[214:215], v248 offset:26112
    v_mfma_f32_16x16x32_bf16 v[148:151], v[216:219], v[76:79], v[148:151]
    v_mul_f32 v192, v192, v200
    v_mul_f32 v193, v193, v201
    v_mfma_f32_16x16x32_bf16 v[152:155], v[220:223], v[72:75], v[152:155]
    ds_read_b64_tr_b16 v[216:217], v248 offset:26624
    ds_read_b64_tr_b16 v[218:219], v248 offset:27136
    v_mfma_f32_16x16x32_bf16 v[156:159], v[220:223], v[76:79], v[156:159]
    v_mul_f32 v194, v194, v202
    v_mul_f32 v195, v195, v203
    s_cmp_ge_u32 s28, 4
    s_cbranch_scc1 L_sequential_preLN__spectral_fnet__glu_gated_glu__prompt_noearly_27
    s_add_u32 m0, s56, 69632
    s_mov_b64 exec, s[40:41]
    buffer_load_dwordx4 v252, s[12:15], s85 offen lds
    s_add_u32 m0, s48, 69632
    s_mov_b64 exec, -1
    buffer_load_dwordx4 v160, s[16:19], s84 offen offset:0 lds
    s_add_u32 s83, s83, 8192
    s_add_u32 s85, s85, 4096
    buffer_load_dwordx4 v161, s[16:19], s84 offen offset:1024 lds
    buffer_load_dwordx4 v162, s[16:19], s84 offen offset:2048 lds
    buffer_load_dwordx4 v163, s[16:19], s84 offen offset:3072 lds
    s_add_u32 s84, s84, 36864
L_sequential_preLN__spectral_fnet__glu_gated_glu__prompt_noearly_27:
    s_waitcnt lgkmcnt(10)
    v_mfma_f32_16x16x32_bf16 v[144:147], v[224:227], v[80:83], v[144:147]
    ds_read_b64_tr_b16 v[220:221], v248 offset:27648
    ds_read_b64_tr_b16 v[222:223], v248 offset:28160
    v_mfma_f32_16x16x32_bf16 v[148:151], v[224:227], v[84:87], v[148:151]
    v_cvt_pk_bf16_f32 v242, v192, v193
    v_cvt_pk_bf16_f32 v243, v194, v195
    v_mfma_f32_16x16x32_bf16 v[152:155], v[228:231], v[80:83], v[152:155]
    ds_read_b64_tr_b16 v[224:225], v248 offset:28672
    ds_read_b64_tr_b16 v[226:227], v248 offset:29184
    v_mfma_f32_16x16x32_bf16 v[156:159], v[228:231], v[84:87], v[156:159]
    v_mul_f32 v196, 0xbfb8aa3b, v196
    v_mul_f32 v197, 0xbfb8aa3b, v197
    s_waitcnt lgkmcnt(10)
    v_mfma_f32_16x16x32_bf16 v[144:147], v[232:235], v[88:91], v[144:147]
    ds_read_b64_tr_b16 v[228:229], v248 offset:29696
    ds_read_b64_tr_b16 v[230:231], v248 offset:30208
    v_mfma_f32_16x16x32_bf16 v[148:151], v[232:235], v[92:95], v[148:151]
    v_mul_f32 v198, 0xbfb8aa3b, v198
    v_mul_f32 v199, 0xbfb8aa3b, v199
    v_mfma_f32_16x16x32_bf16 v[152:155], v[236:239], v[88:91], v[152:155]
    ds_read_b64_tr_b16 v[232:233], v248 offset:30720
    ds_read_b64_tr_b16 v[234:235], v248 offset:31232
    v_mfma_f32_16x16x32_bf16 v[156:159], v[236:239], v[92:95], v[156:159]
    v_exp_f32 v196, v196
    s_cmp_ge_u32 s28, 4
    s_cbranch_scc1 L_sequential_preLN__spectral_fnet__glu_gated_glu__prompt_noearly_28
    s_add_u32 m0, s49, 104448
    s_nop 0
    buffer_load_dwordx4 v252, s[24:27], s86 offen offset:0 sc1 lds
    buffer_load_dwordx4 v252, s[24:27], s86 offen offset:1024 sc1 lds
    buffer_load_dwordx4 v252, s[24:27], s86 offen offset:2048 sc1 lds
    buffer_load_dwordx4 v252, s[24:27], s86 offen offset:3072 sc1 lds
L_sequential_preLN__spectral_fnet__glu_gated_glu__prompt_noearly_28:
    s_waitcnt lgkmcnt(10)
    v_mfma_f32_16x16x32_bf16 v[144:147], v[208:211], v[96:99], v[144:147]
    ds_read_b64_tr_b16 v[236:237], v248 offset:31744
    ds_read_b64_tr_b16 v[238:239], v248 offset:32256
    v_mfma_f32_16x16x32_bf16 v[148:151], v[208:211], v[100:103], v[148:151]
    v_exp_f32 v197, v197
    v_mfma_f32_16x16x32_bf16 v[152:155], v[212:215], v[96:99], v[152:155]
    ds_read_b64_tr_b16 v[208:209], v248 offset:32768
    ds_read_b64_tr_b16 v[210:211], v248 offset:33280
    v_mfma_f32_16x16x32_bf16 v[156:159], v[212:215], v[100:103], v[156:159]
    v_exp_f32 v198, v198
    s_waitcnt lgkmcnt(10)
    v_mfma_f32_16x16x32_bf16 v[144:147], v[216:219], v[104:107], v[144:147]
    ds_read_b64_tr_b16 v[212:213], v248 offset:33792
    ds_read_b64_tr_b16 v[214:215], v248 offset:34304
    v_mfma_f32_16x16x32_bf16 v[148:151], v[216:219], v[108:111], v[148:151]
    v_exp_f32 v199, v199
    v_mfma_f32_16x16x32_bf16 v[152:155], v[220:223], v[104:107], v[152:155]
    ds_read_b64_tr_b16 v[216:217], v248 offset:34816
    ds_read_b64_tr_b16 v[218:219], v248 offset:35328
    v_mfma_f32_16x16x32_bf16 v[156:159], v[220:223], v[108:111], v[156:159]
    v_add_f32 v196, 1.0, v196
    v_add_f32 v197, 1.0, v197
    s_cmp_ge_u32 s28, 4
    s_cbranch_scc1 L_sequential_preLN__spectral_fnet__glu_gated_glu__prompt_noearly_29
    s_add_u32 m0, s56, 104448
    s_mov_b64 exec, s[40:41]
    buffer_load_dwordx4 v252, s[12:15], s88 offen lds
    s_add_u32 m0, s48, 104448
    s_mov_b64 exec, -1
    buffer_load_dwordx4 v160, s[16:19], s87 offen offset:0 lds
    s_add_u32 s86, s86, 8192
    s_add_u32 s88, s88, 4096
    buffer_load_dwordx4 v161, s[16:19], s87 offen offset:1024 lds
    buffer_load_dwordx4 v162, s[16:19], s87 offen offset:2048 lds
    buffer_load_dwordx4 v163, s[16:19], s87 offen offset:3072 lds
    s_add_u32 s87, s87, 36864
L_sequential_preLN__spectral_fnet__glu_gated_glu__prompt_noearly_29:
    s_waitcnt lgkmcnt(10)
    v_mfma_f32_16x16x32_bf16 v[144:147], v[224:227], v[112:115], v[144:147]
    ds_read_b64_tr_b16 v[220:221], v248 offset:35840
    ds_read_b64_tr_b16 v[222:223], v248 offset:36352
    v_mfma_f32_16x16x32_bf16 v[148:151], v[224:227], v[116:119], v[148:151]
    v_add_f32 v198, 1.0, v198
    v_add_f32 v199, 1.0, v199
    v_mfma_f32_16x16x32_bf16 v[152:155], v[228:231], v[112:115], v[152:155]
    v_mfma_f32_16x16x32_bf16 v[156:159], v[228:231], v[116:119], v[156:159]
    v_rcp_f32 v196, v196
    s_waitcnt lgkmcnt(8)
    v_mfma_f32_16x16x32_bf16 v[144:147], v[232:235], v[120:123], v[144:147]
    v_mfma_f32_16x16x32_bf16 v[148:151], v[232:235], v[124:127], v[148:151]
    v_rcp_f32 v197, v197
    v_mfma_f32_16x16x32_bf16 v[152:155], v[236:239], v[120:123], v[152:155]
    v_mfma_f32_16x16x32_bf16 v[156:159], v[236:239], v[124:127], v[156:159]
    v_rcp_f32 v198, v198
    s_waitcnt lgkmcnt(4)
    v_mfma_f32_16x16x32_bf16 v[144:147], v[208:211], v[128:131], v[144:147]
    v_mfma_f32_16x16x32_bf16 v[148:151], v[208:211], v[132:135], v[148:151]
    v_rcp_f32 v199, v199
    v_mfma_f32_16x16x32_bf16 v[152:155], v[212:215], v[128:131], v[152:155]
    v_mfma_f32_16x16x32_bf16 v[156:159], v[212:215], v[132:135], v[156:159]
    v_mul_f32 v196, v196, v204
    v_mul_f32 v197, v197, v205
    s_waitcnt lgkmcnt(0)
    v_mfma_f32_16x16x32_bf16 v[144:147], v[216:219], v[136:139], v[144:147]
    v_mfma_f32_16x16x32_bf16 v[148:151], v[216:219], v[140:143], v[148:151]
    v_mul_f32 v198, v198, v206
    v_mul_f32 v199, v199, v207
    v_mfma_f32_16x16x32_bf16 v[152:155], v[220:223], v[136:139], v[152:155]
    v_mfma_f32_16x16x32_bf16 v[156:159], v[220:223], v[140:143], v[156:159]
    v_cvt_pk_bf16_f32 v246, v196, v197
    v_cvt_pk_bf16_f32 v247, v198, v199
    s_cmp_lt_u32 s28, 4
    s_cbranch_scc1 L_k4f_loader
    s_waitcnt lgkmcnt(0)
    s_add_u32 s46, s50, 24576
    buffer_store_dwordx4 v[240:243], v252, s[24:27], s46 offen offset:0 sc1
    buffer_store_dwordx4 v[244:247], v252, s[24:27], s46 offen offset:1024 sc1
    v_lshrrev_b32 v10, 6, v252
    v_and_b32 v12, 7, v10
    v_lshlrev_b32 v10, 8, v10
    v_bfe_u32 v11, v252, 4, 2
    v_lshl_add_u32 v10, v11, 3, v10
    v_add_u32 v10, 2048, v10
    s_lshl_b32 s46, s45, 2
    v_xor_b32 v12, s46, v12
    v_xor_b32 v11, 0, v12
    v_lshl_add_u32 v176, v11, 5, v10
    v_xor_b32 v11, 1, v12
    v_lshl_add_u32 v177, v11, 5, v10
    v_xor_b32 v11, 2, v12
    v_lshl_add_u32 v178, v11, 5, v10
    v_xor_b32 v11, 3, v12
    v_lshl_add_u32 v179, v11, 5, v10
    v_lshrrev_b32 v11, 1, v252
    v_add_u32 v180, 18432, v11
    s_lshl_b32 s46, s44, 12
    s_add_u32 s46, s46, 20480
    s_lshl_b32 s63, s45, 1
    s_xor_b32 s63, s63, s30
    s_lshl_b32 s50, s63, 10
    v_add_u32 v11, s46, v252
    v_add_u32 v181, s50, v11
    s_xor_b32 s48, s50, 1024
    v_add_u32 v182, s48, v11
    s_xor_b32 s48, s50, 2048
    v_add_u32 v183, s48, v11
    s_xor_b32 s48, s50, 3072
    v_add_u32 v184, s48, v11
    s_mov_b32 s52, 0
    s_setprio 2
    s_barrier
    ds_read_b64_tr_b16 v[72:73], v176 offset:34816
    ds_read_b64_tr_b16 v[74:75], v176 offset:38912
    ds_read_b128 v[92:95], v181 offset:34816
    ds_read_b128 v[96:99], v182 offset:34816
    ds_read_b128 v[100:103], v183 offset:34816
    ds_read_b128 v[104:107], v184 offset:34816
    ds_read_b64_tr_b16 v[76:77], v177 offset:34816
    ds_read_b64_tr_b16 v[78:79], v177 offset:38912
    ds_read_b64_tr_b16 v[80:81], v178 offset:34816
    ds_read_b64_tr_b16 v[82:83], v178 offset:38912
    ds_read_b64_tr_b16 v[84:85], v179 offset:34816
    ds_read_b64_tr_b16 v[86:87], v179 offset:38912
    ds_read_b64_tr_b16 v[88:89], v180 offset:34816
    ds_read_b64_tr_b16 v[90:91], v180 offset:35328
    v_add_u32 v212, 69632, v176
    v_add_u32 v213, 69632, v177
    v_add_u32 v214, 69632, v178
    v_add_u32 v215, 69632, v179
    v_add_u32 v216, 69632, v180
    v_add_u32 v217, 69632, v181
    v_add_u32 v218, 69632, v182
    v_add_u32 v219, 69632, v183
    v_add_u32 v220, 69632, v184
    v_mul_f32 v144, 0xbfb8aa3b, v144
    v_mul_f32 v145, 0xbfb8aa3b, v145
    v_mul_f32 v146, 0xbfb8aa3b, v146
    v_mul_f32 v147, 0xbfb8aa3b, v147
    v_exp_f32 v144, v144
    v_exp_f32 v145, v145
    v_exp_f32 v146, v146
    v_exp_f32 v147, v147
    v_add_f32 v144, 1.0, v144
    v_add_f32 v145, 1.0, v145
    v_add_f32 v146, 1.0, v146
    v_add_f32 v147, 1.0, v147
    v_rcp_f32 v144, v144
    v_rcp_f32 v145, v145
    v_rcp_f32 v146, v146
    v_rcp_f32 v147, v147
    v_mul_f32 v144, v144, v152
    v_mul_f32 v145, v145, v153
    v_mul_f32 v146, v146, v154
    v_mul_f32 v147, v147, v155
    v_cvt_pk_bf16_f32 v208, v144, v145
    v_cvt_pk_bf16_f32 v209, v146, v147
    v_mul_f32 v148, 0xbfb8aa3b, v148
    v_mul_f32 v149, 0xbfb8aa3b, v149
    v_mul_f32 v150, 0xbfb8aa3b, v150
    v_mul_f32 v151, 0xbfb8aa3b, v151
    v_exp_f32 v148, v148
    v_exp_f32 v149, v149
    v_exp_f32 v150, v150
    v_exp_f32 v151, v151
    v_add_f32 v148, 1.0, v148
    v_add_f32 v149, 1.0, v149
    v_add_f32 v150, 1.0, v150
    v_add_f32 v151, 1.0, v151
    v_rcp_f32 v148, v148
    v_rcp_f32 v149, v149
    v_rcp_f32 v150, v150
    v_rcp_f32 v151, v151
    v_mul_f32 v148, v148, v156
    v_mul_f32 v149, v149, v157
    v_mul_f32 v150, v150, v158
    v_mul_f32 v151, v151, v159
    v_cvt_pk_bf16_f32 v210, v148, v149
    v_cvt_pk_bf16_f32 v211, v150, v151
    s_nop 1
    v_permlane16_swap_b32 v208, v210
    v_permlane16_swap_b32 v209, v211
    s_nop 1
    buffer_store_dwordx4 v[208:211], v249, s[24:27], s51 offen sc1
    s_waitcnt lgkmcnt(0)
    v_mfma_f32_16x16x32_bf16 v[0:3], v[72:75], v[92:95], 0
    ds_read_b64_tr_b16 v[108:109], v176 offset:43008
    ds_read_b64_tr_b16 v[110:111], v176 offset:47104
    v_mfma_f32_16x16x32_bf16 v[4:7], v[72:75], v[96:99], 0
    ds_read_b128 v[128:131], v181 offset:43008
    ds_read_b128 v[132:135], v182 offset:43008
    v_mfma_f32_16x16x32_bf16 v[8:11], v[72:75], v[100:103], 0
    ds_read_b128 v[136:139], v183 offset:43008
    ds_read_b128 v[140:143], v184 offset:43008
    v_mfma_f32_16x16x32_bf16 v[12:15], v[72:75], v[104:107], 0
    ds_read_b64_tr_b16 v[112:113], v177 offset:43008
    ds_read_b64_tr_b16 v[114:115], v177 offset:47104
    v_mfma_f32_16x16x32_bf16 v[16:19], v[76:79], v[92:95], 0
    ds_read_b64_tr_b16 v[116:117], v178 offset:43008
    v_mfma_f32_16x16x32_bf16 v[20:23], v[76:79], v[96:99], 0
    ds_read_b64_tr_b16 v[118:119], v178 offset:47104
    v_mfma_f32_16x16x32_bf16 v[24:27], v[76:79], v[100:103], 0
    ds_read_b64_tr_b16 v[120:121], v179 offset:43008
    v_mfma_f32_16x16x32_bf16 v[28:31], v[76:79], v[104:107], 0
    ds_read_b64_tr_b16 v[122:123], v179 offset:47104
    v_mfma_f32_16x16x32_bf16 v[32:35], v[80:83], v[92:95], 0
    ds_read_b64_tr_b16 v[124:125], v180 offset:35840
    v_mfma_f32_16x16x32_bf16 v[36:39], v[80:83], v[96:99], 0
    ds_read_b64_tr_b16 v[126:127], v180 offset:36352
    v_mfma_f32_16x16x32_bf16 v[40:43], v[80:83], v[100:103], 0
    v_mfma_f32_16x16x32_bf16 v[44:47], v[80:83], v[104:107], 0
    v_mfma_f32_16x16x32_bf16 v[48:51], v[84:87], v[92:95], 0
    v_mfma_f32_16x16x32_bf16 v[52:55], v[84:87], v[96:99], 0
    v_mfma_f32_16x16x32_bf16 v[56:59], v[84:87], v[100:103], 0
    v_mfma_f32_16x16x32_bf16 v[60:63], v[84:87], v[104:107], 0
    v_mfma_f32_16x16x32_bf16 v[64:67], v[88:91], v[92:95], 0
    v_mfma_f32_16x16x32_bf16 v[68:71], v[88:91], v[96:99], 0
    s_waitcnt lgkmcnt(0)
    s_barrier
    v_mfma_f32_16x16x32_bf16 v[0:3], v[108:111], v[128:131], v[0:3]
    ds_read_b64_tr_b16 v[72:73], v212 offset:0
    ds_read_b64_tr_b16 v[74:75], v212 offset:4096
    v_mfma_f32_16x16x32_bf16 v[4:7], v[108:111], v[132:135], v[4:7]
    ds_read_b128 v[92:95], v217 offset:0
    ds_read_b128 v[96:99], v218 offset:0
    v_mfma_f32_16x16x32_bf16 v[8:11], v[108:111], v[136:139], v[8:11]
    ds_read_b128 v[100:103], v219 offset:0
    ds_read_b128 v[104:107], v220 offset:0
    v_mfma_f32_16x16x32_bf16 v[12:15], v[108:111], v[140:143], v[12:15]
    ds_read_b64_tr_b16 v[76:77], v213 offset:0
    ds_read_b64_tr_b16 v[78:79], v213 offset:4096
    v_mfma_f32_16x16x32_bf16 v[16:19], v[112:115], v[128:131], v[16:19]
    ds_read_b64_tr_b16 v[80:81], v214 offset:0
    v_mfma_f32_16x16x32_bf16 v[20:23], v[112:115], v[132:135], v[20:23]
    ds_read_b64_tr_b16 v[82:83], v214 offset:4096
    v_mfma_f32_16x16x32_bf16 v[24:27], v[112:115], v[136:139], v[24:27]
    ds_read_b64_tr_b16 v[84:85], v215 offset:0
    v_mfma_f32_16x16x32_bf16 v[28:31], v[112:115], v[140:143], v[28:31]
    ds_read_b64_tr_b16 v[86:87], v215 offset:4096
    v_mfma_f32_16x16x32_bf16 v[32:35], v[116:119], v[128:131], v[32:35]
    ds_read_b64_tr_b16 v[88:89], v216 offset:0
    v_mfma_f32_16x16x32_bf16 v[36:39], v[116:119], v[132:135], v[36:39]
    ds_read_b64_tr_b16 v[90:91], v216 offset:512
    v_mfma_f32_16x16x32_bf16 v[40:43], v[116:119], v[136:139], v[40:43]
    v_mfma_f32_16x16x32_bf16 v[44:47], v[116:119], v[140:143], v[44:47]
    v_mfma_f32_16x16x32_bf16 v[48:51], v[120:123], v[128:131], v[48:51]
    v_mfma_f32_16x16x32_bf16 v[52:55], v[120:123], v[132:135], v[52:55]
    v_mfma_f32_16x16x32_bf16 v[56:59], v[120:123], v[136:139], v[56:59]
    v_mfma_f32_16x16x32_bf16 v[60:63], v[120:123], v[140:143], v[60:63]
    v_mfma_f32_16x16x32_bf16 v[64:67], v[124:127], v[128:131], v[64:67]
    v_mfma_f32_16x16x32_bf16 v[68:71], v[124:127], v[132:135], v[68:71]
L_k4f_loop:
    s_waitcnt lgkmcnt(0)
    v_mfma_f32_16x16x32_bf16 v[0:3], v[72:75], v[92:95], v[0:3]
    ds_read_b64_tr_b16 v[108:109], v212 offset:8192
    ds_read_b64_tr_b16 v[110:111], v212 offset:12288
    v_mfma_f32_16x16x32_bf16 v[4:7], v[72:75], v[96:99], v[4:7]
    ds_read_b128 v[128:131], v217 offset:8192
    ds_read_b128 v[132:135], v218 offset:8192
    v_mfma_f32_16x16x32_bf16 v[8:11], v[72:75], v[100:103], v[8:11]
    ds_read_b128 v[136:139], v219 offset:8192
    ds_read_b128 v[140:143], v220 offset:8192
    v_mfma_f32_16x16x32_bf16 v[12:15], v[72:75], v[104:107], v[12:15]
    ds_read_b64_tr_b16 v[112:113], v213 offset:8192
    ds_read_b64_tr_b16 v[114:115], v213 offset:12288
    v_mfma_f32_16x16x32_bf16 v[16:19], v[76:79], v[92:95], v[16:19]
    ds_read_b64_tr_b16 v[116:117], v214 offset:8192
    v_mfma_f32_16x16x32_bf16 v[20:23], v[76:79], v[96:99], v[20:23]
    ds_read_b64_tr_b16 v[118:119], v214 offset:12288
    v_mfma_f32_16x16x32_bf16 v[24:27], v[76:79], v[100:103], v[24:27]
    ds_read_b64_tr_b16 v[120:121], v215 offset:8192
    v_mfma_f32_16x16x32_bf16 v[28:31], v[76:79], v[104:107], v[28:31]
    ds_read_b64_tr_b16 v[122:123], v215 offset:12288
    v_mfma_f32_16x16x32_bf16 v[32:35], v[80:83], v[92:95], v[32:35]
    ds_read_b64_tr_b16 v[124:125], v216 offset:1024
    v_mfma_f32_16x16x32_bf16 v[36:39], v[80:83], v[96:99], v[36:39]
    ds_read_b64_tr_b16 v[126:127], v216 offset:1536
    v_mfma_f32_16x16x32_bf16 v[40:43], v[80:83], v[100:103], v[40:43]
    v_mfma_f32_16x16x32_bf16 v[44:47], v[80:83], v[104:107], v[44:47]
    v_mfma_f32_16x16x32_bf16 v[48:51], v[84:87], v[92:95], v[48:51]
    v_mfma_f32_16x16x32_bf16 v[52:55], v[84:87], v[96:99], v[52:55]
    v_mfma_f32_16x16x32_bf16 v[56:59], v[84:87], v[100:103], v[56:59]
    v_mfma_f32_16x16x32_bf16 v[60:63], v[84:87], v[104:107], v[60:63]
    v_mfma_f32_16x16x32_bf16 v[64:67], v[88:91], v[92:95], v[64:67]
    v_mfma_f32_16x16x32_bf16 v[68:71], v[88:91], v[96:99], v[68:71]
    s_waitcnt lgkmcnt(0)
    s_barrier
    v_mfma_f32_16x16x32_bf16 v[0:3], v[108:111], v[128:131], v[0:3]
    ds_read_b64_tr_b16 v[72:73], v212 offset:34816
    ds_read_b64_tr_b16 v[74:75], v212 offset:38912
    v_mfma_f32_16x16x32_bf16 v[4:7], v[108:111], v[132:135], v[4:7]
    ds_read_b128 v[92:95], v217 offset:34816
    ds_read_b128 v[96:99], v218 offset:34816
    v_mfma_f32_16x16x32_bf16 v[8:11], v[108:111], v[136:139], v[8:11]
    ds_read_b128 v[100:103], v219 offset:34816
    ds_read_b128 v[104:107], v220 offset:34816
    v_mfma_f32_16x16x32_bf16 v[12:15], v[108:111], v[140:143], v[12:15]
    ds_read_b64_tr_b16 v[76:77], v213 offset:34816
    ds_read_b64_tr_b16 v[78:79], v213 offset:38912
    v_mfma_f32_16x16x32_bf16 v[16:19], v[112:115], v[128:131], v[16:19]
    ds_read_b64_tr_b16 v[80:81], v214 offset:34816
    v_mfma_f32_16x16x32_bf16 v[20:23], v[112:115], v[132:135], v[20:23]
    ds_read_b64_tr_b16 v[82:83], v214 offset:38912
    v_mfma_f32_16x16x32_bf16 v[24:27], v[112:115], v[136:139], v[24:27]
    ds_read_b64_tr_b16 v[84:85], v215 offset:34816
    v_mfma_f32_16x16x32_bf16 v[28:31], v[112:115], v[140:143], v[28:31]
    ds_read_b64_tr_b16 v[86:87], v215 offset:38912
    v_mfma_f32_16x16x32_bf16 v[32:35], v[116:119], v[128:131], v[32:35]
    ds_read_b64_tr_b16 v[88:89], v216 offset:34816
    v_mfma_f32_16x16x32_bf16 v[36:39], v[116:119], v[132:135], v[36:39]
    ds_read_b64_tr_b16 v[90:91], v216 offset:35328
    v_mfma_f32_16x16x32_bf16 v[40:43], v[116:119], v[136:139], v[40:43]
    s_cmp_eq_u32 s52, 4
    v_mfma_f32_16x16x32_bf16 v[44:47], v[116:119], v[140:143], v[44:47]
    v_mfma_f32_16x16x32_bf16 v[48:51], v[120:123], v[128:131], v[48:51]
    v_mfma_f32_16x16x32_bf16 v[52:55], v[120:123], v[132:135], v[52:55]
    v_mfma_f32_16x16x32_bf16 v[56:59], v[120:123], v[136:139], v[56:59]
    v_mfma_f32_16x16x32_bf16 v[60:63], v[120:123], v[140:143], v[60:63]
    v_mfma_f32_16x16x32_bf16 v[64:67], v[124:127], v[128:131], v[64:67]
    v_mfma_f32_16x16x32_bf16 v[68:71], v[124:127], v[132:135], v[68:71]
    s_cbranch_scc1 L_k4f_done
    s_waitcnt lgkmcnt(0)
    v_mfma_f32_16x16x32_bf16 v[0:3], v[72:75], v[92:95], v[0:3]
    ds_read_b64_tr_b16 v[108:109], v212 offset:43008
    ds_read_b64_tr_b16 v[110:111], v212 offset:47104
    v_mfma_f32_16x16x32_bf16 v[4:7], v[72:75], v[96:99], v[4:7]
    ds_read_b128 v[128:131], v217 offset:43008
    ds_read_b128 v[132:135], v218 offset:43008
    v_mfma_f32_16x16x32_bf16 v[8:11], v[72:75], v[100:103], v[8:11]
    ds_read_b128 v[136:139], v219 offset:43008
    ds_read_b128 v[140:143], v220 offset:43008
    v_mfma_f32_16x16x32_bf16 v[12:15], v[72:75], v[104:107], v[12:15]
    ds_read_b64_tr_b16 v[112:113], v213 offset:43008
    ds_read_b64_tr_b16 v[114:115], v213 offset:47104
    v_mfma_f32_16x16x32_bf16 v[16:19], v[76:79], v[92:95], v[16:19]
    ds_read_b64_tr_b16 v[116:117], v214 offset:43008
    v_mfma_f32_16x16x32_bf16 v[20:23], v[76:79], v[96:99], v[20:23]
    ds_read_b64_tr_b16 v[118:119], v214 offset:47104
    v_mfma_f32_16x16x32_bf16 v[24:27], v[76:79], v[100:103], v[24:27]
    ds_read_b64_tr_b16 v[120:121], v215 offset:43008
    v_mfma_f32_16x16x32_bf16 v[28:31], v[76:79], v[104:107], v[28:31]
    ds_read_b64_tr_b16 v[122:123], v215 offset:47104
    v_mfma_f32_16x16x32_bf16 v[32:35], v[80:83], v[92:95], v[32:35]
    ds_read_b64_tr_b16 v[124:125], v216 offset:35840
    v_mfma_f32_16x16x32_bf16 v[36:39], v[80:83], v[96:99], v[36:39]
    ds_read_b64_tr_b16 v[126:127], v216 offset:36352
    v_mfma_f32_16x16x32_bf16 v[40:43], v[80:83], v[100:103], v[40:43]
    v_mfma_f32_16x16x32_bf16 v[44:47], v[80:83], v[104:107], v[44:47]
    v_mfma_f32_16x16x32_bf16 v[48:51], v[84:87], v[92:95], v[48:51]
    v_mfma_f32_16x16x32_bf16 v[52:55], v[84:87], v[96:99], v[52:55]
    v_mfma_f32_16x16x32_bf16 v[56:59], v[84:87], v[100:103], v[56:59]
    v_mfma_f32_16x16x32_bf16 v[60:63], v[84:87], v[104:107], v[60:63]
    v_mfma_f32_16x16x32_bf16 v[64:67], v[88:91], v[92:95], v[64:67]
    v_mfma_f32_16x16x32_bf16 v[68:71], v[88:91], v[96:99], v[68:71]
    s_waitcnt lgkmcnt(0)
    s_barrier
    v_mfma_f32_16x16x32_bf16 v[0:3], v[108:111], v[128:131], v[0:3]
    ds_read_b64_tr_b16 v[72:73], v176 offset:0
    ds_read_b64_tr_b16 v[74:75], v176 offset:4096
    v_mfma_f32_16x16x32_bf16 v[4:7], v[108:111], v[132:135], v[4:7]
    ds_read_b128 v[92:95], v181 offset:0
    ds_read_b128 v[96:99], v182 offset:0
    v_mfma_f32_16x16x32_bf16 v[8:11], v[108:111], v[136:139], v[8:11]
    ds_read_b128 v[100:103], v183 offset:0
    ds_read_b128 v[104:107], v184 offset:0
    v_mfma_f32_16x16x32_bf16 v[12:15], v[108:111], v[140:143], v[12:15]
    ds_read_b64_tr_b16 v[76:77], v177 offset:0
    ds_read_b64_tr_b16 v[78:79], v177 offset:4096
    v_mfma_f32_16x16x32_bf16 v[16:19], v[112:115], v[128:131], v[16:19]
    ds_read_b64_tr_b16 v[80:81], v178 offset:0
    v_mfma_f32_16x16x32_bf16 v[20:23], v[112:115], v[132:135], v[20:23]
    ds_read_b64_tr_b16 v[82:83], v178 offset:4096
    v_mfma_f32_16x16x32_bf16 v[24:27], v[112:115], v[136:139], v[24:27]
    ds_read_b64_tr_b16 v[84:85], v179 offset:0
    v_mfma_f32_16x16x32_bf16 v[28:31], v[112:115], v[140:143], v[28:31]
    ds_read_b64_tr_b16 v[86:87], v179 offset:4096
    v_mfma_f32_16x16x32_bf16 v[32:35], v[116:119], v[128:131], v[32:35]
    ds_read_b64_tr_b16 v[88:89], v180 offset:0
    v_mfma_f32_16x16x32_bf16 v[36:39], v[116:119], v[132:135], v[36:39]
    ds_read_b64_tr_b16 v[90:91], v180 offset:512
    v_mfma_f32_16x16x32_bf16 v[40:43], v[116:119], v[136:139], v[40:43]
    v_mfma_f32_16x16x32_bf16 v[44:47], v[116:119], v[140:143], v[44:47]
    v_mfma_f32_16x16x32_bf16 v[48:51], v[120:123], v[128:131], v[48:51]
    v_mfma_f32_16x16x32_bf16 v[52:55], v[120:123], v[132:135], v[52:55]
    v_mfma_f32_16x16x32_bf16 v[56:59], v[120:123], v[136:139], v[56:59]
    v_mfma_f32_16x16x32_bf16 v[60:63], v[120:123], v[140:143], v[60:63]
    v_mfma_f32_16x16x32_bf16 v[64:67], v[124:127], v[128:131], v[64:67]
    v_mfma_f32_16x16x32_bf16 v[68:71], v[124:127], v[132:135], v[68:71]
    s_waitcnt lgkmcnt(0)
    v_mfma_f32_16x16x32_bf16 v[0:3], v[72:75], v[92:95], v[0:3]
    ds_read_b64_tr_b16 v[108:109], v176 offset:8192
    ds_read_b64_tr_b16 v[110:111], v176 offset:12288
    v_mfma_f32_16x16x32_bf16 v[4:7], v[72:75], v[96:99], v[4:7]
    ds_read_b128 v[128:131], v181 offset:8192
    ds_read_b128 v[132:135], v182 offset:8192
    v_mfma_f32_16x16x32_bf16 v[8:11], v[72:75], v[100:103], v[8:11]
    ds_read_b128 v[136:139], v183 offset:8192
    ds_read_b128 v[140:143], v184 offset:8192
    v_mfma_f32_16x16x32_bf16 v[12:15], v[72:75], v[104:107], v[12:15]
    ds_read_b64_tr_b16 v[112:113], v177 offset:8192
    ds_read_b64_tr_b16 v[114:115], v177 offset:12288
    v_mfma_f32_16x16x32_bf16 v[16:19], v[76:79], v[92:95], v[16:19]
    ds_read_b64_tr_b16 v[116:117], v178 offset:8192
    v_mfma_f32_16x16x32_bf16 v[20:23], v[76:79], v[96:99], v[20:23]
    ds_read_b64_tr_b16 v[118:119], v178 offset:12288
    v_mfma_f32_16x16x32_bf16 v[24:27], v[76:79], v[100:103], v[24:27]
    ds_read_b64_tr_b16 v[120:121], v179 offset:8192
    v_mfma_f32_16x16x32_bf16 v[28:31], v[76:79], v[104:107], v[28:31]
    ds_read_b64_tr_b16 v[122:123], v179 offset:12288
    v_mfma_f32_16x16x32_bf16 v[32:35], v[80:83], v[92:95], v[32:35]
    ds_read_b64_tr_b16 v[124:125], v180 offset:1024
    v_mfma_f32_16x16x32_bf16 v[36:39], v[80:83], v[96:99], v[36:39]
    ds_read_b64_tr_b16 v[126:127], v180 offset:1536
    v_mfma_f32_16x16x32_bf16 v[40:43], v[80:83], v[100:103], v[40:43]
    v_mfma_f32_16x16x32_bf16 v[44:47], v[80:83], v[104:107], v[44:47]
    v_mfma_f32_16x16x32_bf16 v[48:51], v[84:87], v[92:95], v[48:51]
    v_mfma_f32_16x16x32_bf16 v[52:55], v[84:87], v[96:99], v[52:55]
    v_mfma_f32_16x16x32_bf16 v[56:59], v[84:87], v[100:103], v[56:59]
    v_mfma_f32_16x16x32_bf16 v[60:63], v[84:87], v[104:107], v[60:63]
    v_mfma_f32_16x16x32_bf16 v[64:67], v[88:91], v[92:95], v[64:67]
    v_mfma_f32_16x16x32_bf16 v[68:71], v[88:91], v[96:99], v[68:71]
    s_waitcnt lgkmcnt(0)
    s_barrier
    v_mfma_f32_16x16x32_bf16 v[0:3], v[108:111], v[128:131], v[0:3]
    ds_read_b64_tr_b16 v[72:73], v176 offset:34816
    ds_read_b64_tr_b16 v[74:75], v176 offset:38912
    v_mfma_f32_16x16x32_bf16 v[4:7], v[108:111], v[132:135], v[4:7]
    ds_read_b128 v[92:95], v181 offset:34816
    ds_read_b128 v[96:99], v182 offset:34816
    v_mfma_f32_16x16x32_bf16 v[8:11], v[108:111], v[136:139], v[8:11]
    ds_read_b128 v[100:103], v183 offset:34816
    ds_read_b128 v[104:107], v184 offset:34816
    v_mfma_f32_16x16x32_bf16 v[12:15], v[108:111], v[140:143], v[12:15]
    ds_read_b64_tr_b16 v[76:77], v177 offset:34816
    ds_read_b64_tr_b16 v[78:79], v177 offset:38912
    v_mfma_f32_16x16x32_bf16 v[16:19], v[112:115], v[128:131], v[16:19]
    ds_read_b64_tr_b16 v[80:81], v178 offset:34816
    v_mfma_f32_16x16x32_bf16 v[20:23], v[112:115], v[132:135], v[20:23]
    ds_read_b64_tr_b16 v[82:83], v178 offset:38912
    v_mfma_f32_16x16x32_bf16 v[24:27], v[112:115], v[136:139], v[24:27]
    ds_read_b64_tr_b16 v[84:85], v179 offset:34816
    v_mfma_f32_16x16x32_bf16 v[28:31], v[112:115], v[140:143], v[28:31]
    ds_read_b64_tr_b16 v[86:87], v179 offset:38912
    v_mfma_f32_16x16x32_bf16 v[32:35], v[116:119], v[128:131], v[32:35]
    ds_read_b64_tr_b16 v[88:89], v180 offset:34816
    v_mfma_f32_16x16x32_bf16 v[36:39], v[116:119], v[132:135], v[36:39]
    ds_read_b64_tr_b16 v[90:91], v180 offset:35328
    v_mfma_f32_16x16x32_bf16 v[40:43], v[116:119], v[136:139], v[40:43]
    v_mfma_f32_16x16x32_bf16 v[44:47], v[116:119], v[140:143], v[44:47]
    v_mfma_f32_16x16x32_bf16 v[48:51], v[120:123], v[128:131], v[48:51]
    v_mfma_f32_16x16x32_bf16 v[52:55], v[120:123], v[132:135], v[52:55]
    v_mfma_f32_16x16x32_bf16 v[56:59], v[120:123], v[136:139], v[56:59]
    v_mfma_f32_16x16x32_bf16 v[60:63], v[120:123], v[140:143], v[60:63]
    v_mfma_f32_16x16x32_bf16 v[64:67], v[124:127], v[128:131], v[64:67]
    v_mfma_f32_16x16x32_bf16 v[68:71], v[124:127], v[132:135], v[68:71]
    s_waitcnt lgkmcnt(0)
    v_mfma_f32_16x16x32_bf16 v[0:3], v[72:75], v[92:95], v[0:3]
    ds_read_b64_tr_b16 v[108:109], v176 offset:43008
    ds_read_b64_tr_b16 v[110:111], v176 offset:47104
    v_mfma_f32_16x16x32_bf16 v[4:7], v[72:75], v[96:99], v[4:7]
    ds_read_b128 v[128:131], v181 offset:43008
    ds_read_b128 v[132:135], v182 offset:43008
    v_mfma_f32_16x16x32_bf16 v[8:11], v[72:75], v[100:103], v[8:11]
    ds_read_b128 v[136:139], v183 offset:43008
    ds_read_b128 v[140:143], v184 offset:43008
    v_mfma_f32_16x16x32_bf16 v[12:15], v[72:75], v[104:107], v[12:15]
    ds_read_b64_tr_b16 v[112:113], v177 offset:43008
    ds_read_b64_tr_b16 v[114:115], v177 offset:47104
    v_mfma_f32_16x16x32_bf16 v[16:19], v[76:79], v[92:95], v[16:19]
    ds_read_b64_tr_b16 v[116:117], v178 offset:43008
    v_mfma_f32_16x16x32_bf16 v[20:23], v[76:79], v[96:99], v[20:23]
    ds_read_b64_tr_b16 v[118:119], v178 offset:47104
    v_mfma_f32_16x16x32_bf16 v[24:27], v[76:79], v[100:103], v[24:27]
    ds_read_b64_tr_b16 v[120:121], v179 offset:43008
    v_mfma_f32_16x16x32_bf16 v[28:31], v[76:79], v[104:107], v[28:31]
    ds_read_b64_tr_b16 v[122:123], v179 offset:47104
    v_mfma_f32_16x16x32_bf16 v[32:35], v[80:83], v[92:95], v[32:35]
    ds_read_b64_tr_b16 v[124:125], v180 offset:35840
    v_mfma_f32_16x16x32_bf16 v[36:39], v[80:83], v[96:99], v[36:39]
    ds_read_b64_tr_b16 v[126:127], v180 offset:36352
    v_mfma_f32_16x16x32_bf16 v[40:43], v[80:83], v[100:103], v[40:43]
    v_mfma_f32_16x16x32_bf16 v[44:47], v[80:83], v[104:107], v[44:47]
    v_mfma_f32_16x16x32_bf16 v[48:51], v[84:87], v[92:95], v[48:51]
    v_mfma_f32_16x16x32_bf16 v[52:55], v[84:87], v[96:99], v[52:55]
    v_mfma_f32_16x16x32_bf16 v[56:59], v[84:87], v[100:103], v[56:59]
    v_mfma_f32_16x16x32_bf16 v[60:63], v[84:87], v[104:107], v[60:63]
    v_mfma_f32_16x16x32_bf16 v[64:67], v[88:91], v[92:95], v[64:67]
    v_mfma_f32_16x16x32_bf16 v[68:71], v[88:91], v[96:99], v[68:71]
    s_waitcnt lgkmcnt(0)
    s_barrier
    v_mfma_f32_16x16x32_bf16 v[0:3], v[108:111], v[128:131], v[0:3]
    ds_read_b64_tr_b16 v[72:73], v212 offset:0
    ds_read_b64_tr_b16 v[74:75], v212 offset:4096
    v_mfma_f32_16x16x32_bf16 v[4:7], v[108:111], v[132:135], v[4:7]
    ds_read_b128 v[92:95], v217 offset:0
    ds_read_b128 v[96:99], v218 offset:0
    v_mfma_f32_16x16x32_bf16 v[8:11], v[108:111], v[136:139], v[8:11]
    ds_read_b128 v[100:103], v219 offset:0
    ds_read_b128 v[104:107], v220 offset:0
    v_mfma_f32_16x16x32_bf16 v[12:15], v[108:111], v[140:143], v[12:15]
    ds_read_b64_tr_b16 v[76:77], v213 offset:0
    ds_read_b64_tr_b16 v[78:79], v213 offset:4096
    v_mfma_f32_16x16x32_bf16 v[16:19], v[112:115], v[128:131], v[16:19]
    ds_read_b64_tr_b16 v[80:81], v214 offset:0
    v_mfma_f32_16x16x32_bf16 v[20:23], v[112:115], v[132:135], v[20:23]
    ds_read_b64_tr_b16 v[82:83], v214 offset:4096
    v_mfma_f32_16x16x32_bf16 v[24:27], v[112:115], v[136:139], v[24:27]
    ds_read_b64_tr_b16 v[84:85], v215 offset:0
    v_mfma_f32_16x16x32_bf16 v[28:31], v[112:115], v[140:143], v[28:31]
    ds_read_b64_tr_b16 v[86:87], v215 offset:4096
    v_mfma_f32_16x16x32_bf16 v[32:35], v[116:119], v[128:131], v[32:35]
    ds_read_b64_tr_b16 v[88:89], v216 offset:0
    v_mfma_f32_16x16x32_bf16 v[36:39], v[116:119], v[132:135], v[36:39]
    ds_read_b64_tr_b16 v[90:91], v216 offset:512
    v_mfma_f32_16x16x32_bf16 v[40:43], v[116:119], v[136:139], v[40:43]
    s_add_u32 s52, s52, 1
    v_mfma_f32_16x16x32_bf16 v[44:47], v[116:119], v[140:143], v[44:47]
    s_cmp_ge_u32 s52, 2
    v_mfma_f32_16x16x32_bf16 v[48:51], v[120:123], v[128:131], v[48:51]
    v_mfma_f32_16x16x32_bf16 v[52:55], v[120:123], v[132:135], v[52:55]
    v_mfma_f32_16x16x32_bf16 v[56:59], v[120:123], v[136:139], v[56:59]
    v_mfma_f32_16x16x32_bf16 v[60:63], v[120:123], v[140:143], v[60:63]
    v_mfma_f32_16x16x32_bf16 v[64:67], v[124:127], v[128:131], v[64:67]
    v_mfma_f32_16x16x32_bf16 v[68:71], v[124:127], v[132:135], v[68:71]
    s_cbranch_scc1 L_k4f_loop
    s_waitcnt vmcnt(0)
    v_mov_b32 v254, 1
    s_mov_b64 exec, 1
    buffer_store_byte v254, off, s[20:23], s47 sc1
    s_mov_b64 exec, -1
    s_add_u32 s47, s47, 8192
    s_branch L_k4f_loop
L_k4f_done:
    s_add_u32 s24, s8, 0x2500000
    s_addc_u32 s25, s9, 0
    s_mov_b32 s26, 0x900000
    s_mov_b32 s27, 0x20000
    s_lshl_b32 s40, s29, 2
    s_add_u32 s40, s40, s31
    s_lshl_b32 s46, s40, 17
    s_and_b32 s42, s28, 3
    s_lshl_b32 s43, s42, 13
    s_add_u32 s43, s43, s46
    s_lshl_b32 s46, s30, 15
    s_add_u32 s46, s46, s43
    s_add_u32 s48, s46, 4096
    s_waitcnt lgkmcnt(0)
    s_load_dwordx2 s[4:5], s[0:1], 72
    v_cvt_pk_bf16_f32 v72, v4, v5
    v_cvt_pk_bf16_f32 v73, v6, v7
    v_cvt_pk_bf16_f32 v74, v20, v21
    v_cvt_pk_bf16_f32 v75, v22, v23
    buffer_store_dwordx4 v[72:75], v252, s[24:27], s46 offen offset:2048 sc1
    v_cvt_pk_bf16_f32 v76, v36, v37
    v_cvt_pk_bf16_f32 v77, v38, v39
    v_cvt_pk_bf16_f32 v78, v52, v53
    v_cvt_pk_bf16_f32 v79, v54, v55
    buffer_store_dwordx4 v[76:79], v252, s[24:27], s46 offen offset:3072 sc1
    v_cvt_pk_bf16_f32 v80, v8, v9
    v_cvt_pk_bf16_f32 v81, v10, v11
    v_cvt_pk_bf16_f32 v82, v24, v25
    v_cvt_pk_bf16_f32 v83, v26, v27
    buffer_store_dwordx4 v[80:83], v252, s[24:27], s48 offen offset:0 sc1
    v_cvt_pk_bf16_f32 v84, v40, v41
    v_cvt_pk_bf16_f32 v85, v42, v43
    v_cvt_pk_bf16_f32 v86, v56, v57
    v_cvt_pk_bf16_f32 v87, v58, v59
    buffer_store_dwordx4 v[84:87], v252, s[24:27], s48 offen offset:1024 sc1
    v_cvt_pk_bf16_f32 v88, v12, v13
    v_cvt_pk_bf16_f32 v89, v14, v15
    v_cvt_pk_bf16_f32 v90, v28, v29
    v_cvt_pk_bf16_f32 v91, v30, v31
    buffer_store_dwordx4 v[88:91], v252, s[24:27], s48 offen offset:2048 sc1
    v_cvt_pk_bf16_f32 v92, v44, v45
    v_cvt_pk_bf16_f32 v93, v46, v47
    v_cvt_pk_bf16_f32 v94, v60, v61
    v_cvt_pk_bf16_f32 v95, v62, v63
    buffer_store_dwordx4 v[92:95], v252, s[24:27], s48 offen offset:3072 sc1
    v_cvt_pk_bf16_f32 v96, v64, v65
    v_cvt_pk_bf16_f32 v97, v66, v67
    v_cvt_pk_bf16_f32 v98, v68, v69
    v_cvt_pk_bf16_f32 v99, v70, v71
    buffer_store_dwordx4 v[96:99], v252, s[24:27], s46 offen sc1
    s_add_u32 s12, s8, 0xe00000
    s_addc_u32 s13, s9, 0
    s_mov_b32 s14, 0x240000
    s_mov_b32 s15, 0x20000
    s_lshl_b32 s36, s29, 3
    s_lshl_b32 s37, s44, 2
    s_add_u32 s36, s36, s37
    s_add_u32 s36, s36, s63
    s_mul_i32 s37, s36, 18432
    s_lshl_b32 s38, s31, 1
    s_add_u32 s38, s38, s45
    s_lshl_b32 s39, s38, 11
    s_add_u32 s39, s39, s37
    buffer_load_dwordx4 v[186:189], v252, s[12:15], s39 offen
    buffer_load_dwordx4 v[190:193], v252, s[12:15], s39 offen offset:1024
    s_lshr_b32 s39, s31, 1
    s_lshl_b32 s39, s39, 10
    s_and_b32 s49, s31, 1
    s_lshl_b32 s49, s49, 3
    s_add_u32 s39, s39, s49
    s_add_u32 s39, s39, s37
    s_add_u32 s39, s39, 16384
    buffer_load_dwordx2 v[194:195], v252, s[12:15], s39 offen
    s_lshl_b32 s38, s38, 7
    s_add_u32 s38, s38, s37
    s_lshl_b32 s39, s31, 5
    s_add_u32 s39, s39, s37
    s_add_u32 s39, s39, 1024
    v_bfe_u32 v196, v252, 4, 4
    v_mul_u32_u24 v196, 1152, v196
    v_lshrrev_b32 v198, 8, v252
    v_lshl_add_u32 v199, v198, 3, v196
    v_and_b32 v197, 1, v198
    v_lshl_add_u32 v196, v197, 5, v196
    v_lshrrev_b32 v197, 1, v198
    v_lshl_add_u32 v196, v197, 4, v196
    v_lshlrev_b32 v197, 3, v252
    s_lshl_b32 s41, s40, 1
    s_add_u32 s41, s41, s44
    s_lshl_b32 s41, s41, 10
    s_add_u32 s41, s41, 327680
    s_lshl_b32 s47, s30, 1
    s_add_u32 s47, s47, s45
    s_lshl_b32 s47, s47, 7
    s_add_u32 s47, s47, s41
    s_waitcnt lgkmcnt(0)
    s_mov_b32 s16, s4
    s_mov_b32 s17, s5
    s_mov_b32 s18, 0x240000
    s_mov_b32 s19, 0x20000
    s_xor_b32 s49, s30, 1
    s_lshl_b32 s49, s49, 15
    s_add_u32 s61, s49, s43
    s_add_u32 s61, s61, 2048
    s_add_u32 s57, s49, s43
    s_add_u32 s57, s57, 8
    s_xor_b32 s49, s30, 2
    s_lshl_b32 s49, s49, 15
    s_add_u32 s62, s49, s43
    s_add_u32 s62, s62, 4096
    s_add_u32 s58, s49, s43
    s_add_u32 s58, s58, 8192
    s_xor_b32 s49, s30, 3
    s_lshl_b32 s49, s49, 15
    s_add_u32 s63, s49, s43
    s_add_u32 s63, s63, 6144
    s_add_u32 s59, s49, s43
    s_add_u32 s59, s59, 8200
    v_mov_b32 v254, 1
    s_waitcnt vmcnt(3)
    s_mov_b64 exec, 1
    buffer_store_dword v254, off, s[20:23], s47 sc1
    s_mov_b64 exec, -1
    s_waitcnt vmcnt(1)
    v_lshlrev_b32 v108, 16, v186
    v_and_b32 v109, 0xffff0000, v186
    v_add_f32 v0, v0, v108
    v_add_f32 v1, v1, v109
    v_lshlrev_b32 v108, 16, v187
    v_and_b32 v109, 0xffff0000, v187
    v_add_f32 v2, v2, v108
    v_add_f32 v3, v3, v109
    v_lshlrev_b32 v108, 16, v188
    v_and_b32 v109, 0xffff0000, v188
    v_add_f32 v16, v16, v108
    v_add_f32 v17, v17, v109
    v_lshlrev_b32 v108, 16, v189
    v_and_b32 v109, 0xffff0000, v189
    v_add_f32 v18, v18, v108
    v_add_f32 v19, v19, v109
    v_lshlrev_b32 v108, 16, v190
    v_and_b32 v109, 0xffff0000, v190
    v_add_f32 v32, v32, v108
    v_add_f32 v33, v33, v109
    v_lshlrev_b32 v108, 16, v191
    v_and_b32 v109, 0xffff0000, v191
    v_add_f32 v34, v34, v108
    v_add_f32 v35, v35, v109
    v_lshlrev_b32 v108, 16, v192
    v_and_b32 v109, 0xffff0000, v192
    v_add_f32 v48, v48, v108
    v_add_f32 v49, v49, v109
    v_lshlrev_b32 v108, 16, v193
    v_and_b32 v109, 0xffff0000, v193
    v_add_f32 v50, v50, v108
    v_add_f32 v51, v51, v109
    v_lshlrev_b32 v108, 16, v194
    v_and_b32 v109, 0xffff0000, v194
    v_add_f32 v64, v64, v108
    v_add_f32 v65, v65, v109
    v_lshlrev_b32 v108, 16, v195
    v_and_b32 v109, 0xffff0000, v195
    v_add_f32 v66, v66, v108
    v_add_f32 v67, v67, v109
    s_mov_b64 exec, 0xff
    s_mov_b32 s55, 0x20000
L_sequential_preLN__spectral_fnet__glu_gated_glu__prompt_pagain_33:
    buffer_load_dword v56, v197, s[20:23], s41 offen sc1
    s_waitcnt vmcnt(0)
    v_cmp_ne_u32 vcc, 1, v56
    s_nop 4
    s_cbranch_vccz L_sequential_preLN__spectral_fnet__glu_gated_glu__prompt_pw_34
    s_sleep 2
    s_sub_u32 s55, s55, 1
    s_cbranch_scc0 L_sequential_preLN__spectral_fnet__glu_gated_glu__prompt_pagain_33
L_sequential_preLN__spectral_fnet__glu_gated_glu__prompt_pw_34:
L_sequential_preLN__spectral_fnet__glu_gated_glu__prompt_pok_32:
    s_mov_b64 exec, -1
    buffer_load_dwordx4 v[112:115], v252, s[24:27], s61 offen sc1
    buffer_load_dwordx4 v[116:119], v252, s[24:27], s61 offen offset:1024 sc1
    buffer_load_dwordx2 v[120:121], v252, s[24:27], s57 offen sc1
    buffer_load_dwordx4 v[122:125], v252, s[24:27], s62 offen sc1
    buffer_load_dwordx4 v[126:129], v252, s[24:27], s62 offen offset:1024 sc1
    buffer_load_dwordx2 v[130:131], v252, s[24:27], s58 offen sc1
    buffer_load_dwordx4 v[132:135], v252, s[24:27], s63 offen sc1
    buffer_load_dwordx4 v[136:139], v252, s[24:27], s63 offen offset:1024 sc1
    buffer_load_dwordx2 v[140:141], v252, s[24:27], s59 offen sc1
    s_waitcnt vmcnt(6)
    v_lshlrev_b32 v108, 16, v112
    v_and_b32 v109, 0xffff0000, v112
    v_add_f32 v0, v0, v108
    v_add_f32 v1, v1, v109
    v_lshlrev_b32 v108, 16, v113
    v_and_b32 v109, 0xffff0000, v113
    v_add_f32 v2, v2, v108
    v_add_f32 v3, v3, v109
    v_lshlrev_b32 v108, 16, v114
    v_and_b32 v109, 0xffff0000, v114
    v_add_f32 v16, v16, v108
    v_add_f32 v17, v17, v109
    v_lshlrev_b32 v108, 16, v115
    v_and_b32 v109, 0xffff0000, v115
    v_add_f32 v18, v18, v108
    v_add_f32 v19, v19, v109
    v_lshlrev_b32 v108, 16, v116
    v_and_b32 v109, 0xffff0000, v116
    v_add_f32 v32, v32, v108
    v_add_f32 v33, v33, v109
    v_lshlrev_b32 v108, 16, v117
    v_and_b32 v109, 0xffff0000, v117
    v_add_f32 v34, v34, v108
    v_add_f32 v35, v35, v109
    v_lshlrev_b32 v108, 16, v118
    v_and_b32 v109, 0xffff0000, v118
    v_add_f32 v48, v48, v108
    v_add_f32 v49, v49, v109
    v_lshlrev_b32 v108, 16, v119
    v_and_b32 v109, 0xffff0000, v119
    v_add_f32 v50, v50, v108
    v_add_f32 v51, v51, v109
    v_lshlrev_b32 v108, 16, v120
    v_and_b32 v109, 0xffff0000, v120
    v_add_f32 v64, v64, v108
    v_add_f32 v65, v65, v109
    v_lshlrev_b32 v108, 16, v121
    v_and_b32 v109, 0xffff0000, v121
    v_add_f32 v66, v66, v108
    v_add_f32 v67, v67, v109
    s_waitcnt vmcnt(3)
    v_lshlrev_b32 v108, 16, v122
    v_and_b32 v109, 0xffff0000, v122
    v_add_f32 v0, v0, v108
    v_add_f32 v1, v1, v109
    v_lshlrev_b32 v108, 16, v123
    v_and_b32 v109, 0xffff0000, v123
    v_add_f32 v2, v2, v108
    v_add_f32 v3, v3, v109
    v_lshlrev_b32 v108, 16, v124
    v_and_b32 v109, 0xffff0000, v124
    v_add_f32 v16, v16, v108
    v_add_f32 v17, v17, v109
    v_lshlrev_b32 v108, 16, v125
    v_and_b32 v109, 0xffff0000, v125
    v_add_f32 v18, v18, v108
    v_add_f32 v19, v19, v109
    v_lshlrev_b32 v108, 16, v126
    v_and_b32 v109, 0xffff0000, v126
    v_add_f32 v32, v32, v108
    v_add_f32 v33, v33, v109
    v_lshlrev_b32 v108, 16, v127
    v_and_b32 v109, 0xffff0000, v127
    v_add_f32 v34, v34, v108
    v_add_f32 v35, v35, v109
    v_lshlrev_b32 v108, 16, v128
    v_and_b32 v109, 0xffff0000, v128
    v_add_f32 v48, v48, v108
    v_add_f32 v49, v49, v109
    v_lshlrev_b32 v108, 16, v129
    v_and_b32 v109, 0xffff0000, v129
    v_add_f32 v50, v50, v108
    v_add_f32 v51, v51, v109
    v_lshlrev_b32 v108, 16, v130
    v_and_b32 v109, 0xffff0000, v130
    v_add_f32 v64, v64, v108
    v_add_f32 v65, v65, v109
    v_lshlrev_b32 v108, 16, v131
    v_and_b32 v109, 0xffff0000, v131
    v_add_f32 v66, v66, v108
    v_add_f32 v67, v67, v109
    s_waitcnt vmcnt(0)
    v_lshlrev_b32 v108, 16, v132
    v_and_b32 v109, 0xffff0000, v132
    v_add_f32 v0, v0, v108
    v_add_f32 v1, v1, v109
    v_lshlrev_b32 v108, 16, v133
    v_and_b32 v109, 0xffff0000, v133
    v_add_f32 v2, v2, v108
    v_add_f32 v3, v3, v109
    v_lshlrev_b32 v108, 16, v134
    v_and_b32 v109, 0xffff0000, v134
    v_add_f32 v16, v16, v108
    v_add_f32 v17, v17, v109
    v_lshlrev_b32 v108, 16, v135
    v_and_b32 v109, 0xffff0000, v135
    v_add_f32 v18, v18, v108
    v_add_f32 v19, v19, v109
    v_lshlrev_b32 v108, 16, v136
    v_and_b32 v109, 0xffff0000, v136
    v_add_f32 v32, v32, v108
    v_add_f32 v33, v33, v109
    v_lshlrev_b32 v108, 16, v137
    v_and_b32 v109, 0xffff0000, v137
    v_add_f32 v34, v34, v108
    v_add_f32 v35, v35, v109
    v_lshlrev_b32 v108, 16, v138
    v_and_b32 v109, 0xffff0000, v138
    v_add_f32 v48, v48, v108
    v_add_f32 v49, v49, v109
    v_lshlrev_b32 v108, 16, v139
    v_and_b32 v109, 0xffff0000, v139
    v_add_f32 v50, v50, v108
    v_add_f32 v51, v51, v109
    v_lshlrev_b32 v108, 16, v140
    v_and_b32 v109, 0xffff0000, v140
    v_add_f32 v64, v64, v108
    v_add_f32 v65, v65, v109
    v_lshlrev_b32 v108, 16, v141
    v_and_b32 v109, 0xffff0000, v141
    v_add_f32 v66, v66, v108
    v_add_f32 v67, v67, v109
    v_cvt_pk_bf16_f32 v72, v0, v1
    v_cvt_pk_bf16_f32 v73, v2, v3
    v_cvt_pk_bf16_f32 v74, v16, v17
    v_cvt_pk_bf16_f32 v75, v18, v19
    v_cvt_pk_bf16_f32 v76, v32, v33
    v_cvt_pk_bf16_f32 v77, v34, v35
    v_cvt_pk_bf16_f32 v78, v48, v49
    v_cvt_pk_bf16_f32 v79, v50, v51
    v_cvt_pk_bf16_f32 v80, v64, v65
    v_cvt_pk_bf16_f32 v81, v66, v67
    s_nop 1
    v_permlane16_swap_b32 v72, v74
    v_permlane16_swap_b32 v73, v75
    v_permlane16_swap_b32 v76, v78
    v_permlane16_swap_b32 v77, v79
    s_nop 1
    buffer_store_dwordx4 v[72:75], v196, s[16:19], s38 offen
    buffer_store_dwordx4 v[76:79], v196, s[16:19], s38 offen offset:64
    s_cmp_lg_u32 s45, 0
    s_cbranch_scc1 L_k4f_noex
    buffer_store_dwordx2 v[80:81], v199, s[16:19], s39 offen
L_k4f_noex:
    s_endpgm
L_k4f_loader:
    s_load_dwordx8 s[72:79], s[6:7], s35
    s_waitcnt vmcnt(18)
    s_setprio 0
    s_barrier
    s_add_u32 s46, s50, 24576
    buffer_store_dwordx4 v[240:243], v252, s[24:27], s46 offen offset:0 sc1
    buffer_store_dwordx4 v[244:247], v252, s[24:27], s46 offen offset:1024 sc1
    s_add_u32 m0, s49, 0
    s_nop 0
    buffer_load_dwordx4 v252, s[24:27], s89 offen offset:0 sc1 lds
    buffer_load_dwordx4 v252, s[24:27], s89 offen offset:1024 sc1 lds
    buffer_load_dwordx4 v252, s[24:27], s89 offen offset:2048 sc1 lds
    buffer_load_dwordx4 v252, s[24:27], s89 offen offset:3072 sc1 lds
    s_add_u32 m0, s56, 0
    s_mov_b64 exec, s[40:41]
    buffer_load_dwordx4 v252, s[12:15], s91 offen lds
    s_add_u32 m0, s48, 0
    s_mov_b64 exec, -1
    buffer_load_dwordx4 v160, s[16:19], s90 offen offset:0 lds
    s_add_u32 s89, s89, 8192
    s_add_u32 s91, s91, 4096
    buffer_load_dwordx4 v161, s[16:19], s90 offen offset:1024 lds
    buffer_load_dwordx4 v162, s[16:19], s90 offen offset:2048 lds
    buffer_load_dwordx4 v163, s[16:19], s90 offen offset:3072 lds
    s_add_u32 s90, s90, 36864
    v_mul_f32 v144, 0xbfb8aa3b, v144
    v_mul_f32 v145, 0xbfb8aa3b, v145
    v_mul_f32 v146, 0xbfb8aa3b, v146
    v_mul_f32 v147, 0xbfb8aa3b, v147
    v_exp_f32 v144, v144
    v_exp_f32 v145, v145
    v_exp_f32 v146, v146
    v_exp_f32 v147, v147
    v_add_f32 v144, 1.0, v144
    v_add_f32 v145, 1.0, v145
    v_add_f32 v146, 1.0, v146
    v_add_f32 v147, 1.0, v147
    v_rcp_f32 v144, v144
    v_rcp_f32 v145, v145
    v_rcp_f32 v146, v146
    v_rcp_f32 v147, v147
    v_mul_f32 v144, v144, v152
    v_mul_f32 v145, v145, v153
    v_mul_f32 v146, v146, v154
    v_mul_f32 v147, v147, v155
    v_cvt_pk_bf16_f32 v208, v144, v145
    v_cvt_pk_bf16_f32 v209, v146, v147
    v_mul_f32 v148, 0xbfb8aa3b, v148
    v_mul_f32 v149, 0xbfb8aa3b, v149
    v_mul_f32 v150, 0xbfb8aa3b, v150
    v_mul_f32 v151, 0xbfb8aa3b, v151
    v_exp_f32 v148, v148
    v_exp_f32 v149, v149
    v_exp_f32 v150, v150
    v_exp_f32 v151, v151
    v_add_f32 v148, 1.0, v148
    v_add_f32 v149, 1.0, v149
    v_add_f32 v150, 1.0, v150
    v_add_f32 v151, 1.0, v151
    v_rcp_f32 v148, v148
    v_rcp_f32 v149, v149
    v_rcp_f32 v150, v150
    v_rcp_f32 v151, v151
    v_mul_f32 v148, v148, v156
    v_mul_f32 v149, v149, v157
    v_mul_f32 v150, v150, v158
    v_mul_f32 v151, v151, v159
    v_cvt_pk_bf16_f32 v210, v148, v149
    v_cvt_pk_bf16_f32 v211, v150, v151
    s_nop 1
    v_permlane16_swap_b32 v208, v210
    v_permlane16_swap_b32 v209, v211
    s_nop 1
    buffer_store_dwordx4 v[208:211], v249, s[24:27], s51 offen sc1
    v_add_u32 v168, 0, v160
    v_add_u32 v169, 4608, v161
    v_add_u32 v170, 9216, v162
    v_add_u32 v171, 13824, v163
    s_mov_b32 s62, 0x01010101
    s_waitcnt lgkmcnt(0)
    s_and_b64 s[72:73], s[72:73], s[74:75]
    s_and_b64 s[76:77], s[76:77], s[78:79]
    s_and_b64 s[72:73], s[72:73], s[76:77]
    s_and_b32 s72, s72, s73
    s_and_b32 s72, s72, s62
    s_cmp_eq_u32 s72, s62
    s_cbranch_scc1 L_sequential_preLN__spectral_fnet__glu_gated_glu__prompt_ok_35
    s_mov_b32 s55, 0x40000
L_sequential_preLN__spectral_fnet__glu_gated_glu__prompt_again_36:
    buffer_load_dword v255, v253, s[20:23], s35 offen sc1
    s_waitcnt vmcnt(0)
    v_and_b32 v255, s62, v255
    v_cmp_ne_u32 vcc, s62, v255
    s_nop 4
    s_cbranch_vccz L_sequential_preLN__spectral_fnet__glu_gated_glu__prompt_ok_35
    s_sub_u32 s55, s55, 1
    s_cbranch_scc1 L_sequential_preLN__spectral_fnet__glu_gated_glu__prompt_ok_35
    s_sleep 2
    s_branch L_sequential_preLN__spectral_fnet__glu_gated_glu__prompt_again_36
L_sequential_preLN__spectral_fnet__glu_gated_glu__prompt_ok_35:
    s_add_u32 s35, s35, 8192
    s_mov_b32 s43, 0
L_k4f_lloop:
    s_add_u32 m0, s49, 34816
    s_waitcnt vmcnt(18)
    s_barrier
    buffer_load_dwordx4 v252, s[24:27], s80 offen offset:0 sc1 lds
    buffer_load_dwordx4 v252, s[24:27], s80 offen offset:1024 sc1 lds
    buffer_load_dwordx4 v252, s[24:27], s80 offen offset:2048 sc1 lds
    buffer_load_dwordx4 v252, s[24:27], s80 offen offset:3072 sc1 lds
    s_add_u32 m0, s56, 34816
    s_mov_b64 exec, s[40:41]
    buffer_load_dwordx4 v252, s[12:15], s82 offen lds
    s_add_u32 m0, s48, 34816
    s_mov_b64 exec, -1
    buffer_load_dwordx4 v160, s[16:19], s81 offen offset:0 lds
    s_add_u32 s80, s80, 8192
    s_add_u32 s82, s82, 4096
    buffer_load_dwordx4 v161, s[16:19], s81 offen offset:1024 lds
    buffer_load_dwordx4 v162, s[16:19], s81 offen offset:2048 lds
    buffer_load_dwordx4 v163, s[16:19], s81 offen offset:3072 lds
    s_add_u32 s81, s81, 36864
    s_add_u32 m0, s49, 69632
    s_waitcnt vmcnt(18)
    s_barrier
    buffer_load_dwordx4 v252, s[24:27], s83 offen offset:0 sc1 lds
    buffer_load_dwordx4 v252, s[24:27], s83 offen offset:1024 sc1 lds
    buffer_load_dwordx4 v252, s[24:27], s83 offen offset:2048 sc1 lds
    buffer_load_dwordx4 v252, s[24:27], s83 offen offset:3072 sc1 lds
    s_add_u32 m0, s56, 69632
    s_mov_b64 exec, s[40:41]
    buffer_load_dwordx4 v252, s[12:15], s85 offen lds
    s_add_u32 m0, s48, 69632
    s_mov_b64 exec, -1
    buffer_load_dwordx4 v160, s[16:19], s84 offen offset:0 lds
    s_add_u32 s83, s83, 8192
    s_add_u32 s85, s85, 4096
    buffer_load_dwordx4 v161, s[16:19], s84 offen offset:1024 lds
    buffer_load_dwordx4 v162, s[16:19], s84 offen offset:2048 lds
    buffer_load_dwordx4 v163, s[16:19], s84 offen offset:3072 lds
    s_add_u32 s84, s84, 36864
    s_add_u32 m0, s49, 104448
    s_waitcnt vmcnt(18)
    s_barrier
    buffer_load_dwordx4 v252, s[24:27], s86 offen offset:0 sc1 lds
    buffer_load_dwordx4 v252, s[24:27], s86 offen offset:1024 sc1 lds
    buffer_load_dwordx4 v252, s[24:27], s86 offen offset:2048 sc1 lds
    buffer_load_dwordx4 v252, s[24:27], s86 offen offset:3072 sc1 lds
    s_add_u32 m0, s56, 104448
    s_mov_b64 exec, s[40:41]
    buffer_load_dwordx4 v252, s[12:15], s88 offen lds
    s_add_u32 m0, s48, 104448
    s_mov_b64 exec, -1
    buffer_load_dwordx4 v160, s[16:19], s87 offen offset:0 lds
    s_add_u32 s86, s86, 8192
    s_add_u32 s88, s88, 4096
    buffer_load_dwordx4 v161, s[16:19], s87 offen offset:1024 lds
    buffer_load_dwordx4 v162, s[16:19], s87 offen offset:2048 lds
    buffer_load_dwordx4 v163, s[16:19], s87 offen offset:3072 lds
    s_add_u32 s87, s87, 36864
    s_cmp_eq_u32 s43, 0
    s_cbranch_scc0 L_k4f_nofl
    v_mov_b32 v254, 1
    s_mov_b64 exec, 1
    buffer_store_byte v254, off, s[20:23], s47 sc1
    s_mov_b64 exec, -1
    s_add_u32 s47, s47, 8192
L_k4f_nofl:
    s_load_dwordx8 s[72:79], s[6:7], s35
    s_add_u32 m0, s49, 0
    s_waitcnt vmcnt(18)
    s_barrier
    buffer_load_dwordx4 v252, s[24:27], s89 offen offset:0 sc1 lds
    buffer_load_dwordx4 v252, s[24:27], s89 offen offset:1024 sc1 lds
    buffer_load_dwordx4 v252, s[24:27], s89 offen offset:2048 sc1 lds
    buffer_load_dwordx4 v252, s[24:27], s89 offen offset:3072 sc1 lds
    s_add_u32 m0, s56, 0
    s_mov_b64 exec, s[40:41]
    buffer_load_dwordx4 v252, s[12:15], s91 offen lds
    s_add_u32 m0, s48, 0
    s_mov_b64 exec, -1
    buffer_load_dwordx4 v160, s[16:19], s90 offen offset:0 lds
    s_add_u32 s89, s89, 8192
    s_add_u32 s91, s91, 4096
    buffer_load_dwordx4 v161, s[16:19], s90 offen offset:1024 lds
    buffer_load_dwordx4 v162, s[16:19], s90 offen offset:2048 lds
    buffer_load_dwordx4 v163, s[16:19], s90 offen offset:3072 lds
    s_add_u32 s90, s90, 36864
    s_cmp_eq_u32 s43, 2
    s_cbranch_scc1 L_k4f_lx
    s_mov_b32 s62, 0x01010101
    s_waitcnt lgkmcnt(0)
    s_and_b64 s[72:73], s[72:73], s[74:75]
    s_and_b64 s[76:77], s[76:77], s[78:79]
    s_and_b64 s[72:73], s[72:73], s[76:77]
    s_and_b32 s72, s72, s73
    s_and_b32 s72, s72, s62
    s_cmp_eq_u32 s72, s62
    s_cbranch_scc1 L_sequential_preLN__spectral_fnet__glu_gated_glu__prompt_ok_37
    s_mov_b32 s55, 0x40000
L_sequential_preLN__spectral_fnet__glu_gated_glu__prompt_again_38:
    buffer_load_dword v255, v253, s[20:23], s35 offen sc1
    s_waitcnt vmcnt(0)
    v_and_b32 v255, s62, v255
    v_cmp_ne_u32 vcc, s62, v255
    s_nop 4
    s_cbranch_vccz L_sequential_preLN__spectral_fnet__glu_gated_glu__prompt_ok_37
    s_sub_u32 s55, s55, 1
    s_cbranch_scc1 L_sequential_preLN__spectral_fnet__glu_gated_glu__prompt_ok_37
    s_sleep 2
    s_branch L_sequential_preLN__spectral_fnet__glu_gated_glu__prompt_again_38
L_sequential_preLN__spectral_fnet__glu_gated_glu__prompt_ok_37:
    s_add_u32 s35, s35, 8192
    s_add_u32 s43, s43, 1
    s_branch L_k4f_lloop
L_k4f_lx:
    s_add_u32 m0, s49, 34816
    s_waitcnt vmcnt(18)
    s_barrier
    buffer_load_dwordx4 v252, s[24:27], s92 offen offset:0 sc1 lds
    buffer_load_dwordx4 v252, s[24:27], s92 offen offset:1024 sc1 lds
    buffer_load_dwordx4 v252, s[24:27], s92 offen offset:2048 sc1 lds
    buffer_load_dwordx4 v252, s[24:27], s92 offen offset:3072 sc1 lds
    s_add_u32 m0, s56, 34816
    s_mov_b64 exec, s[40:41]
    buffer_load_dwordx4 v252, s[12:15], s94 offen lds
    s_add_u32 m0, s48, 34816
    s_mov_b64 exec, -1
    buffer_load_dwordx4 v168, s[16:19], s93 offen offset:0 lds
    buffer_load_dwordx4 v169, s[16:19], s93 offen offset:1024 lds
    buffer_load_dwordx4 v170, s[16:19], s93 offen offset:2048 lds
    buffer_load_dwordx4 v171, s[16:19], s93 offen offset:3072 lds
    s_add_u32 m0, s49, 69632
    s_waitcnt vmcnt(18)
    s_barrier
    buffer_load_dwordx4 v252, s[24:27], s95 offen offset:0 sc1 lds
    buffer_load_dwordx4 v252, s[24:27], s95 offen offset:1024 sc1 lds
    buffer_load_dwordx4 v252, s[24:27], s95 offen offset:2048 sc1 lds
    buffer_load_dwordx4 v252, s[24:27], s95 offen offset:3072 sc1 lds
    s_add_u32 m0, s56, 69632
    s_mov_b64 exec, s[40:41]
    buffer_load_dwordx4 v252, s[12:15], s97 offen lds
    s_add_u32 m0, s48, 69632
    s_mov_b64 exec, -1
    buffer_load_dwordx4 v168, s[16:19], s96 offen offset:0 lds
    buffer_load_dwordx4 v169, s[16:19], s96 offen offset:1024 lds
    buffer_load_dwordx4 v170, s[16:19], s96 offen offset:2048 lds
    buffer_load_dwordx4 v171, s[16:19], s96 offen offset:3072 lds
    s_waitcnt vmcnt(18)
    s_barrier
    s_waitcnt vmcnt(9)
    s_barrier
    s_waitcnt vmcnt(0) lgkmcnt(0)
    s_barrier
    s_barrier
L_k3_end:
    s_endpgm
.section .rodata,"a"
.p2align 6
.amdhsa_kernel sequential_preLN__spectral_fnet__glu_gated_glu__prompt_kernel
  .amdhsa_next_free_vgpr 256
  .amdhsa_next_free_sgpr 102
  .amdhsa_accum_offset 256
  .amdhsa_group_segment_fixed_size 0
  .amdhsa_kernarg_size 96
  .amdhsa_user_sgpr_count 2
  .amdhsa_user_sgpr_kernarg_segment_ptr 1
  .amdhsa_system_sgpr_workgroup_id_x 1
  .amdhsa_float_denorm_mode_32 3
  .amdhsa_float_denorm_mode_16_64 3
.end_amdhsa_kernel
.text
.p2align 8
L_code_end:
.fill 4096, 4, 0xbf800000
```
